```python
import torch

def _softmax(x, axis=-1):
    return torch.softmax(x, dim=axis)
def _gelu(x):
    return torch.nn.functional.gelu(x, approximate="tanh")
def _silu(x):
    return torch.nn.functional.silu(x)
def _sigmoid(x):
    return torch.sigmoid(x)
def _layernorm(x, axis=-1, eps=1e-5):
    m = x.mean(dim=axis, keepdim=True)
    v = x.var(dim=axis, keepdim=True, unbiased=False)
    return (x - m) / torch.sqrt(v + eps)
def _scatter_add(tgt, idx, src, axis=0):
    return tgt.clone().index_add_(axis, idx, src)
def _segment_sum(src, seg, n):
    out = torch.zeros((n,) + src.shape[1:], dtype=src.dtype)
    return out.index_add_(0, seg, src)
def _pad(x, pw):
    flat = tuple(v for pair in reversed(pw) for v in pair)
    return torch.nn.functional.pad(x, flat)

kernel_name = 'recurrent_scan__compressed_kv_cla__moe_arch_mod__prompt'

def setup_inputs():

    _w = (lambda a: (lambda t: t.to(torch.bfloat16) if t.is_floating_point() else t)(torch.as_tensor(a)))
    def _A_setup():
        B, H, Sq, Sk, D, M = 1, 32, 2048, 2048, 128, 512
        Dc = 4 * D
        return {
            "x": _w((lambda *s: torch.randn(*s, dtype=torch.bfloat16) * 0.05)(B, Sq, M)),
            "c_kv": _w((lambda *s: torch.randn(*s, dtype=torch.bfloat16) * 0.2)(B, Sk, Dc)),
            "w_q": _w((lambda *s: torch.randn(*s, dtype=torch.bfloat16) * 3.2)(M, H, D) * (M ** -0.5)),
            "w_uk": _w((lambda *s: torch.randn(*s, dtype=torch.bfloat16) * 3.2)(Dc, H, D) * (Dc ** -0.5)),
            "w_uv": _w((lambda *s: torch.randn(*s, dtype=torch.bfloat16) * 0.2)(Dc, H, D) * (Dc ** -0.5)),
            "w_o": _w((lambda *s: torch.randn(*s, dtype=torch.bfloat16) * 0.2)(H, D, M) * ((H * D) ** -0.5)),
        }
    _A_in = _A_setup()

    def _B_setup():
        B, S, D, F, C = 1, 2048, 512, 1792, 1
        return {
            "x": _w((lambda *s: torch.randn(*s, dtype=torch.bfloat16) * 0.05)(B, S, D)),
            "w_r": _w((lambda *s: torch.randn(*s, dtype=torch.bfloat16) * 1.6)(D)),
            "w_gate": _w((lambda *s: torch.randn(*s, dtype=torch.bfloat16) * 0.2)(D, F)),
            "w_up": _w((lambda *s: torch.randn(*s, dtype=torch.bfloat16) * 0.2)(D, F)),
            "w_down": _w((lambda *s: torch.randn(*s, dtype=torch.bfloat16) * 0.2)(F, D)),
        }
    _B_in = _B_setup()

    return {
        "A_x": _A_in["x"],
        "A_c_kv": _A_in["c_kv"],
        "A_w_q": _A_in["w_q"],
        "A_w_uk": _A_in["w_uk"],
        "A_w_uv": _A_in["w_uv"],
        "A_w_o": _A_in["w_o"],
        "B_x": _B_in["x"],
        "B_w_r": _B_in["w_r"],
        "B_w_gate": _B_in["w_gate"],
        "B_w_up": _B_in["w_up"],
        "B_w_down": _B_in["w_down"],
    }

def reference(A_x, A_c_kv, A_w_q, A_w_uk, A_w_uv, A_w_o, B_x, B_w_r, B_w_gate, B_w_up, B_w_down):
    def _A_ref(x, c_kv, w_q, w_uk, w_uv, w_o):
        B, Sq, M = x.shape[0], x.shape[1], x.shape[2]
        Sk = c_kv.shape[1]
        H, D = w_q.shape[1], w_q.shape[2]
        q = torch.einsum("bqm,mhd->bhqd", x, w_q)
        k = torch.einsum("bkc,chd->bhkd", c_kv, w_uk)
        v = torch.einsum("bkc,chd->bhkd", c_kv, w_uv)
        scores = torch.einsum("bhqd,bhkd->bhqk", q, k) * (D ** -0.5)
        off = Sk - Sq
        qi = torch.arange(Sq)[:, None]
        kj = torch.arange(Sk)[None, :]
        cmask = kj <= (qi + off)
        scores = torch.where(cmask[None, None], scores, -1e9)
        p = _softmax(scores, axis=-1)
        ctx = torch.einsum("bhqk,bhkd->bhqd", p, v)
        return torch.einsum("bhqd,hdm->bqm", ctx, w_o)

    def _B_ref(x, w_r, w_gate, w_up, w_down):
        B, S, D = x.shape
        C = 1
        r = x @ w_r
        idx = torch.argsort(-r, axis=-1)[:, :C]
        idx_e = (lambda x, n, axis: torch.repeat_interleave(x, n, dim=axis))(idx.reshape(B, C, 1), D, axis=2)
        x_sel = (lambda x, i, axis: torch.take_along_dim(x, i, dim=axis))(x, idx_e, axis=1)
        g = _silu(x_sel @ w_gate)
        u = x_sel @ w_up
        y = (g * u) @ w_down
        r_sel = _sigmoid((lambda x, i, axis: torch.take_along_dim(x, i, dim=axis))(r, idx, axis=1))
        y = y * r_sel.reshape(B, C, 1)
        b_off = (torch.arange(B) * S).reshape(B, 1)
        flat_idx = (idx + b_off).reshape(B * C)
        zero = (x * 0.0).reshape(B * S, D)
        upd = _scatter_add(zero, flat_idx, y.reshape(B * C, D), axis=0)
        return x + upd.reshape(B, S, D)

    x = A_x
    xn = _layernorm(x, axis=-1)
    s = _A_ref(xn, A_c_kv, A_w_q, A_w_uk, A_w_uv, A_w_o)
    g = _silu(_B_ref(xn, B_w_r, B_w_gate, B_w_up, B_w_down))
    return x + s * g
```

```asm
; @launch kernel=kvattn_kernel grid=(256,1,1) block=(512,1,1) lds=163840
.amdgcn_target "amdgcn-amd-amdhsa--gfx950"

.text
.globl kvattn_kernel
.p2align 8
.type kvattn_kernel,@function
kvattn_kernel:
    s_cmp_ge_u32 s2, 256
    s_cbranch_scc1 KF_END
    s_load_dwordx2 s[4:5], s[0:1], 8
    s_load_dwordx4 s[8:11], s[0:1], 24
    s_load_dwordx2 s[16:17], s[0:1], 0
    s_load_dwordx2 s[20:21], s[0:1], 56
    s_load_dwordx2 s[86:87], s[0:1], 104
    s_load_dwordx2 s[88:89], s[0:1], 16
    s_load_dwordx2 s[90:91], s[0:1], 40
    s_load_dwordx4 s[92:95], s[0:1], 64
    s_load_dwordx2 s[96:97], s[0:1], 80
    s_load_dwordx2 s[36:37], s[0:1], 96
    s_setprio 3
    v_lshrrev_b32 v2, 6, v0
    v_and_b32 v1, 63, v0
    s_nop 0
    v_readfirstlane_b32 s40, v2
    s_and_b32 s41, s2, 7
    s_lshl_b32 s41, s41, 2
    s_bfe_u32 s59, s2, 0x20003
    s_add_u32 s41, s41, s59
    s_lshr_b32 s42, s2, 5
    v_lshlrev_b32 v2, 4, v1
    v_lshrrev_b32 v11, 3, v1
    v_lshlrev_b32 v3, 10, v11
    v_and_b32 v60, 7, v1
    v_lshrrev_b32 v61, 4, v1
    v_xor_b32 v62, v60, v61
    v_lshl_add_u32 v63, v62, 4, v3
    v_xor_b32 v62, 4, v62
    v_lshl_add_u32 v4, v62, 4, v3
    v_add_u32 v4, 7168, v4
    v_mov_b32 v3, v63
    v_lshrrev_b32 v5, 2, v1
    v_lshlrev_b32 v5, 13, v5
    v_and_b32 v60, 3, v1
    v_lshl_add_u32 v5, v60, 4, v5
    s_lshl_b32 s66, s40, 12
    s_add_u32 s48, s66, 65536
    s_lshl_b32 s51, s42, 18
    s_and_b32 s59, s40, 1
    s_lshl_b32 s59, s59, 14
    s_add_u32 s60, s51, s59
    s_lshr_b32 s59, s40, 1
    s_lshl_b32 s49, s59, 15
    s_add_u32 s49, s49, s60
    s_lshl_b32 s50, s59, 7
    s_add_u32 s50, s50, s60
    s_lshl_b32 s59, s40, 7
    s_add_u32 s51, s51, s59
    s_lshl_b32 s52, s40, 11
    s_and_b32 s43, s40, 3
    s_lshl_b32 s53, s43, 6
    s_lshl_b32 s59, s41, 8
    s_add_u32 s53, s53, s59
    s_lshl_b32 s54, s42, 16
    s_lshl_b32 s59, s43, 11
    s_add_u32 s54, s54, s59
    s_lshl_b32 s55, s2, 3
    s_add_u32 s55, s55, s40
    s_cmp_lt_u32 s40, 4
    s_waitcnt lgkmcnt(0)
    s_cselect_b32 s8, s8, s10
    s_cselect_b32 s9, s9, s11
    s_and_b32 s9, s9, 0xffff
    s_mov_b32 s10, 0x400000
    s_mov_b32 s11, 0x00020000
    s_and_b32 s5, s5, 0xffff
    s_mov_b32 s6, 0x200000
    s_mov_b32 s7, 0x00020000
    s_and_b32 s17, s17, 0xffff
    s_mov_b32 s18, 0x200000
    s_mov_b32 s19, 0x00020000
    s_and_b32 s21, s21, 0xffff
    s_mov_b32 s22, 0x400
    s_mov_b32 s23, 0x00020000
    s_lshl_b32 s59, s55, 10
    buffer_load_dwordx4 v[232:235], v2, s[16:19], s59 offen
    buffer_load_dwordx4 v[236:239], v2, s[20:23], 0 offen
    v_lshrrev_b32 v12, 3, v1
    v_lshlrev_b32 v12, 20, v12
    v_and_b32 v13, 7, v1
    v_lshlrev_b32 v13, 7, v13
    v_add_u32 v12, v12, v13
    s_lshr_b32 s57, s2, 3
    s_lshl_b32 s57, s57, 2
    s_add_u32 s57, s57, s43
    s_lshl_b32 s57, s57, 13
    s_and_b32 s59, s2, 7
    s_lshl_b32 s59, s59, 10
    s_add_u32 s70, s57, s59
    s_mov_b32 exec_lo, 0xffff
    s_mov_b32 exec_hi, 0
    s_and_b32 s59, s41, 3
    s_cmp_eq_u32 s59, 1
    s_cbranch_scc1 KFT_2
    s_cmp_eq_u32 s41, 31
    s_cbranch_scc1 KFT_2
    s_add_u32 s60, s70, 0xffff8000
    s_cmp_eq_u32 s59, 2
    s_cbranch_scc1 KFT_3
    s_add_u32 s60, s70, 98304
    s_cmp_lg_u32 s41, 28
    s_cbranch_scc1 KFT_1
KFT_3:
    buffer_load_dword v15, v12, s[8:11], s60 offen
KFT_1:
    buffer_load_dword v15, v12, s[8:11], s70 offen
KFT_2:
    s_mov_b64 exec, -1
    s_bitcmp1_b32 s41, 0
    s_cbranch_scc1 KFT_4
    s_lshl_b32 s59, s55, 10
    s_bitcmp1_b32 s41, 1
    s_cselect_b32 s60, 0xffff0000, 0
    s_add_u32 s59, s59, s60
    s_mov_b32 exec_lo, 0xff
    s_mov_b32 exec_hi, 0
    buffer_load_dword v14, v13, s[4:7], s59 offen
    s_mov_b64 exec, -1
KFT_4:
    s_add_u32 m0, s48, 32768
    s_add_u32 s59, s53, 0
    buffer_load_dwordx4 v5, s[8:11], s59 offen lds
    s_add_u32 m0, s48, 33792
    s_add_u32 s59, s53, 131072
    buffer_load_dwordx4 v5, s[8:11], s59 offen lds
    s_add_u32 m0, s48, 34816
    s_add_u32 s59, s53, 262144
    buffer_load_dwordx4 v5, s[8:11], s59 offen lds
    s_add_u32 m0, s48, 35840
    s_add_u32 s59, s53, 393216
    buffer_load_dwordx4 v5, s[8:11], s59 offen lds
    s_add_u32 m0, s52, 32768
    s_add_u32 s59, s49, 0
    buffer_load_dwordx4 v3, s[4:7], s59 offen lds
    buffer_load_dwordx4 v4, s[4:7], s59 offen offset:1024 lds
    s_setprio 0
    s_lshl_b32 s60, s41, 19
    s_add_u32 s59, s60, 16777216
    s_add_u32 s28, s86, s59
    s_addc_u32 s29, s87, 0
    s_add_u32 s59, s60, 33554432
    s_add_u32 s32, s86, s59
    s_addc_u32 s33, s87, 0
    s_cmp_lt_u32 s40, 4
    s_cselect_b32 s12, s28, s32
    s_cselect_b32 s13, s29, s33
    s_and_b32 s13, s13, 0xffff
    s_mov_b32 s14, 0x80000
    s_mov_b32 s15, 0x00020000
    s_mov_b32 s24, s86
    s_and_b32 s25, s87, 0xffff
    s_mov_b32 s26, 0x900000
    s_mov_b32 s27, 0x00020000
    s_and_b32 s37, s37, 0xffff
    s_mov_b32 s38, 0x100
    s_mov_b32 s39, 0x00020000
    v_and_b32 v60, 15, v1
    v_lshrrev_b32 v61, 4, v1
    v_bfe_u32 v62, v1, 1, 3
    v_xor_b32 v62, v62, v61
    v_lshlrev_b32 v60, 7, v60
    v_lshl_add_u32 v6, v62, 4, v60
    v_xor_b32 v62, 4, v62
    v_lshl_add_u32 v7, v62, 4, v60
    v_lshrrev_b32 v60, 4, v1
    v_lshlrev_b32 v60, 9, v60
    v_bfe_u32 v61, v1, 2, 2
    v_lshl_add_u32 v60, v61, 6, v60
    v_and_b32 v61, 3, v1
    v_lshl_add_u32 v60, v61, 3, v60
    v_add_u32 v8, s48, v60
    v_add_u32 v9, 0x10000, v8
    v_mov_b32 v11, 0
    s_lshl_b32 s58, s55, 2
    s_add_u32 s58, s58, 2097152
    s_sub_u32 s56, 2047, s55
    s_sub_u32 s46, 15, s42
    s_cmp_lt_u32 s40, 4
    s_cselect_b32 s44, s46, s42
    s_sub_u32 s59, 3, s43
    s_cmp_lt_u32 s40, 4
    s_cselect_b32 s59, s43, s59
    s_lshl_b32 s44, s44, 2
    s_add_u32 s44, s44, s59
    s_lshr_b32 s45, s44, 1
    s_lshl_b32 s46, s46, 1
    s_add_u32 s46, s46, 2
    s_and_b32 s29, s29, 0xffff
    s_lshl_b32 s30, s46, 14
    s_mov_b32 s31, 0x00020000
    s_and_b32 s33, s33, 0xffff
    s_lshl_b32 s34, s46, 14
    s_mov_b32 s35, 0x00020000
    s_lshl_b32 s65, s41, 8
    s_lshl_b32 s59, s40, 17
    s_add_u32 s65, s65, s59
    s_lshl_b32 s67, s44, 15
    s_lshl_b32 s68, s43, 12
    s_lshl_b32 s69, s43, 12
    s_add_u32 s59, s46, 3
    s_lshr_b32 s59, s59, 2
    s_bfm_b32 s77, s59, 0
    s_lshl_b32 s76, s41, 7
    s_add_u32 s76, s76, 2293760
    s_cmp_lg_u32 s40, 0
    s_cbranch_scc1 KF_NZ
    s_lshl_b32 s59, s2, 7
    s_add_u32 s59, s59, 2293760
    v_lshlrev_b32 v60, 2, v1
    s_mov_b32 exec_hi, 0
    buffer_store_dword v11, v60, s[24:27], s59 offen sc1
    s_mov_b64 exec, -1
    v_mov_b32 v16, 0
    v_mov_b32 v17, 0
    v_mov_b32 v18, 0
    v_mov_b32 v19, 0
    s_lshl_b32 s59, s2, 10
    s_add_u32 s59, s59, 4194304
    buffer_store_dwordx4 v[16:19], v2, s[24:27], s59 offen sc1
KF_NZ:
    s_cmp_lg_u32 s40, 4
    s_cbranch_scc1 KF_NS
    s_lshl_b32 s59, s2, 8
    s_add_u32 s59, s59, 2162688
    v_lshlrev_b32 v60, 2, v1
    buffer_store_dword v1, v60, s[24:27], s59 offen
KF_NS:
    s_waitcnt vmcnt(6)
    v_lshlrev_b32 v240, 16, v232
    v_and_b32 v241, 0xffff0000, v232
    v_lshlrev_b32 v242, 16, v233
    v_and_b32 v243, 0xffff0000, v233
    v_lshlrev_b32 v244, 16, v234
    v_and_b32 v245, 0xffff0000, v234
    v_lshlrev_b32 v246, 16, v235
    v_and_b32 v247, 0xffff0000, v235
    v_readfirstlane_b32 s59, v240
    s_nop 1
    v_subrev_f32 v248, s59, v240
    v_mul_f32 v249, v248, v248
    v_subrev_f32 v251, s59, v241
    v_add_f32 v248, v248, v251
    v_fmac_f32 v249, v251, v251
    v_subrev_f32 v250, s59, v242
    v_add_f32 v248, v248, v250
    v_fmac_f32 v249, v250, v250
    v_subrev_f32 v251, s59, v243
    v_add_f32 v248, v248, v251
    v_fmac_f32 v249, v251, v251
    v_subrev_f32 v250, s59, v244
    v_add_f32 v248, v248, v250
    v_fmac_f32 v249, v250, v250
    v_subrev_f32 v251, s59, v245
    v_add_f32 v248, v248, v251
    v_fmac_f32 v249, v251, v251
    v_subrev_f32 v250, s59, v246
    v_add_f32 v248, v248, v250
    v_fmac_f32 v249, v250, v250
    v_subrev_f32 v251, s59, v247
    v_add_f32 v248, v248, v251
    v_fmac_f32 v249, v251, v251
    s_nop 0
    s_nop 0
    v_add_f32_dpp v248, v248, v248 quad_perm:[1,0,3,2] row_mask:0xf bank_mask:0xf
    v_add_f32_dpp v249, v249, v249 quad_perm:[1,0,3,2] row_mask:0xf bank_mask:0xf
    s_nop 0
    v_add_f32_dpp v248, v248, v248 quad_perm:[2,3,0,1] row_mask:0xf bank_mask:0xf
    v_add_f32_dpp v249, v249, v249 quad_perm:[2,3,0,1] row_mask:0xf bank_mask:0xf
    s_nop 0
    v_add_f32_dpp v248, v248, v248 row_half_mirror row_mask:0xf bank_mask:0xf
    v_add_f32_dpp v249, v249, v249 row_half_mirror row_mask:0xf bank_mask:0xf
    s_nop 0
    v_add_f32_dpp v248, v248, v248 row_mirror row_mask:0xf bank_mask:0xf
    v_add_f32_dpp v249, v249, v249 row_mirror row_mask:0xf bank_mask:0xf
    v_readlane_b32 s78, v248, 0
    v_readlane_b32 s79, v248, 16
    v_readlane_b32 s80, v248, 32
    v_readlane_b32 s81, v248, 48
    v_readlane_b32 s82, v249, 0
    v_readlane_b32 s83, v249, 16
    v_readlane_b32 s84, v249, 32
    v_readlane_b32 s85, v249, 48
    v_mov_b32 v248, s78
    v_add_f32 v248, s79, v248
    v_mov_b32 v249, s82
    v_add_f32 v249, s83, v249
    v_add_f32 v248, s80, v248
    v_add_f32 v249, s84, v249
    v_add_f32 v248, s81, v248
    v_add_f32 v249, s85, v249
    v_mul_f32 v248, 0x3b000000, v248
    v_mul_f32 v249, 0x3b000000, v249
    v_fma_f32 v249, -v248, v248, v249
    v_max_f32 v249, 0, v249
    v_add_f32 v248, s59, v248
    v_cvt_pk_bf16_f32 v249, v249, v249
    v_lshlrev_b32 v249, 16, v249
    v_add_f32 v249, 0x3727c5ac, v249
    v_cvt_pk_bf16_f32 v249, v249, v249
    v_lshlrev_b32 v249, 16, v249
    v_sqrt_f32 v249, v249
    v_cvt_pk_bf16_f32 v248, v248, v248
    v_lshlrev_b32 v248, 16, v248
    v_cvt_pk_bf16_f32 v249, v249, v249
    v_lshlrev_b32 v249, 16, v249
    v_rcp_f32 v249, v249
    v_sub_f32 v240, v240, v248
    v_sub_f32 v241, v241, v248
    v_sub_f32 v242, v242, v248
    v_sub_f32 v243, v243, v248
    v_sub_f32 v244, v244, v248
    v_sub_f32 v245, v245, v248
    v_sub_f32 v246, v246, v248
    v_sub_f32 v247, v247, v248
    v_cvt_pk_bf16_f32 v232, v240, v241
    v_cvt_pk_bf16_f32 v233, v242, v243
    v_cvt_pk_bf16_f32 v234, v244, v245
    v_cvt_pk_bf16_f32 v235, v246, v247
    v_lshlrev_b32 v240, 16, v232
    v_and_b32 v241, 0xffff0000, v232
    v_lshlrev_b32 v242, 16, v233
    v_and_b32 v243, 0xffff0000, v233
    v_lshlrev_b32 v244, 16, v234
    v_and_b32 v245, 0xffff0000, v234
    v_lshlrev_b32 v246, 16, v235
    v_and_b32 v247, 0xffff0000, v235
    v_mul_f32 v240, v240, v249
    v_mul_f32 v241, v241, v249
    v_mul_f32 v242, v242, v249
    v_mul_f32 v243, v243, v249
    v_mul_f32 v244, v244, v249
    v_mul_f32 v245, v245, v249
    v_mul_f32 v246, v246, v249
    v_mul_f32 v247, v247, v249
    v_cvt_pk_bf16_f32 v232, v240, v241
    v_cvt_pk_bf16_f32 v233, v242, v243
    v_cvt_pk_bf16_f32 v234, v244, v245
    v_cvt_pk_bf16_f32 v235, v246, v247
    s_mul_i32 s59, s40, 1040
    v_add_u32 v60, s59, v2
    ds_write_b128 v60, v[232:235] offset:16384
    s_add_u32 m0, s48, 65536
    s_add_u32 s59, s53, 524288
    buffer_load_dwordx4 v5, s[8:11], s59 offen lds
    s_add_u32 m0, s48, 66560
    s_add_u32 s59, s53, 655360
    buffer_load_dwordx4 v5, s[8:11], s59 offen lds
    s_add_u32 m0, s48, 67584
    s_add_u32 s59, s53, 786432
    buffer_load_dwordx4 v5, s[8:11], s59 offen lds
    s_add_u32 m0, s48, 68608
    s_add_u32 s59, s53, 917504
    buffer_load_dwordx4 v5, s[8:11], s59 offen lds
    s_add_u32 m0, s52, 49152
    s_add_u32 s59, s49, 128
    buffer_load_dwordx4 v3, s[4:7], s59 offen lds
    buffer_load_dwordx4 v4, s[4:7], s59 offen offset:1024 lds
    s_mov_b32 s78, 0xfff0ffff
    s_mov_b32 s79, 0xf000ff00
    s_mov_b32 s80, 0xffe0fffe
    s_mov_b32 s81, 0xe000fe00
    s_mov_b32 s82, 0xffc0fffc
    s_mov_b32 s83, 0xc000fc00
    s_mov_b32 s84, 0xff80fff8
    s_mov_b32 s85, 0x8000f800
    v_and_b32 v60, 7, v1
    v_lshrrev_b32 v61, 3, v1
    v_lshlrev_b32 v10, 4, v60
    v_lshl_add_u32 v10, v61, 8, v10
    v_mul_u32_u24 v60, 1040, v60
    v_lshl_add_u32 v60, v61, 4, v60
    s_lshl_b32 s59, s40, 7
    v_add_u32 v60, s59, v60
    s_lshr_b32 s57, s2, 1
    s_lshl_b32 s57, s57, 14
    s_and_b32 s59, s2, 1
    s_lshl_b32 s59, s59, 7
    s_add_u32 s57, s57, s59
    s_lshl_b32 s59, s40, 11
    s_add_u32 s57, s57, s59
    s_waitcnt lgkmcnt(0)
    s_cmp_ge_u32 s40, 4
    s_cbranch_scc1 KF_A
    s_waitcnt vmcnt(6)
    s_barrier
    ds_read_b128 v[240:243], v60 offset:16384
    ds_read_b64_tr_b16 v[128:129], v8 offset:32768
    ds_read_b64_tr_b16 v[130:131], v8 offset:33024
    ds_read_b64_tr_b16 v[132:133], v8 offset:32800
    ds_read_b64_tr_b16 v[134:135], v8 offset:33056
    ds_read_b64_tr_b16 v[136:137], v8 offset:34816
    ds_read_b64_tr_b16 v[138:139], v8 offset:35072
    ds_read_b64_tr_b16 v[140:141], v8 offset:34848
    ds_read_b64_tr_b16 v[142:143], v8 offset:35104
    ds_read_b128 v[28:31], v6 offset:32768
    ds_read_b128 v[32:35], v7 offset:32768
    ds_read_b128 v[36:39], v6 offset:34816
    ds_read_b128 v[40:43], v7 offset:34816
    ds_read_b128 v[44:47], v6 offset:36864
    ds_read_b128 v[48:51], v7 offset:36864
    s_waitcnt lgkmcnt(14)
    buffer_store_dwordx4 v[240:243], v10, s[24:27], s57 offen sc1
    ds_read_b128 v[52:55], v6 offset:38912
    ds_read_b128 v[56:59], v7 offset:38912
    s_waitcnt lgkmcnt(4)
    v_mfma_f32_16x16x32_bf16 v[64:67], v[128:131], v[28:31], 0
    v_mfma_f32_16x16x32_bf16 v[64:67], v[136:139], v[32:35], v[64:67]
    s_add_u32 m0, s48, 0
    s_add_u32 s59, s53, 1048576
    buffer_load_dwordx4 v5, s[8:11], s59 offen lds
    v_mov_b32 v248, 0
    v_lshlrev_b32 v250, 16, v232
    v_lshlrev_b32 v251, 16, v236
    v_fmac_f32 v248, v250, v251
    v_and_b32 v250, 0xffff0000, v232
    v_mfma_f32_16x16x32_bf16 v[68:71], v[132:135], v[28:31], 0
    ds_read_b128 v[28:31], v6 offset:40960
    v_mfma_f32_16x16x32_bf16 v[68:71], v[140:143], v[32:35], v[68:71]
    ds_read_b128 v[32:35], v7 offset:40960
    s_add_u32 m0, s48, 1024
    s_add_u32 s59, s53, 1179648
    buffer_load_dwordx4 v5, s[8:11], s59 offen lds
    v_and_b32 v251, 0xffff0000, v236
    v_fmac_f32 v248, v250, v251
    v_lshlrev_b32 v250, 16, v233
    v_lshlrev_b32 v251, 16, v237
    v_fmac_f32 v248, v250, v251
    v_mfma_f32_16x16x32_bf16 v[72:75], v[128:131], v[36:39], 0
    v_mfma_f32_16x16x32_bf16 v[72:75], v[136:139], v[40:43], v[72:75]
    s_add_u32 m0, s48, 2048
    s_add_u32 s59, s53, 1310720
    buffer_load_dwordx4 v5, s[8:11], s59 offen lds
    v_and_b32 v250, 0xffff0000, v233
    v_and_b32 v251, 0xffff0000, v237
    v_fmac_f32 v248, v250, v251
    v_lshlrev_b32 v250, 16, v234
    v_lshlrev_b32 v251, 16, v238
    v_mfma_f32_16x16x32_bf16 v[76:79], v[132:135], v[36:39], 0
    ds_read_b128 v[36:39], v6 offset:43008
    v_mfma_f32_16x16x32_bf16 v[76:79], v[140:143], v[40:43], v[76:79]
    ds_read_b128 v[40:43], v7 offset:43008
    s_add_u32 m0, s48, 3072
    s_add_u32 s59, s53, 1441792
    buffer_load_dwordx4 v5, s[8:11], s59 offen lds
    v_fmac_f32 v248, v250, v251
    v_and_b32 v250, 0xffff0000, v234
    v_and_b32 v251, 0xffff0000, v238
    v_fmac_f32 v248, v250, v251
    v_lshlrev_b32 v250, 16, v235
    s_waitcnt lgkmcnt(4)
    v_mfma_f32_16x16x32_bf16 v[80:83], v[128:131], v[44:47], 0
    v_mfma_f32_16x16x32_bf16 v[80:83], v[136:139], v[48:51], v[80:83]
    s_add_u32 m0, s52, 0
    s_add_u32 s59, s49, 256
    buffer_load_dwordx4 v3, s[4:7], s59 offen lds
    buffer_load_dwordx4 v4, s[4:7], s59 offen offset:1024 lds
    v_lshlrev_b32 v251, 16, v239
    v_fmac_f32 v248, v250, v251
    v_and_b32 v250, 0xffff0000, v235
    v_and_b32 v251, 0xffff0000, v239
    v_fmac_f32 v248, v250, v251
    v_mfma_f32_16x16x32_bf16 v[84:87], v[132:135], v[44:47], 0
    ds_read_b128 v[44:47], v6 offset:45056
    v_mfma_f32_16x16x32_bf16 v[84:87], v[140:143], v[48:51], v[84:87]
    ds_read_b128 v[48:51], v7 offset:45056
    s_nop 1
    v_add_f32_dpp v248, v248, v248 quad_perm:[1,0,3,2] row_mask:0xf bank_mask:0xf
    s_nop 1
    v_add_f32_dpp v248, v248, v248 quad_perm:[2,3,0,1] row_mask:0xf bank_mask:0xf
    s_nop 1
    v_mfma_f32_16x16x32_bf16 v[88:91], v[128:131], v[52:55], 0
    v_mfma_f32_16x16x32_bf16 v[88:91], v[136:139], v[56:59], v[88:91]
    v_add_f32_dpp v248, v248, v248 row_half_mirror row_mask:0xf bank_mask:0xf
    s_nop 1
    v_add_f32_dpp v248, v248, v248 row_mirror row_mask:0xf bank_mask:0xf
    s_nop 0
    v_readlane_b32 s61, v248, 0
    v_mfma_f32_16x16x32_bf16 v[92:95], v[132:135], v[52:55], 0
    ds_read_b128 v[52:55], v6 offset:47104
    v_mfma_f32_16x16x32_bf16 v[92:95], v[140:143], v[56:59], v[92:95]
    ds_read_b128 v[56:59], v7 offset:47104
    v_readlane_b32 s62, v248, 16
    v_readlane_b32 s63, v248, 32
    v_readlane_b32 s64, v248, 48
    s_nop 1
    v_mov_b32 v248, s61
    s_waitcnt vmcnt(7)
    s_barrier
    s_waitcnt lgkmcnt(4)
    v_mfma_f32_16x16x32_bf16 v[96:99], v[128:131], v[28:31], 0
    v_mfma_f32_16x16x32_bf16 v[96:99], v[136:139], v[32:35], v[96:99]
    ds_read_b64_tr_b16 v[144:145], v9 offset:0
    s_add_u32 m0, s48, 32768
    s_add_u32 s59, s53, 1572864
    buffer_load_dwordx4 v5, s[8:11], s59 offen lds
    v_add_f32 v248, s62, v248
    v_add_f32 v248, s63, v248
    v_add_f32 v248, s64, v248
    v_cvt_pk_bf16_f32 v248, v248, v248
    v_lshlrev_b32 v248, 16, v248
    v_mfma_f32_16x16x32_bf16 v[100:103], v[132:135], v[28:31], 0
    ds_read_b128 v[28:31], v6 offset:49152
    v_mfma_f32_16x16x32_bf16 v[100:103], v[140:143], v[32:35], v[100:103]
    ds_read_b128 v[32:35], v7 offset:49152
    ds_read_b64_tr_b16 v[146:147], v9 offset:256
    s_add_u32 m0, s48, 33792
    s_add_u32 s59, s53, 1703936
    buffer_load_dwordx4 v5, s[8:11], s59 offen lds
    v_ashrrev_i32 v250, 31, v248
    v_or_b32 v250, 0x80000000, v250
    v_xor_b32 v248, v248, v250
    v_and_b32 v248, 0xffff0000, v248
    v_or_b32 v248, s56, v248
    s_mov_b64 exec, 1
    buffer_store_dword v248, v11, s[24:27], s58 offen sc1
    s_mov_b64 exec, -1
    s_mov_b32 exec_lo, 0xffff0000
    s_mov_b32 exec_hi, 0
    s_and_b32 s59, s41, 3
    s_cmp_eq_u32 s59, 1
    s_cbranch_scc1 KFT_6
    s_cmp_eq_u32 s41, 31
    s_cbranch_scc1 KFT_6
    s_add_u32 s60, s70, 0x8000
    s_cmp_eq_u32 s59, 0
    s_cbranch_scc1 KFT_7
    s_add_u32 s60, s70, 32768
    s_cmp_lg_u32 s41, 30
    s_cbranch_scc1 KFT_5
KFT_7:
    buffer_load_dword v15, v12, s[8:11], s60 offen
KFT_5:
    buffer_load_dword v15, v12, s[8:11], s70 offen
KFT_6:
    s_mov_b64 exec, -1
    v_mfma_f32_16x16x32_bf16 v[104:107], v[128:131], v[36:39], 0
    v_mfma_f32_16x16x32_bf16 v[104:107], v[136:139], v[40:43], v[104:107]
    ds_read_b64_tr_b16 v[148:149], v9 offset:32
    s_add_u32 m0, s48, 34816
    s_add_u32 s59, s53, 1835008
    buffer_load_dwordx4 v5, s[8:11], s59 offen lds
    v_mfma_f32_16x16x32_bf16 v[108:111], v[132:135], v[36:39], 0
    ds_read_b128 v[36:39], v6 offset:51200
    v_mfma_f32_16x16x32_bf16 v[108:111], v[140:143], v[40:43], v[108:111]
    ds_read_b128 v[40:43], v7 offset:51200
    ds_read_b64_tr_b16 v[150:151], v9 offset:288
    s_add_u32 m0, s48, 35840
    s_add_u32 s59, s53, 1966080
    buffer_load_dwordx4 v5, s[8:11], s59 offen lds
    s_waitcnt lgkmcnt(8)
    v_mfma_f32_16x16x32_bf16 v[112:115], v[128:131], v[44:47], 0
    v_mfma_f32_16x16x32_bf16 v[112:115], v[136:139], v[48:51], v[112:115]
    ds_read_b64_tr_b16 v[152:153], v9 offset:2048
    s_add_u32 m0, s52, 16384
    s_add_u32 s59, s49, 384
    buffer_load_dwordx4 v3, s[4:7], s59 offen lds
    buffer_load_dwordx4 v4, s[4:7], s59 offen offset:1024 lds
    v_mfma_f32_16x16x32_bf16 v[116:119], v[132:135], v[44:47], 0
    ds_read_b128 v[44:47], v6 offset:53248
    v_mfma_f32_16x16x32_bf16 v[116:119], v[140:143], v[48:51], v[116:119]
    ds_read_b128 v[48:51], v7 offset:53248
    ds_read_b64_tr_b16 v[154:155], v9 offset:2304
    v_mfma_f32_16x16x32_bf16 v[120:123], v[128:131], v[52:55], 0
    v_mfma_f32_16x16x32_bf16 v[120:123], v[136:139], v[56:59], v[120:123]
    ds_read_b64_tr_b16 v[156:157], v9 offset:2080
    v_mfma_f32_16x16x32_bf16 v[124:127], v[132:135], v[52:55], 0
    ds_read_b128 v[52:55], v6 offset:55296
    v_mfma_f32_16x16x32_bf16 v[124:127], v[140:143], v[56:59], v[124:127]
    ds_read_b128 v[56:59], v7 offset:55296
    ds_read_b64_tr_b16 v[158:159], v9 offset:2336
    s_waitcnt lgkmcnt(0)
    v_mfma_f32_16x16x32_bf16 v[64:67], v[144:147], v[28:31], v[64:67]
    v_mfma_f32_16x16x32_bf16 v[64:67], v[152:155], v[32:35], v[64:67]
    v_mfma_f32_16x16x32_bf16 v[68:71], v[148:151], v[28:31], v[68:71]
    ds_read_b128 v[28:31], v6 offset:57344
    v_mfma_f32_16x16x32_bf16 v[68:71], v[156:159], v[32:35], v[68:71]
    ds_read_b128 v[32:35], v7 offset:57344
    v_mfma_f32_16x16x32_bf16 v[72:75], v[144:147], v[36:39], v[72:75]
    v_mfma_f32_16x16x32_bf16 v[72:75], v[152:155], v[40:43], v[72:75]
    v_mfma_f32_16x16x32_bf16 v[76:79], v[148:151], v[36:39], v[76:79]
    ds_read_b128 v[36:39], v6 offset:59392
    v_mfma_f32_16x16x32_bf16 v[76:79], v[156:159], v[40:43], v[76:79]
    ds_read_b128 v[40:43], v7 offset:59392
    v_mfma_f32_16x16x32_bf16 v[80:83], v[144:147], v[44:47], v[80:83]
    v_mfma_f32_16x16x32_bf16 v[80:83], v[152:155], v[48:51], v[80:83]
    v_mfma_f32_16x16x32_bf16 v[84:87], v[148:151], v[44:47], v[84:87]
    ds_read_b128 v[44:47], v6 offset:61440
    v_mfma_f32_16x16x32_bf16 v[84:87], v[156:159], v[48:51], v[84:87]
    ds_read_b128 v[48:51], v7 offset:61440
    v_mfma_f32_16x16x32_bf16 v[88:91], v[144:147], v[52:55], v[88:91]
    v_mfma_f32_16x16x32_bf16 v[88:91], v[152:155], v[56:59], v[88:91]
    v_mfma_f32_16x16x32_bf16 v[92:95], v[148:151], v[52:55], v[92:95]
    ds_read_b128 v[52:55], v6 offset:63488
    v_mfma_f32_16x16x32_bf16 v[92:95], v[156:159], v[56:59], v[92:95]
    ds_read_b128 v[56:59], v7 offset:63488
    s_waitcnt vmcnt(7)
    s_barrier
    s_waitcnt lgkmcnt(4)
    v_mfma_f32_16x16x32_bf16 v[96:99], v[144:147], v[28:31], v[96:99]
    v_mfma_f32_16x16x32_bf16 v[96:99], v[152:155], v[32:35], v[96:99]
    ds_read_b64_tr_b16 v[160:161], v8 offset:0
    s_add_u32 m0, s48, 65536
    s_add_u32 s59, s53, 2097152
    buffer_load_dwordx4 v5, s[8:11], s59 offen lds
    v_mfma_f32_16x16x32_bf16 v[100:103], v[148:151], v[28:31], v[100:103]
    ds_read_b128 v[28:31], v6 offset:0
    v_mfma_f32_16x16x32_bf16 v[100:103], v[156:159], v[32:35], v[100:103]
    ds_read_b128 v[32:35], v7 offset:0
    ds_read_b64_tr_b16 v[162:163], v8 offset:256
    s_add_u32 m0, s48, 66560
    s_add_u32 s59, s53, 2228224
    buffer_load_dwordx4 v5, s[8:11], s59 offen lds
    v_mfma_f32_16x16x32_bf16 v[104:107], v[144:147], v[36:39], v[104:107]
    v_mfma_f32_16x16x32_bf16 v[104:107], v[152:155], v[40:43], v[104:107]
    ds_read_b64_tr_b16 v[164:165], v8 offset:32
    s_add_u32 m0, s48, 67584
    s_add_u32 s59, s53, 2359296
    buffer_load_dwordx4 v5, s[8:11], s59 offen lds
    v_mfma_f32_16x16x32_bf16 v[108:111], v[148:151], v[36:39], v[108:111]
    ds_read_b128 v[36:39], v6 offset:2048
    v_mfma_f32_16x16x32_bf16 v[108:111], v[156:159], v[40:43], v[108:111]
    ds_read_b128 v[40:43], v7 offset:2048
    ds_read_b64_tr_b16 v[166:167], v8 offset:288
    s_add_u32 m0, s48, 68608
    s_add_u32 s59, s53, 2490368
    buffer_load_dwordx4 v5, s[8:11], s59 offen lds
    s_waitcnt lgkmcnt(8)
    v_mfma_f32_16x16x32_bf16 v[112:115], v[144:147], v[44:47], v[112:115]
    v_mfma_f32_16x16x32_bf16 v[112:115], v[152:155], v[48:51], v[112:115]
    ds_read_b64_tr_b16 v[168:169], v8 offset:2048
    s_add_u32 m0, s52, 32768
    s_add_u32 s59, s49, 512
    buffer_load_dwordx4 v3, s[4:7], s59 offen lds
    buffer_load_dwordx4 v4, s[4:7], s59 offen offset:1024 lds
    v_mfma_f32_16x16x32_bf16 v[116:119], v[148:151], v[44:47], v[116:119]
    ds_read_b128 v[44:47], v6 offset:4096
    v_mfma_f32_16x16x32_bf16 v[116:119], v[156:159], v[48:51], v[116:119]
    ds_read_b128 v[48:51], v7 offset:4096
    ds_read_b64_tr_b16 v[170:171], v8 offset:2304
    v_mfma_f32_16x16x32_bf16 v[120:123], v[144:147], v[52:55], v[120:123]
    v_mfma_f32_16x16x32_bf16 v[120:123], v[152:155], v[56:59], v[120:123]
    ds_read_b64_tr_b16 v[172:173], v8 offset:2080
    s_bitcmp1_b32 s41, 0
    s_cbranch_scc1 KFT_8
    s_lshl_b32 s59, s55, 10
    s_bitcmp1_b32 s41, 1
    s_cselect_b32 s60, 0, 196608
    s_add_u32 s59, s59, s60
    s_mov_b32 exec_lo, 0xff
    s_mov_b32 exec_hi, 0
    buffer_load_dword v14, v13, s[4:7], s59 offen
    s_mov_b64 exec, -1
KFT_8:
    v_mfma_f32_16x16x32_bf16 v[124:127], v[148:151], v[52:55], v[124:127]
    ds_read_b128 v[52:55], v6 offset:6144
    v_mfma_f32_16x16x32_bf16 v[124:127], v[156:159], v[56:59], v[124:127]
    ds_read_b128 v[56:59], v7 offset:6144
    ds_read_b64_tr_b16 v[174:175], v8 offset:2336
    s_waitcnt lgkmcnt(0)
    v_mfma_f32_16x16x32_bf16 v[64:67], v[160:163], v[28:31], v[64:67]
    v_mfma_f32_16x16x32_bf16 v[64:67], v[168:171], v[32:35], v[64:67]
    v_mfma_f32_16x16x32_bf16 v[68:71], v[164:167], v[28:31], v[68:71]
    ds_read_b128 v[28:31], v6 offset:8192
    v_mfma_f32_16x16x32_bf16 v[68:71], v[172:175], v[32:35], v[68:71]
    ds_read_b128 v[32:35], v7 offset:8192
    v_mfma_f32_16x16x32_bf16 v[72:75], v[160:163], v[36:39], v[72:75]
    v_mfma_f32_16x16x32_bf16 v[72:75], v[168:171], v[40:43], v[72:75]
    v_mfma_f32_16x16x32_bf16 v[76:79], v[164:167], v[36:39], v[76:79]
    ds_read_b128 v[36:39], v6 offset:10240
    v_mfma_f32_16x16x32_bf16 v[76:79], v[172:175], v[40:43], v[76:79]
    ds_read_b128 v[40:43], v7 offset:10240
    v_mfma_f32_16x16x32_bf16 v[80:83], v[160:163], v[44:47], v[80:83]
    v_mfma_f32_16x16x32_bf16 v[80:83], v[168:171], v[48:51], v[80:83]
    v_mfma_f32_16x16x32_bf16 v[84:87], v[164:167], v[44:47], v[84:87]
    ds_read_b128 v[44:47], v6 offset:12288
    v_mfma_f32_16x16x32_bf16 v[84:87], v[172:175], v[48:51], v[84:87]
    ds_read_b128 v[48:51], v7 offset:12288
    v_mfma_f32_16x16x32_bf16 v[88:91], v[160:163], v[52:55], v[88:91]
    v_mfma_f32_16x16x32_bf16 v[88:91], v[168:171], v[56:59], v[88:91]
    v_mfma_f32_16x16x32_bf16 v[92:95], v[164:167], v[52:55], v[92:95]
    ds_read_b128 v[52:55], v6 offset:14336
    v_mfma_f32_16x16x32_bf16 v[92:95], v[172:175], v[56:59], v[92:95]
    ds_read_b128 v[56:59], v7 offset:14336
    s_waitcnt vmcnt(6)
    s_barrier
    s_cmp_lg_u32 s40, 0
    s_cbranch_scc1 KFG_9
    v_mov_b32 v60, 0
    v_mov_b32 v61, 1
    s_mov_b64 exec, 1
    buffer_atomic_add v61, v60, s[36:39], 0 offen sc1
    s_mov_b64 exec, -1
KFG_9:
    s_waitcnt lgkmcnt(4)
    v_mfma_f32_16x16x32_bf16 v[96:99], v[160:163], v[28:31], v[96:99]
    v_mfma_f32_16x16x32_bf16 v[96:99], v[168:171], v[32:35], v[96:99]
    ds_read_b64_tr_b16 v[176:177], v8 offset:32768
    s_add_u32 m0, s48, 0
    s_add_u32 s59, s53, 2621440
    buffer_load_dwordx4 v5, s[8:11], s59 offen lds
    v_mfma_f32_16x16x32_bf16 v[100:103], v[164:167], v[28:31], v[100:103]
    ds_read_b128 v[28:31], v6 offset:16384
    v_mfma_f32_16x16x32_bf16 v[100:103], v[172:175], v[32:35], v[100:103]
    ds_read_b128 v[32:35], v7 offset:16384
    ds_read_b64_tr_b16 v[178:179], v8 offset:33024
    s_add_u32 m0, s48, 1024
    s_add_u32 s59, s53, 2752512
    buffer_load_dwordx4 v5, s[8:11], s59 offen lds
    v_mfma_f32_16x16x32_bf16 v[104:107], v[160:163], v[36:39], v[104:107]
    v_mfma_f32_16x16x32_bf16 v[104:107], v[168:171], v[40:43], v[104:107]
    ds_read_b64_tr_b16 v[180:181], v8 offset:32800
    s_add_u32 m0, s48, 2048
    s_add_u32 s59, s53, 2883584
    buffer_load_dwordx4 v5, s[8:11], s59 offen lds
    v_mfma_f32_16x16x32_bf16 v[108:111], v[164:167], v[36:39], v[108:111]
    ds_read_b128 v[36:39], v6 offset:18432
    v_mfma_f32_16x16x32_bf16 v[108:111], v[172:175], v[40:43], v[108:111]
    ds_read_b128 v[40:43], v7 offset:18432
    ds_read_b64_tr_b16 v[182:183], v8 offset:33056
    s_add_u32 m0, s48, 3072
    s_add_u32 s59, s53, 3014656
    buffer_load_dwordx4 v5, s[8:11], s59 offen lds
    s_waitcnt lgkmcnt(8)
    v_mfma_f32_16x16x32_bf16 v[112:115], v[160:163], v[44:47], v[112:115]
    v_mfma_f32_16x16x32_bf16 v[112:115], v[168:171], v[48:51], v[112:115]
    ds_read_b64_tr_b16 v[184:185], v8 offset:34816
    s_add_u32 m0, s52, 49152
    s_add_u32 s59, s49, 640
    buffer_load_dwordx4 v3, s[4:7], s59 offen lds
    buffer_load_dwordx4 v4, s[4:7], s59 offen offset:1024 lds
    v_mfma_f32_16x16x32_bf16 v[116:119], v[164:167], v[44:47], v[116:119]
    ds_read_b128 v[44:47], v6 offset:20480
    v_mfma_f32_16x16x32_bf16 v[116:119], v[172:175], v[48:51], v[116:119]
    ds_read_b128 v[48:51], v7 offset:20480
    ds_read_b64_tr_b16 v[186:187], v8 offset:35072
    v_mfma_f32_16x16x32_bf16 v[120:123], v[160:163], v[52:55], v[120:123]
    v_mfma_f32_16x16x32_bf16 v[120:123], v[168:171], v[56:59], v[120:123]
    ds_read_b64_tr_b16 v[188:189], v8 offset:34848
    v_mfma_f32_16x16x32_bf16 v[124:127], v[164:167], v[52:55], v[124:127]
    ds_read_b128 v[52:55], v6 offset:22528
    v_mfma_f32_16x16x32_bf16 v[124:127], v[172:175], v[56:59], v[124:127]
    ds_read_b128 v[56:59], v7 offset:22528
    ds_read_b64_tr_b16 v[190:191], v8 offset:35104
    s_waitcnt lgkmcnt(0)
    v_mfma_f32_16x16x32_bf16 v[64:67], v[176:179], v[28:31], v[64:67]
    v_mfma_f32_16x16x32_bf16 v[64:67], v[184:187], v[32:35], v[64:67]
    v_mfma_f32_16x16x32_bf16 v[68:71], v[180:183], v[28:31], v[68:71]
    ds_read_b128 v[28:31], v6 offset:24576
    v_mfma_f32_16x16x32_bf16 v[68:71], v[188:191], v[32:35], v[68:71]
    ds_read_b128 v[32:35], v7 offset:24576
    v_mfma_f32_16x16x32_bf16 v[72:75], v[176:179], v[36:39], v[72:75]
    v_mfma_f32_16x16x32_bf16 v[72:75], v[184:187], v[40:43], v[72:75]
    v_mfma_f32_16x16x32_bf16 v[76:79], v[180:183], v[36:39], v[76:79]
    ds_read_b128 v[36:39], v6 offset:26624
    v_mfma_f32_16x16x32_bf16 v[76:79], v[188:191], v[40:43], v[76:79]
    ds_read_b128 v[40:43], v7 offset:26624
    v_mfma_f32_16x16x32_bf16 v[80:83], v[176:179], v[44:47], v[80:83]
    v_mfma_f32_16x16x32_bf16 v[80:83], v[184:187], v[48:51], v[80:83]
    v_mfma_f32_16x16x32_bf16 v[84:87], v[180:183], v[44:47], v[84:87]
    ds_read_b128 v[44:47], v6 offset:28672
    v_mfma_f32_16x16x32_bf16 v[84:87], v[188:191], v[48:51], v[84:87]
    ds_read_b128 v[48:51], v7 offset:28672
    v_mfma_f32_16x16x32_bf16 v[88:91], v[176:179], v[52:55], v[88:91]
    v_mfma_f32_16x16x32_bf16 v[88:91], v[184:187], v[56:59], v[88:91]
    v_mfma_f32_16x16x32_bf16 v[92:95], v[180:183], v[52:55], v[92:95]
    ds_read_b128 v[52:55], v6 offset:30720
    v_mfma_f32_16x16x32_bf16 v[92:95], v[188:191], v[56:59], v[92:95]
    ds_read_b128 v[56:59], v7 offset:30720
    s_waitcnt vmcnt(6)
    s_barrier
    s_waitcnt lgkmcnt(4)
    v_mfma_f32_16x16x32_bf16 v[96:99], v[176:179], v[28:31], v[96:99]
    v_mfma_f32_16x16x32_bf16 v[96:99], v[184:187], v[32:35], v[96:99]
    ds_read_b64_tr_b16 v[192:193], v9 offset:0
    s_add_u32 m0, s48, 32768
    s_add_u32 s59, s53, 3145728
    buffer_load_dwordx4 v5, s[8:11], s59 offen lds
    v_mfma_f32_16x16x32_bf16 v[100:103], v[180:183], v[28:31], v[100:103]
    ds_read_b128 v[28:31], v6 offset:32768
    v_mfma_f32_16x16x32_bf16 v[100:103], v[188:191], v[32:35], v[100:103]
    ds_read_b128 v[32:35], v7 offset:32768
    ds_read_b64_tr_b16 v[194:195], v9 offset:256
    s_add_u32 m0, s48, 33792
    s_add_u32 s59, s53, 3276800
    buffer_load_dwordx4 v5, s[8:11], s59 offen lds
    v_mfma_f32_16x16x32_bf16 v[104:107], v[176:179], v[36:39], v[104:107]
    v_mfma_f32_16x16x32_bf16 v[104:107], v[184:187], v[40:43], v[104:107]
    ds_read_b64_tr_b16 v[196:197], v9 offset:32
    s_add_u32 m0, s48, 34816
    s_add_u32 s59, s53, 3407872
    buffer_load_dwordx4 v5, s[8:11], s59 offen lds
    v_mfma_f32_16x16x32_bf16 v[108:111], v[180:183], v[36:39], v[108:111]
    ds_read_b128 v[36:39], v6 offset:34816
    v_mfma_f32_16x16x32_bf16 v[108:111], v[188:191], v[40:43], v[108:111]
    ds_read_b128 v[40:43], v7 offset:34816
    ds_read_b64_tr_b16 v[198:199], v9 offset:288
    s_add_u32 m0, s48, 35840
    s_add_u32 s59, s53, 3538944
    buffer_load_dwordx4 v5, s[8:11], s59 offen lds
    s_waitcnt lgkmcnt(8)
    v_mfma_f32_16x16x32_bf16 v[112:115], v[176:179], v[44:47], v[112:115]
    v_mfma_f32_16x16x32_bf16 v[112:115], v[184:187], v[48:51], v[112:115]
    ds_read_b64_tr_b16 v[200:201], v9 offset:2048
    s_add_u32 m0, s52, 0
    s_add_u32 s59, s49, 768
    buffer_load_dwordx4 v3, s[4:7], s59 offen lds
    buffer_load_dwordx4 v4, s[4:7], s59 offen offset:1024 lds
    s_mov_b32 s16, s88
    s_and_b32 s17, s89, 0xffff
    s_mov_b32 s18, 0x400000
    s_mov_b32 s19, 0x00020000
    s_mov_b32 exec_lo, 0xffff
    s_mov_b32 exec_hi, 0
    s_and_b32 s59, s41, 3
    s_cmp_eq_u32 s59, 1
    s_cbranch_scc1 KFT_11
    s_cmp_eq_u32 s41, 31
    s_cbranch_scc1 KFT_11
    s_add_u32 s60, s70, 0xffff8000
    s_cmp_eq_u32 s59, 2
    s_cbranch_scc1 KFT_12
    s_add_u32 s60, s70, 98304
    s_cmp_lg_u32 s41, 28
    s_cbranch_scc1 KFT_10
KFT_12:
    buffer_load_dword v15, v12, s[16:19], s60 offen
KFT_10:
    buffer_load_dword v15, v12, s[16:19], s70 offen
KFT_11:
    s_mov_b64 exec, -1
    v_mfma_f32_16x16x32_bf16 v[116:119], v[180:183], v[44:47], v[116:119]
    ds_read_b128 v[44:47], v6 offset:36864
    v_mfma_f32_16x16x32_bf16 v[116:119], v[188:191], v[48:51], v[116:119]
    ds_read_b128 v[48:51], v7 offset:36864
    ds_read_b64_tr_b16 v[202:203], v9 offset:2304
    v_mfma_f32_16x16x32_bf16 v[120:123], v[176:179], v[52:55], v[120:123]
    v_mfma_f32_16x16x32_bf16 v[120:123], v[184:187], v[56:59], v[120:123]
    ds_read_b64_tr_b16 v[204:205], v9 offset:2080
    v_mfma_f32_16x16x32_bf16 v[124:127], v[180:183], v[52:55], v[124:127]
    ds_read_b128 v[52:55], v6 offset:38912
    v_mfma_f32_16x16x32_bf16 v[124:127], v[188:191], v[56:59], v[124:127]
    ds_read_b128 v[56:59], v7 offset:38912
    ds_read_b64_tr_b16 v[206:207], v9 offset:2336
    s_waitcnt lgkmcnt(0)
    v_mfma_f32_16x16x32_bf16 v[64:67], v[192:195], v[28:31], v[64:67]
    v_mfma_f32_16x16x32_bf16 v[64:67], v[200:203], v[32:35], v[64:67]
    v_mfma_f32_16x16x32_bf16 v[68:71], v[196:199], v[28:31], v[68:71]
    ds_read_b128 v[28:31], v6 offset:40960
    v_mfma_f32_16x16x32_bf16 v[68:71], v[204:207], v[32:35], v[68:71]
    ds_read_b128 v[32:35], v7 offset:40960
    v_mfma_f32_16x16x32_bf16 v[72:75], v[192:195], v[36:39], v[72:75]
    v_mfma_f32_16x16x32_bf16 v[72:75], v[200:203], v[40:43], v[72:75]
    v_mfma_f32_16x16x32_bf16 v[76:79], v[196:199], v[36:39], v[76:79]
    ds_read_b128 v[36:39], v6 offset:43008
    v_mfma_f32_16x16x32_bf16 v[76:79], v[204:207], v[40:43], v[76:79]
    ds_read_b128 v[40:43], v7 offset:43008
    v_mfma_f32_16x16x32_bf16 v[80:83], v[192:195], v[44:47], v[80:83]
    v_mfma_f32_16x16x32_bf16 v[80:83], v[200:203], v[48:51], v[80:83]
    v_mfma_f32_16x16x32_bf16 v[84:87], v[196:199], v[44:47], v[84:87]
    ds_read_b128 v[44:47], v6 offset:45056
    v_mfma_f32_16x16x32_bf16 v[84:87], v[204:207], v[48:51], v[84:87]
    ds_read_b128 v[48:51], v7 offset:45056
    v_mfma_f32_16x16x32_bf16 v[88:91], v[192:195], v[52:55], v[88:91]
    v_mfma_f32_16x16x32_bf16 v[88:91], v[200:203], v[56:59], v[88:91]
    v_mfma_f32_16x16x32_bf16 v[92:95], v[196:199], v[52:55], v[92:95]
    ds_read_b128 v[52:55], v6 offset:47104
    v_mfma_f32_16x16x32_bf16 v[92:95], v[204:207], v[56:59], v[92:95]
    ds_read_b128 v[56:59], v7 offset:47104
    s_waitcnt vmcnt(6)
    s_barrier
    s_waitcnt lgkmcnt(4)
    v_mfma_f32_16x16x32_bf16 v[96:99], v[192:195], v[28:31], v[96:99]
    v_mfma_f32_16x16x32_bf16 v[96:99], v[200:203], v[32:35], v[96:99]
    ds_read_b64_tr_b16 v[208:209], v8 offset:0
    s_add_u32 m0, s48, 65536
    s_add_u32 s59, s53, 3670016
    buffer_load_dwordx4 v5, s[8:11], s59 offen lds
    v_mfma_f32_16x16x32_bf16 v[100:103], v[196:199], v[28:31], v[100:103]
    ds_read_b128 v[28:31], v6 offset:49152
    v_mfma_f32_16x16x32_bf16 v[100:103], v[204:207], v[32:35], v[100:103]
    ds_read_b128 v[32:35], v7 offset:49152
    ds_read_b64_tr_b16 v[210:211], v8 offset:256
    s_add_u32 m0, s48, 66560
    s_add_u32 s59, s53, 3801088
    buffer_load_dwordx4 v5, s[8:11], s59 offen lds
    v_mfma_f32_16x16x32_bf16 v[104:107], v[192:195], v[36:39], v[104:107]
    v_mfma_f32_16x16x32_bf16 v[104:107], v[200:203], v[40:43], v[104:107]
    ds_read_b64_tr_b16 v[212:213], v8 offset:32
    s_add_u32 m0, s48, 67584
    s_add_u32 s59, s53, 3932160
    buffer_load_dwordx4 v5, s[8:11], s59 offen lds
    v_mfma_f32_16x16x32_bf16 v[108:111], v[196:199], v[36:39], v[108:111]
    ds_read_b128 v[36:39], v6 offset:51200
    v_mfma_f32_16x16x32_bf16 v[108:111], v[204:207], v[40:43], v[108:111]
    ds_read_b128 v[40:43], v7 offset:51200
    ds_read_b64_tr_b16 v[214:215], v8 offset:288
    s_add_u32 m0, s48, 68608
    s_add_u32 s59, s53, 4063232
    buffer_load_dwordx4 v5, s[8:11], s59 offen lds
    s_waitcnt lgkmcnt(8)
    v_mfma_f32_16x16x32_bf16 v[112:115], v[192:195], v[44:47], v[112:115]
    v_mfma_f32_16x16x32_bf16 v[112:115], v[200:203], v[48:51], v[112:115]
    ds_read_b64_tr_b16 v[216:217], v8 offset:2048
    s_add_u32 m0, s52, 16384
    s_add_u32 s59, s49, 896
    buffer_load_dwordx4 v3, s[4:7], s59 offen lds
    buffer_load_dwordx4 v4, s[4:7], s59 offen offset:1024 lds
    v_mfma_f32_16x16x32_bf16 v[116:119], v[196:199], v[44:47], v[116:119]
    ds_read_b128 v[44:47], v6 offset:53248
    v_mfma_f32_16x16x32_bf16 v[116:119], v[204:207], v[48:51], v[116:119]
    ds_read_b128 v[48:51], v7 offset:53248
    ds_read_b64_tr_b16 v[218:219], v8 offset:2304
    v_mfma_f32_16x16x32_bf16 v[120:123], v[192:195], v[52:55], v[120:123]
    v_mfma_f32_16x16x32_bf16 v[120:123], v[200:203], v[56:59], v[120:123]
    ds_read_b64_tr_b16 v[220:221], v8 offset:2080
    v_mfma_f32_16x16x32_bf16 v[124:127], v[196:199], v[52:55], v[124:127]
    ds_read_b128 v[52:55], v6 offset:55296
    v_mfma_f32_16x16x32_bf16 v[124:127], v[204:207], v[56:59], v[124:127]
    ds_read_b128 v[56:59], v7 offset:55296
    ds_read_b64_tr_b16 v[222:223], v8 offset:2336
    s_waitcnt lgkmcnt(0)
    v_mfma_f32_16x16x32_bf16 v[64:67], v[208:211], v[28:31], v[64:67]
    v_mfma_f32_16x16x32_bf16 v[64:67], v[216:219], v[32:35], v[64:67]
    v_mfma_f32_16x16x32_bf16 v[68:71], v[212:215], v[28:31], v[68:71]
    ds_read_b128 v[28:31], v6 offset:57344
    v_mfma_f32_16x16x32_bf16 v[68:71], v[220:223], v[32:35], v[68:71]
    ds_read_b128 v[32:35], v7 offset:57344
    v_mfma_f32_16x16x32_bf16 v[72:75], v[208:211], v[36:39], v[72:75]
    v_mfma_f32_16x16x32_bf16 v[72:75], v[216:219], v[40:43], v[72:75]
    v_mfma_f32_16x16x32_bf16 v[76:79], v[212:215], v[36:39], v[76:79]
    ds_read_b128 v[36:39], v6 offset:59392
    v_mfma_f32_16x16x32_bf16 v[76:79], v[220:223], v[40:43], v[76:79]
    ds_read_b128 v[40:43], v7 offset:59392
    v_mfma_f32_16x16x32_bf16 v[80:83], v[208:211], v[44:47], v[80:83]
    v_mfma_f32_16x16x32_bf16 v[80:83], v[216:219], v[48:51], v[80:83]
    v_mfma_f32_16x16x32_bf16 v[84:87], v[212:215], v[44:47], v[84:87]
    ds_read_b128 v[44:47], v6 offset:61440
    v_mfma_f32_16x16x32_bf16 v[84:87], v[220:223], v[48:51], v[84:87]
    ds_read_b128 v[48:51], v7 offset:61440
    v_mfma_f32_16x16x32_bf16 v[88:91], v[208:211], v[52:55], v[88:91]
    v_mfma_f32_16x16x32_bf16 v[88:91], v[216:219], v[56:59], v[88:91]
    v_mfma_f32_16x16x32_bf16 v[92:95], v[212:215], v[52:55], v[92:95]
    ds_read_b128 v[52:55], v6 offset:63488
    v_mfma_f32_16x16x32_bf16 v[92:95], v[220:223], v[56:59], v[92:95]
    ds_read_b128 v[56:59], v7 offset:63488
    s_waitcnt vmcnt(6)
    s_barrier
    s_waitcnt lgkmcnt(4)
    v_mfma_f32_16x16x32_bf16 v[96:99], v[208:211], v[28:31], v[96:99]
    v_mfma_f32_16x16x32_bf16 v[96:99], v[216:219], v[32:35], v[96:99]
    ds_read_b64_tr_b16 v[224:225], v8 offset:32768
    s_add_u32 m0, s52, 32768
    s_add_u32 s59, s50, 131072
    buffer_load_dwordx4 v3, s[4:7], s59 offen lds
    buffer_load_dwordx4 v4, s[4:7], s59 offen offset:1024 lds
    v_mfma_f32_16x16x32_bf16 v[100:103], v[212:215], v[28:31], v[100:103]
    ds_read_b128 v[28:31], v6 offset:0
    v_mfma_f32_16x16x32_bf16 v[100:103], v[220:223], v[32:35], v[100:103]
    ds_read_b128 v[32:35], v7 offset:0
    ds_read_b64_tr_b16 v[226:227], v8 offset:33024
    s_add_u32 m0, s48, 0
    s_add_u32 s59, s51, 163840
    buffer_load_dwordx4 v3, s[4:7], s59 offen lds
    buffer_load_dwordx4 v4, s[4:7], s59 offen offset:1024 lds
    v_mfma_f32_16x16x32_bf16 v[104:107], v[208:211], v[36:39], v[104:107]
    v_mfma_f32_16x16x32_bf16 v[104:107], v[216:219], v[40:43], v[104:107]
    ds_read_b64_tr_b16 v[228:229], v8 offset:32800
    s_add_u32 m0, s48, 2048
    s_add_u32 s59, s51, 180224
    buffer_load_dwordx4 v3, s[4:7], s59 offen lds
    buffer_load_dwordx4 v4, s[4:7], s59 offen offset:1024 lds
    v_mfma_f32_16x16x32_bf16 v[108:111], v[212:215], v[36:39], v[108:111]
    ds_read_b128 v[36:39], v6 offset:2048
    v_mfma_f32_16x16x32_bf16 v[108:111], v[220:223], v[40:43], v[108:111]
    ds_read_b128 v[40:43], v7 offset:2048
    ds_read_b64_tr_b16 v[230:231], v8 offset:33056
    s_waitcnt lgkmcnt(8)
    v_mfma_f32_16x16x32_bf16 v[112:115], v[208:211], v[44:47], v[112:115]
    v_mfma_f32_16x16x32_bf16 v[112:115], v[216:219], v[48:51], v[112:115]
    ds_read_b64_tr_b16 v[232:233], v8 offset:34816
    v_mfma_f32_16x16x32_bf16 v[116:119], v[212:215], v[44:47], v[116:119]
    ds_read_b128 v[44:47], v6 offset:4096
    v_mfma_f32_16x16x32_bf16 v[116:119], v[220:223], v[48:51], v[116:119]
    ds_read_b128 v[48:51], v7 offset:4096
    ds_read_b64_tr_b16 v[234:235], v8 offset:35072
    v_mfma_f32_16x16x32_bf16 v[120:123], v[208:211], v[52:55], v[120:123]
    v_mfma_f32_16x16x32_bf16 v[120:123], v[216:219], v[56:59], v[120:123]
    ds_read_b64_tr_b16 v[236:237], v8 offset:34848
    v_mfma_f32_16x16x32_bf16 v[124:127], v[212:215], v[52:55], v[124:127]
    ds_read_b128 v[52:55], v6 offset:6144
    v_mfma_f32_16x16x32_bf16 v[124:127], v[220:223], v[56:59], v[124:127]
    ds_read_b128 v[56:59], v7 offset:6144
    ds_read_b64_tr_b16 v[238:239], v8 offset:35104
    s_waitcnt lgkmcnt(0)
    v_mfma_f32_16x16x32_bf16 v[64:67], v[224:227], v[28:31], v[64:67]
    v_mfma_f32_16x16x32_bf16 v[64:67], v[232:235], v[32:35], v[64:67]
    v_mfma_f32_16x16x32_bf16 v[68:71], v[228:231], v[28:31], v[68:71]
    ds_read_b128 v[28:31], v6 offset:8192
    v_mfma_f32_16x16x32_bf16 v[68:71], v[236:239], v[32:35], v[68:71]
    ds_read_b128 v[32:35], v7 offset:8192
    v_mfma_f32_16x16x32_bf16 v[72:75], v[224:227], v[36:39], v[72:75]
    v_mfma_f32_16x16x32_bf16 v[72:75], v[232:235], v[40:43], v[72:75]
    v_mfma_f32_16x16x32_bf16 v[76:79], v[228:231], v[36:39], v[76:79]
    ds_read_b128 v[36:39], v6 offset:10240
    v_mfma_f32_16x16x32_bf16 v[76:79], v[236:239], v[40:43], v[76:79]
    ds_read_b128 v[40:43], v7 offset:10240
    v_mfma_f32_16x16x32_bf16 v[80:83], v[224:227], v[44:47], v[80:83]
    v_mfma_f32_16x16x32_bf16 v[80:83], v[232:235], v[48:51], v[80:83]
    v_mfma_f32_16x16x32_bf16 v[84:87], v[228:231], v[44:47], v[84:87]
    ds_read_b128 v[44:47], v6 offset:12288
    v_mfma_f32_16x16x32_bf16 v[84:87], v[236:239], v[48:51], v[84:87]
    ds_read_b128 v[48:51], v7 offset:12288
    v_mfma_f32_16x16x32_bf16 v[88:91], v[224:227], v[52:55], v[88:91]
    v_mfma_f32_16x16x32_bf16 v[88:91], v[232:235], v[56:59], v[88:91]
    v_mfma_f32_16x16x32_bf16 v[92:95], v[228:231], v[52:55], v[92:95]
    ds_read_b128 v[52:55], v6 offset:14336
    v_mfma_f32_16x16x32_bf16 v[92:95], v[236:239], v[56:59], v[92:95]
    ds_read_b128 v[56:59], v7 offset:14336
    s_waitcnt vmcnt(6)
    s_barrier
    s_waitcnt lgkmcnt(4)
    v_mfma_f32_16x16x32_bf16 v[96:99], v[224:227], v[28:31], v[96:99]
    v_mfma_f32_16x16x32_bf16 v[96:99], v[232:235], v[32:35], v[96:99]
    ds_read_b64_tr_b16 v[240:241], v9 offset:0
    s_add_u32 m0, s52, 49152
    s_add_u32 s59, s50, 131584
    buffer_load_dwordx4 v3, s[4:7], s59 offen lds
    buffer_load_dwordx4 v4, s[4:7], s59 offen offset:1024 lds
    v_mfma_f32_16x16x32_bf16 v[100:103], v[228:231], v[28:31], v[100:103]
    ds_read_b128 v[28:31], v6 offset:16384
    v_mfma_f32_16x16x32_bf16 v[100:103], v[236:239], v[32:35], v[100:103]
    ds_read_b128 v[32:35], v7 offset:16384
    ds_read_b64_tr_b16 v[242:243], v9 offset:256
    s_add_u32 m0, s48, 32768
    s_add_u32 s59, s51, 196608
    buffer_load_dwordx4 v3, s[4:7], s59 offen lds
    buffer_load_dwordx4 v4, s[4:7], s59 offen offset:1024 lds
    v_mfma_f32_16x16x32_bf16 v[104:107], v[224:227], v[36:39], v[104:107]
    v_mfma_f32_16x16x32_bf16 v[104:107], v[232:235], v[40:43], v[104:107]
    ds_read_b64_tr_b16 v[244:245], v9 offset:32
    s_add_u32 m0, s48, 34816
    s_add_u32 s59, s51, 212992
    buffer_load_dwordx4 v3, s[4:7], s59 offen lds
    buffer_load_dwordx4 v4, s[4:7], s59 offen offset:1024 lds
    v_mfma_f32_16x16x32_bf16 v[108:111], v[228:231], v[36:39], v[108:111]
    ds_read_b128 v[36:39], v6 offset:18432
    v_mfma_f32_16x16x32_bf16 v[108:111], v[236:239], v[40:43], v[108:111]
    ds_read_b128 v[40:43], v7 offset:18432
    ds_read_b64_tr_b16 v[246:247], v9 offset:288
    s_waitcnt lgkmcnt(8)
    v_mfma_f32_16x16x32_bf16 v[112:115], v[224:227], v[44:47], v[112:115]
    v_mfma_f32_16x16x32_bf16 v[112:115], v[232:235], v[48:51], v[112:115]
    ds_read_b64_tr_b16 v[248:249], v9 offset:2048
    v_mfma_f32_16x16x32_bf16 v[116:119], v[228:231], v[44:47], v[116:119]
    ds_read_b128 v[44:47], v6 offset:20480
    v_mfma_f32_16x16x32_bf16 v[116:119], v[236:239], v[48:51], v[116:119]
    ds_read_b128 v[48:51], v7 offset:20480
    ds_read_b64_tr_b16 v[250:251], v9 offset:2304
    v_mfma_f32_16x16x32_bf16 v[120:123], v[224:227], v[52:55], v[120:123]
    v_mfma_f32_16x16x32_bf16 v[120:123], v[232:235], v[56:59], v[120:123]
    ds_read_b64_tr_b16 v[252:253], v9 offset:2080
    v_mfma_f32_16x16x32_bf16 v[124:127], v[228:231], v[52:55], v[124:127]
    ds_read_b128 v[52:55], v6 offset:22528
    v_mfma_f32_16x16x32_bf16 v[124:127], v[236:239], v[56:59], v[124:127]
    ds_read_b128 v[56:59], v7 offset:22528
    ds_read_b64_tr_b16 v[254:255], v9 offset:2336
    s_waitcnt lgkmcnt(0)
    v_mfma_f32_16x16x32_bf16 v[64:67], v[240:243], v[28:31], v[64:67]
    v_mfma_f32_16x16x32_bf16 v[64:67], v[248:251], v[32:35], v[64:67]
    v_mfma_f32_16x16x32_bf16 v[68:71], v[244:247], v[28:31], v[68:71]
    ds_read_b128 v[28:31], v6 offset:24576
    v_mfma_f32_16x16x32_bf16 v[68:71], v[252:255], v[32:35], v[68:71]
    ds_read_b128 v[32:35], v7 offset:24576
    v_mfma_f32_16x16x32_bf16 v[72:75], v[240:243], v[36:39], v[72:75]
    v_mfma_f32_16x16x32_bf16 v[72:75], v[248:251], v[40:43], v[72:75]
    v_mfma_f32_16x16x32_bf16 v[76:79], v[244:247], v[36:39], v[76:79]
    ds_read_b128 v[36:39], v6 offset:26624
    v_mfma_f32_16x16x32_bf16 v[76:79], v[252:255], v[40:43], v[76:79]
    ds_read_b128 v[40:43], v7 offset:26624
    v_mfma_f32_16x16x32_bf16 v[80:83], v[240:243], v[44:47], v[80:83]
    v_mfma_f32_16x16x32_bf16 v[80:83], v[248:251], v[48:51], v[80:83]
    v_mfma_f32_16x16x32_bf16 v[84:87], v[244:247], v[44:47], v[84:87]
    ds_read_b128 v[44:47], v6 offset:28672
    v_mfma_f32_16x16x32_bf16 v[84:87], v[252:255], v[48:51], v[84:87]
    ds_read_b128 v[48:51], v7 offset:28672
    v_mfma_f32_16x16x32_bf16 v[88:91], v[240:243], v[52:55], v[88:91]
    v_mfma_f32_16x16x32_bf16 v[88:91], v[248:251], v[56:59], v[88:91]
    v_mfma_f32_16x16x32_bf16 v[92:95], v[244:247], v[52:55], v[92:95]
    ds_read_b128 v[52:55], v6 offset:30720
    v_mfma_f32_16x16x32_bf16 v[92:95], v[252:255], v[56:59], v[92:95]
    ds_read_b128 v[56:59], v7 offset:30720
    s_waitcnt vmcnt(10)
    s_barrier
    s_waitcnt lgkmcnt(4)
    v_mfma_f32_16x16x32_bf16 v[96:99], v[240:243], v[28:31], v[96:99]
    v_mfma_f32_16x16x32_bf16 v[96:99], v[248:251], v[32:35], v[96:99]
    s_add_u32 m0, s48, 65536
    s_add_u32 s59, s51, 229376
    buffer_load_dwordx4 v3, s[4:7], s59 offen lds
    buffer_load_dwordx4 v4, s[4:7], s59 offen offset:1024 lds
    v_mfma_f32_16x16x32_bf16 v[100:103], v[244:247], v[28:31], v[100:103]
    ds_read_b128 v[28:31], v6 offset:32768
    v_mfma_f32_16x16x32_bf16 v[100:103], v[252:255], v[32:35], v[100:103]
    ds_read_b128 v[32:35], v7 offset:32768
    s_add_u32 m0, s48, 67584
    s_add_u32 s59, s51, 245760
    buffer_load_dwordx4 v3, s[4:7], s59 offen lds
    buffer_load_dwordx4 v4, s[4:7], s59 offen offset:1024 lds
    v_mfma_f32_16x16x32_bf16 v[104:107], v[240:243], v[36:39], v[104:107]
    v_mfma_f32_16x16x32_bf16 v[104:107], v[248:251], v[40:43], v[104:107]
    v_mfma_f32_16x16x32_bf16 v[108:111], v[244:247], v[36:39], v[108:111]
    ds_read_b128 v[36:39], v6 offset:34816
    v_mfma_f32_16x16x32_bf16 v[108:111], v[252:255], v[40:43], v[108:111]
    ds_read_b128 v[40:43], v7 offset:34816
    v_mul_f32 v64, 0x3e0293ee, v64
    v_mul_f32 v65, 0x3e0293ee, v65
    v_cvt_pk_bf16_f32 v12, v64, v65
    v_mul_f32 v66, 0x3e0293ee, v66
    v_mul_f32 v67, 0x3e0293ee, v67
    v_cvt_pk_bf16_f32 v13, v66, v67
    s_waitcnt lgkmcnt(4)
    v_mfma_f32_16x16x32_bf16 v[112:115], v[240:243], v[44:47], v[112:115]
    v_mfma_f32_16x16x32_bf16 v[112:115], v[248:251], v[48:51], v[112:115]
    v_mul_f32 v68, 0x3e0293ee, v68
    v_mul_f32 v69, 0x3e0293ee, v69
    v_cvt_pk_bf16_f32 v14, v68, v69
    v_mul_f32 v70, 0x3e0293ee, v70
    v_mul_f32 v71, 0x3e0293ee, v71
    v_cvt_pk_bf16_f32 v15, v70, v71
    v_mfma_f32_16x16x32_bf16 v[116:119], v[244:247], v[44:47], v[116:119]
    ds_read_b128 v[44:47], v6 offset:36864
    v_mfma_f32_16x16x32_bf16 v[116:119], v[252:255], v[48:51], v[116:119]
    ds_read_b128 v[48:51], v7 offset:36864
    v_mul_f32 v72, 0x3e0293ee, v72
    v_mul_f32 v73, 0x3e0293ee, v73
    v_cvt_pk_bf16_f32 v16, v72, v73
    v_mul_f32 v74, 0x3e0293ee, v74
    v_mul_f32 v75, 0x3e0293ee, v75
    v_cvt_pk_bf16_f32 v17, v74, v75
    v_mfma_f32_16x16x32_bf16 v[120:123], v[240:243], v[52:55], v[120:123]
    v_mfma_f32_16x16x32_bf16 v[120:123], v[248:251], v[56:59], v[120:123]
    v_mul_f32 v76, 0x3e0293ee, v76
    v_mul_f32 v77, 0x3e0293ee, v77
    v_cvt_pk_bf16_f32 v18, v76, v77
    v_mul_f32 v78, 0x3e0293ee, v78
    v_mul_f32 v79, 0x3e0293ee, v79
    v_cvt_pk_bf16_f32 v19, v78, v79
    s_add_u32 s60, s54, 0
    buffer_store_dwordx4 v[12:15], v2, s[12:15], s60 offen offset:0 sc1
    v_mfma_f32_16x16x32_bf16 v[124:127], v[244:247], v[52:55], v[124:127]
    ds_read_b128 v[52:55], v6 offset:38912
    v_mfma_f32_16x16x32_bf16 v[124:127], v[252:255], v[56:59], v[124:127]
    ds_read_b128 v[56:59], v7 offset:38912
    s_waitcnt lgkmcnt(4)
    v_mfma_f32_16x16x32_bf16 v[64:67], v[128:131], v[28:31], 0
    v_mfma_f32_16x16x32_bf16 v[64:67], v[136:139], v[32:35], v[64:67]
    v_mfma_f32_16x16x32_bf16 v[68:71], v[132:135], v[28:31], 0
    ds_read_b128 v[28:31], v6 offset:40960
    v_mfma_f32_16x16x32_bf16 v[68:71], v[140:143], v[32:35], v[68:71]
    ds_read_b128 v[32:35], v7 offset:40960
    s_add_u32 s60, s54, 0
    buffer_store_dwordx4 v[16:19], v2, s[12:15], s60 offen offset:1024 sc1
    v_mfma_f32_16x16x32_bf16 v[72:75], v[128:131], v[36:39], 0
    v_mfma_f32_16x16x32_bf16 v[72:75], v[136:139], v[40:43], v[72:75]
    s_mov_b32 s16, s88
    s_and_b32 s17, s89, 0xffff
    s_mov_b32 s18, 0x400000
    s_mov_b32 s19, 0x00020000
    s_add_u32 s20, s86, 50331648
    s_addc_u32 s21, s87, 0
    s_and_b32 s21, s21, 0xffff
    s_mov_b32 s22, 0x1000000
    s_mov_b32 s23, 0x00020000
    v_lshrrev_b32 v60, 5, v1
    v_lshlrev_b32 v60, 5, v60
    v_xor_b32 v5, v5, v60
    v_lshrrev_b32 v8, 5, v1
    v_lshlrev_b32 v8, 12, v8
    v_bfe_u32 v60, v1, 4, 1
    v_lshl_add_u32 v8, v60, 9, v8
    v_lshl_add_u32 v8, v60, 5, v8
    v_bfe_u32 v60, v1, 2, 2
    v_lshl_add_u32 v8, v60, 6, v8
    v_and_b32 v60, 3, v1
    v_lshl_add_u32 v8, v60, 3, v8
    v_xor_b32 v9, 32, v8
    v_add_u32 v10, 0x10000, v8
    v_add_u32 v11, 0x10000, v9
    v_add_u32 v3, 131072, v2
    v_mfma_f32_16x16x32_bf16 v[76:79], v[132:135], v[36:39], 0
    ds_read_b128 v[36:39], v6 offset:43008
    v_mfma_f32_16x16x32_bf16 v[76:79], v[140:143], v[40:43], v[76:79]
    ds_read_b128 v[40:43], v7 offset:43008
    s_waitcnt lgkmcnt(4)
    v_mfma_f32_16x16x32_bf16 v[64:67], v[144:147], v[44:47], v[64:67]
    v_mfma_f32_16x16x32_bf16 v[64:67], v[152:155], v[48:51], v[64:67]
    v_mfma_f32_16x16x32_bf16 v[68:71], v[148:151], v[44:47], v[68:71]
    ds_read_b128 v[44:47], v6 offset:45056
    v_mfma_f32_16x16x32_bf16 v[68:71], v[156:159], v[48:51], v[68:71]
    ds_read_b128 v[48:51], v7 offset:45056
    v_mfma_f32_16x16x32_bf16 v[72:75], v[144:147], v[52:55], v[72:75]
    v_mfma_f32_16x16x32_bf16 v[72:75], v[152:155], v[56:59], v[72:75]
    v_mfma_f32_16x16x32_bf16 v[76:79], v[148:151], v[52:55], v[76:79]
    ds_read_b128 v[52:55], v6 offset:47104
    v_mfma_f32_16x16x32_bf16 v[76:79], v[156:159], v[56:59], v[76:79]
    ds_read_b128 v[56:59], v7 offset:47104
    s_waitcnt vmcnt(10)
    s_barrier
    s_waitcnt lgkmcnt(4)
    v_mfma_f32_16x16x32_bf16 v[64:67], v[160:163], v[28:31], v[64:67]
    v_mfma_f32_16x16x32_bf16 v[64:67], v[168:171], v[32:35], v[64:67]
    s_add_u32 m0, s66, 0
    s_add_u32 s59, s65, 0
    buffer_load_dwordx4 v5, s[16:19], s59 offen lds
    v_mfma_f32_16x16x32_bf16 v[68:71], v[164:167], v[28:31], v[68:71]
    ds_read_b128 v[28:31], v6 offset:49152
    v_mfma_f32_16x16x32_bf16 v[68:71], v[172:175], v[32:35], v[68:71]
    ds_read_b128 v[32:35], v7 offset:49152
    s_add_u32 m0, s66, 1024
    s_add_u32 s59, s65, 64
    buffer_load_dwordx4 v5, s[16:19], s59 offen lds
    v_mfma_f32_16x16x32_bf16 v[72:75], v[160:163], v[36:39], v[72:75]
    v_mfma_f32_16x16x32_bf16 v[72:75], v[168:171], v[40:43], v[72:75]
    s_add_u32 m0, s66, 2048
    s_add_u32 s59, s65, 128
    buffer_load_dwordx4 v5, s[16:19], s59 offen lds
    v_mfma_f32_16x16x32_bf16 v[76:79], v[164:167], v[36:39], v[76:79]
    ds_read_b128 v[36:39], v6 offset:51200
    v_mfma_f32_16x16x32_bf16 v[76:79], v[172:175], v[40:43], v[76:79]
    ds_read_b128 v[40:43], v7 offset:51200
    s_add_u32 m0, s66, 3072
    s_add_u32 s59, s65, 192
    buffer_load_dwordx4 v5, s[16:19], s59 offen lds
    s_waitcnt lgkmcnt(4)
    v_mfma_f32_16x16x32_bf16 v[64:67], v[176:179], v[44:47], v[64:67]
    v_mfma_f32_16x16x32_bf16 v[64:67], v[184:187], v[48:51], v[64:67]
    v_mfma_f32_16x16x32_bf16 v[68:71], v[180:183], v[44:47], v[68:71]
    ds_read_b128 v[44:47], v6 offset:53248
    v_mfma_f32_16x16x32_bf16 v[68:71], v[188:191], v[48:51], v[68:71]
    ds_read_b128 v[48:51], v7 offset:53248
    v_mul_f32 v80, 0x3e0293ee, v80
    v_mul_f32 v81, 0x3e0293ee, v81
    v_cvt_pk_bf16_f32 v20, v80, v81
    v_mul_f32 v82, 0x3e0293ee, v82
    v_mul_f32 v83, 0x3e0293ee, v83
    v_cvt_pk_bf16_f32 v21, v82, v83
    v_mfma_f32_16x16x32_bf16 v[72:75], v[176:179], v[52:55], v[72:75]
    v_mfma_f32_16x16x32_bf16 v[72:75], v[184:187], v[56:59], v[72:75]
    v_mul_f32 v84, 0x3e0293ee, v84
    v_mul_f32 v85, 0x3e0293ee, v85
    v_cvt_pk_bf16_f32 v22, v84, v85
    v_mul_f32 v86, 0x3e0293ee, v86
    v_mul_f32 v87, 0x3e0293ee, v87
    v_cvt_pk_bf16_f32 v23, v86, v87
    v_mfma_f32_16x16x32_bf16 v[76:79], v[180:183], v[52:55], v[76:79]
    ds_read_b128 v[52:55], v6 offset:55296
    v_mfma_f32_16x16x32_bf16 v[76:79], v[188:191], v[56:59], v[76:79]
    ds_read_b128 v[56:59], v7 offset:55296
    v_mul_f32 v88, 0x3e0293ee, v88
    v_mul_f32 v89, 0x3e0293ee, v89
    v_cvt_pk_bf16_f32 v24, v88, v89
    v_mul_f32 v90, 0x3e0293ee, v90
    v_mul_f32 v91, 0x3e0293ee, v91
    v_cvt_pk_bf16_f32 v25, v90, v91
    s_waitcnt lgkmcnt(4)
    v_mfma_f32_16x16x32_bf16 v[64:67], v[192:195], v[28:31], v[64:67]
    v_mfma_f32_16x16x32_bf16 v[64:67], v[200:203], v[32:35], v[64:67]
    v_mul_f32 v92, 0x3e0293ee, v92
    v_mul_f32 v93, 0x3e0293ee, v93
    v_cvt_pk_bf16_f32 v26, v92, v93
    v_mul_f32 v94, 0x3e0293ee, v94
    v_mul_f32 v95, 0x3e0293ee, v95
    v_cvt_pk_bf16_f32 v27, v94, v95
    s_add_u32 s60, s54, 8192
    buffer_store_dwordx4 v[20:23], v2, s[12:15], s60 offen offset:0 sc1
    v_mfma_f32_16x16x32_bf16 v[68:71], v[196:199], v[28:31], v[68:71]
    ds_read_b128 v[28:31], v6 offset:57344
    v_mfma_f32_16x16x32_bf16 v[68:71], v[204:207], v[32:35], v[68:71]
    ds_read_b128 v[32:35], v7 offset:57344
    v_mfma_f32_16x16x32_bf16 v[72:75], v[192:195], v[36:39], v[72:75]
    v_mfma_f32_16x16x32_bf16 v[72:75], v[200:203], v[40:43], v[72:75]
    v_mfma_f32_16x16x32_bf16 v[76:79], v[196:199], v[36:39], v[76:79]
    ds_read_b128 v[36:39], v6 offset:59392
    v_mfma_f32_16x16x32_bf16 v[76:79], v[204:207], v[40:43], v[76:79]
    ds_read_b128 v[40:43], v7 offset:59392
    s_add_u32 s60, s54, 8192
    buffer_store_dwordx4 v[24:27], v2, s[12:15], s60 offen offset:1024 sc1
    s_waitcnt lgkmcnt(4)
    v_mfma_f32_16x16x32_bf16 v[64:67], v[208:211], v[44:47], v[64:67]
    v_mfma_f32_16x16x32_bf16 v[64:67], v[216:219], v[48:51], v[64:67]
    v_mfma_f32_16x16x32_bf16 v[68:71], v[212:215], v[44:47], v[68:71]
    ds_read_b128 v[44:47], v6 offset:61440
    v_mfma_f32_16x16x32_bf16 v[68:71], v[220:223], v[48:51], v[68:71]
    ds_read_b128 v[48:51], v7 offset:61440
    v_mfma_f32_16x16x32_bf16 v[72:75], v[208:211], v[52:55], v[72:75]
    v_mfma_f32_16x16x32_bf16 v[72:75], v[216:219], v[56:59], v[72:75]
    v_mfma_f32_16x16x32_bf16 v[76:79], v[212:215], v[52:55], v[76:79]
    ds_read_b128 v[52:55], v6 offset:63488
    v_mfma_f32_16x16x32_bf16 v[76:79], v[220:223], v[56:59], v[76:79]
    ds_read_b128 v[56:59], v7 offset:63488
    s_waitcnt vmcnt(8)
    s_barrier
    s_waitcnt lgkmcnt(4)
    v_mfma_f32_16x16x32_bf16 v[64:67], v[224:227], v[28:31], v[64:67]
    v_mfma_f32_16x16x32_bf16 v[64:67], v[232:235], v[32:35], v[64:67]
    v_mfma_f32_16x16x32_bf16 v[68:71], v[228:231], v[28:31], v[68:71]
    v_add_u32 v6, 0x10000, v6
    v_add_u32 v7, 0x10000, v7
    ds_read_b128 v[28:31], v6 offset:0
    v_mfma_f32_16x16x32_bf16 v[68:71], v[236:239], v[32:35], v[68:71]
    ds_read_b128 v[32:35], v7 offset:0
    v_mfma_f32_16x16x32_bf16 v[72:75], v[224:227], v[36:39], v[72:75]
    v_mfma_f32_16x16x32_bf16 v[72:75], v[232:235], v[40:43], v[72:75]
    v_mul_f32 v96, 0x3e0293ee, v96
    v_mul_f32 v97, 0x3e0293ee, v97
    v_cvt_pk_bf16_f32 v12, v96, v97
    v_mul_f32 v98, 0x3e0293ee, v98
    v_mul_f32 v99, 0x3e0293ee, v99
    v_cvt_pk_bf16_f32 v13, v98, v99
    v_mfma_f32_16x16x32_bf16 v[76:79], v[228:231], v[36:39], v[76:79]
    ds_read_b128 v[36:39], v6 offset:2048
    v_mfma_f32_16x16x32_bf16 v[76:79], v[236:239], v[40:43], v[76:79]
    ds_read_b128 v[40:43], v7 offset:2048
    v_mul_f32 v100, 0x3e0293ee, v100
    v_mul_f32 v101, 0x3e0293ee, v101
    v_cvt_pk_bf16_f32 v14, v100, v101
    v_mul_f32 v102, 0x3e0293ee, v102
    v_mul_f32 v103, 0x3e0293ee, v103
    v_cvt_pk_bf16_f32 v15, v102, v103
    s_waitcnt lgkmcnt(4)
    v_mfma_f32_16x16x32_bf16 v[64:67], v[240:243], v[44:47], v[64:67]
    v_mfma_f32_16x16x32_bf16 v[64:67], v[248:251], v[48:51], v[64:67]
    v_mul_f32 v104, 0x3e0293ee, v104
    v_mul_f32 v105, 0x3e0293ee, v105
    v_cvt_pk_bf16_f32 v16, v104, v105
    v_mul_f32 v106, 0x3e0293ee, v106
    v_mul_f32 v107, 0x3e0293ee, v107
    v_cvt_pk_bf16_f32 v17, v106, v107
    v_mfma_f32_16x16x32_bf16 v[68:71], v[244:247], v[44:47], v[68:71]
    ds_read_b128 v[44:47], v6 offset:4096
    v_mfma_f32_16x16x32_bf16 v[68:71], v[252:255], v[48:51], v[68:71]
    ds_read_b128 v[48:51], v7 offset:4096
    v_mul_f32 v108, 0x3e0293ee, v108
    v_mul_f32 v109, 0x3e0293ee, v109
    v_cvt_pk_bf16_f32 v18, v108, v109
    v_mul_f32 v110, 0x3e0293ee, v110
    v_mul_f32 v111, 0x3e0293ee, v111
    v_cvt_pk_bf16_f32 v19, v110, v111
    s_add_u32 s60, s54, 16384
    buffer_store_dwordx4 v[12:15], v2, s[12:15], s60 offen offset:0 sc1
    v_mfma_f32_16x16x32_bf16 v[72:75], v[240:243], v[52:55], v[72:75]
    v_mfma_f32_16x16x32_bf16 v[72:75], v[248:251], v[56:59], v[72:75]
    v_mfma_f32_16x16x32_bf16 v[76:79], v[244:247], v[52:55], v[76:79]
    ds_read_b128 v[52:55], v6 offset:6144
    v_mfma_f32_16x16x32_bf16 v[76:79], v[252:255], v[56:59], v[76:79]
    ds_read_b128 v[56:59], v7 offset:6144
    s_waitcnt lgkmcnt(4)
    v_mfma_f32_16x16x32_bf16 v[80:83], v[128:131], v[28:31], 0
    v_mfma_f32_16x16x32_bf16 v[80:83], v[136:139], v[32:35], v[80:83]
    s_add_u32 s60, s54, 16384
    buffer_store_dwordx4 v[16:19], v2, s[12:15], s60 offen offset:1024 sc1
    v_mfma_f32_16x16x32_bf16 v[84:87], v[132:135], v[28:31], 0
    ds_read_b128 v[28:31], v6 offset:8192
    v_mfma_f32_16x16x32_bf16 v[84:87], v[140:143], v[32:35], v[84:87]
    ds_read_b128 v[32:35], v7 offset:8192
    v_mfma_f32_16x16x32_bf16 v[88:91], v[128:131], v[36:39], 0
    v_mfma_f32_16x16x32_bf16 v[88:91], v[136:139], v[40:43], v[88:91]
    v_mfma_f32_16x16x32_bf16 v[92:95], v[132:135], v[36:39], 0
    ds_read_b128 v[36:39], v6 offset:10240
    v_mfma_f32_16x16x32_bf16 v[92:95], v[140:143], v[40:43], v[92:95]
    ds_read_b128 v[40:43], v7 offset:10240
    s_waitcnt lgkmcnt(4)
    v_mfma_f32_16x16x32_bf16 v[80:83], v[144:147], v[44:47], v[80:83]
    v_mfma_f32_16x16x32_bf16 v[80:83], v[152:155], v[48:51], v[80:83]
    v_mfma_f32_16x16x32_bf16 v[84:87], v[148:151], v[44:47], v[84:87]
    ds_read_b128 v[44:47], v6 offset:12288
    v_mfma_f32_16x16x32_bf16 v[84:87], v[156:159], v[48:51], v[84:87]
    ds_read_b128 v[48:51], v7 offset:12288
    v_mfma_f32_16x16x32_bf16 v[88:91], v[144:147], v[52:55], v[88:91]
    v_mfma_f32_16x16x32_bf16 v[88:91], v[152:155], v[56:59], v[88:91]
    v_mfma_f32_16x16x32_bf16 v[92:95], v[148:151], v[52:55], v[92:95]
    ds_read_b128 v[52:55], v6 offset:14336
    v_mfma_f32_16x16x32_bf16 v[92:95], v[156:159], v[56:59], v[92:95]
    ds_read_b128 v[56:59], v7 offset:14336
    s_barrier
    s_waitcnt lgkmcnt(4)
    v_mfma_f32_16x16x32_bf16 v[80:83], v[160:163], v[28:31], v[80:83]
    v_mfma_f32_16x16x32_bf16 v[80:83], v[168:171], v[32:35], v[80:83]
    s_add_u32 m0, s66, 32768
    s_add_u32 s59, s65, 1048576
    buffer_load_dwordx4 v5, s[16:19], s59 offen lds
    v_mfma_f32_16x16x32_bf16 v[84:87], v[164:167], v[28:31], v[84:87]
    ds_read_b128 v[28:31], v6 offset:16384
    v_mfma_f32_16x16x32_bf16 v[84:87], v[172:175], v[32:35], v[84:87]
    ds_read_b128 v[32:35], v7 offset:16384
    s_add_u32 m0, s66, 33792
    s_add_u32 s59, s65, 1048640
    buffer_load_dwordx4 v5, s[16:19], s59 offen lds
    v_mfma_f32_16x16x32_bf16 v[88:91], v[160:163], v[36:39], v[88:91]
    v_mfma_f32_16x16x32_bf16 v[88:91], v[168:171], v[40:43], v[88:91]
    s_add_u32 m0, s66, 34816
    s_add_u32 s59, s65, 1048704
    buffer_load_dwordx4 v5, s[16:19], s59 offen lds
    v_mfma_f32_16x16x32_bf16 v[92:95], v[164:167], v[36:39], v[92:95]
    ds_read_b128 v[36:39], v6 offset:18432
    v_mfma_f32_16x16x32_bf16 v[92:95], v[172:175], v[40:43], v[92:95]
    ds_read_b128 v[40:43], v7 offset:18432
    s_add_u32 m0, s66, 35840
    s_add_u32 s59, s65, 1048768
    buffer_load_dwordx4 v5, s[16:19], s59 offen lds
    s_waitcnt lgkmcnt(4)
    v_mfma_f32_16x16x32_bf16 v[80:83], v[176:179], v[44:47], v[80:83]
    v_mfma_f32_16x16x32_bf16 v[80:83], v[184:187], v[48:51], v[80:83]
    v_mfma_f32_16x16x32_bf16 v[84:87], v[180:183], v[44:47], v[84:87]
    ds_read_b128 v[44:47], v6 offset:20480
    v_mfma_f32_16x16x32_bf16 v[84:87], v[188:191], v[48:51], v[84:87]
    ds_read_b128 v[48:51], v7 offset:20480
    v_mul_f32 v112, 0x3e0293ee, v112
    v_mul_f32 v113, 0x3e0293ee, v113
    v_cvt_pk_bf16_f32 v20, v112, v113
    v_mul_f32 v114, 0x3e0293ee, v114
    v_mul_f32 v115, 0x3e0293ee, v115
    v_cvt_pk_bf16_f32 v21, v114, v115
    v_mfma_f32_16x16x32_bf16 v[88:91], v[176:179], v[52:55], v[88:91]
    v_mfma_f32_16x16x32_bf16 v[88:91], v[184:187], v[56:59], v[88:91]
    v_mul_f32 v116, 0x3e0293ee, v116
    v_mul_f32 v117, 0x3e0293ee, v117
    v_cvt_pk_bf16_f32 v22, v116, v117
    v_mul_f32 v118, 0x3e0293ee, v118
    v_mul_f32 v119, 0x3e0293ee, v119
    v_cvt_pk_bf16_f32 v23, v118, v119
    v_mfma_f32_16x16x32_bf16 v[92:95], v[180:183], v[52:55], v[92:95]
    ds_read_b128 v[52:55], v6 offset:22528
    v_mfma_f32_16x16x32_bf16 v[92:95], v[188:191], v[56:59], v[92:95]
    ds_read_b128 v[56:59], v7 offset:22528
    v_mul_f32 v120, 0x3e0293ee, v120
    v_mul_f32 v121, 0x3e0293ee, v121
    v_cvt_pk_bf16_f32 v24, v120, v121
    v_mul_f32 v122, 0x3e0293ee, v122
    v_mul_f32 v123, 0x3e0293ee, v123
    v_cvt_pk_bf16_f32 v25, v122, v123
    s_waitcnt lgkmcnt(4)
    v_mfma_f32_16x16x32_bf16 v[80:83], v[192:195], v[28:31], v[80:83]
    v_mfma_f32_16x16x32_bf16 v[80:83], v[200:203], v[32:35], v[80:83]
    v_mul_f32 v124, 0x3e0293ee, v124
    v_mul_f32 v125, 0x3e0293ee, v125
    v_cvt_pk_bf16_f32 v26, v124, v125
    v_mul_f32 v126, 0x3e0293ee, v126
    v_mul_f32 v127, 0x3e0293ee, v127
    v_cvt_pk_bf16_f32 v27, v126, v127
    s_add_u32 s60, s54, 24576
    buffer_store_dwordx4 v[20:23], v2, s[12:15], s60 offen offset:0 sc1
    v_mfma_f32_16x16x32_bf16 v[84:87], v[196:199], v[28:31], v[84:87]
    ds_read_b128 v[28:31], v6 offset:24576
    v_mfma_f32_16x16x32_bf16 v[84:87], v[204:207], v[32:35], v[84:87]
    ds_read_b128 v[32:35], v7 offset:24576
    v_mfma_f32_16x16x32_bf16 v[88:91], v[192:195], v[36:39], v[88:91]
    v_mfma_f32_16x16x32_bf16 v[88:91], v[200:203], v[40:43], v[88:91]
    v_mfma_f32_16x16x32_bf16 v[92:95], v[196:199], v[36:39], v[92:95]
    ds_read_b128 v[36:39], v6 offset:26624
    v_mfma_f32_16x16x32_bf16 v[92:95], v[204:207], v[40:43], v[92:95]
    ds_read_b128 v[40:43], v7 offset:26624
    s_add_u32 s60, s54, 24576
    buffer_store_dwordx4 v[24:27], v2, s[12:15], s60 offen offset:1024 sc1
    s_waitcnt lgkmcnt(4)
    v_mfma_f32_16x16x32_bf16 v[80:83], v[208:211], v[44:47], v[80:83]
    v_mfma_f32_16x16x32_bf16 v[80:83], v[216:219], v[48:51], v[80:83]
    v_mfma_f32_16x16x32_bf16 v[84:87], v[212:215], v[44:47], v[84:87]
    ds_read_b128 v[44:47], v6 offset:28672
    v_mfma_f32_16x16x32_bf16 v[84:87], v[220:223], v[48:51], v[84:87]
    ds_read_b128 v[48:51], v7 offset:28672
    v_mfma_f32_16x16x32_bf16 v[88:91], v[208:211], v[52:55], v[88:91]
    v_mfma_f32_16x16x32_bf16 v[88:91], v[216:219], v[56:59], v[88:91]
    v_mfma_f32_16x16x32_bf16 v[92:95], v[212:215], v[52:55], v[92:95]
    ds_read_b128 v[52:55], v6 offset:30720
    v_mfma_f32_16x16x32_bf16 v[92:95], v[220:223], v[56:59], v[92:95]
    ds_read_b128 v[56:59], v7 offset:30720
    s_waitcnt lgkmcnt(4)
    v_mfma_f32_16x16x32_bf16 v[80:83], v[224:227], v[28:31], v[80:83]
    v_mfma_f32_16x16x32_bf16 v[80:83], v[232:235], v[32:35], v[80:83]
    v_mul_f32 v64, 0x3e0293ee, v64
    v_mul_f32 v65, 0x3e0293ee, v65
    v_cvt_pk_bf16_f32 v12, v64, v65
    v_mul_f32 v66, 0x3e0293ee, v66
    v_mul_f32 v67, 0x3e0293ee, v67
    v_cvt_pk_bf16_f32 v13, v66, v67
    v_mfma_f32_16x16x32_bf16 v[84:87], v[228:231], v[28:31], v[84:87]
    ds_read_b128 v[28:31], v6 offset:32768
    v_mfma_f32_16x16x32_bf16 v[84:87], v[236:239], v[32:35], v[84:87]
    ds_read_b128 v[32:35], v7 offset:32768
    v_mul_f32 v68, 0x3e0293ee, v68
    v_mul_f32 v69, 0x3e0293ee, v69
    v_cvt_pk_bf16_f32 v14, v68, v69
    v_mul_f32 v70, 0x3e0293ee, v70
    v_mul_f32 v71, 0x3e0293ee, v71
    v_cvt_pk_bf16_f32 v15, v70, v71
    v_mfma_f32_16x16x32_bf16 v[88:91], v[224:227], v[36:39], v[88:91]
    v_mfma_f32_16x16x32_bf16 v[88:91], v[232:235], v[40:43], v[88:91]
    s_cmp_lg_u32 s40, 1
    s_cbranch_scc1 KFP_13
    v_mov_b32 v63, 0
    buffer_load_dword v63, v63, s[36:39], 0 offen sc1
KFP_13:
    v_mul_f32 v72, 0x3e0293ee, v72
    v_mul_f32 v73, 0x3e0293ee, v73
    v_cvt_pk_bf16_f32 v16, v72, v73
    v_mul_f32 v74, 0x3e0293ee, v74
    v_mul_f32 v75, 0x3e0293ee, v75
    v_cvt_pk_bf16_f32 v17, v74, v75
    v_mfma_f32_16x16x32_bf16 v[92:95], v[228:231], v[36:39], v[92:95]
    ds_read_b128 v[36:39], v6 offset:34816
    v_mfma_f32_16x16x32_bf16 v[92:95], v[236:239], v[40:43], v[92:95]
    ds_read_b128 v[40:43], v7 offset:34816
    v_mul_f32 v76, 0x3e0293ee, v76
    v_mul_f32 v77, 0x3e0293ee, v77
    v_cvt_pk_bf16_f32 v18, v76, v77
    v_mul_f32 v78, 0x3e0293ee, v78
    v_mul_f32 v79, 0x3e0293ee, v79
    v_cvt_pk_bf16_f32 v19, v78, v79
    s_add_u32 s60, s54, 32768
    buffer_store_dwordx4 v[12:15], v2, s[12:15], s60 offen offset:0 sc1
    s_waitcnt lgkmcnt(4)
    v_mfma_f32_16x16x32_bf16 v[80:83], v[240:243], v[44:47], v[80:83]
    v_mfma_f32_16x16x32_bf16 v[80:83], v[248:251], v[48:51], v[80:83]
    v_mfma_f32_16x16x32_bf16 v[84:87], v[244:247], v[44:47], v[84:87]
    ds_read_b128 v[44:47], v6 offset:36864
    v_mfma_f32_16x16x32_bf16 v[84:87], v[252:255], v[48:51], v[84:87]
    ds_read_b128 v[48:51], v7 offset:36864
    v_mfma_f32_16x16x32_bf16 v[88:91], v[240:243], v[52:55], v[88:91]
    v_mfma_f32_16x16x32_bf16 v[88:91], v[248:251], v[56:59], v[88:91]
    s_add_u32 s60, s54, 32768
    buffer_store_dwordx4 v[16:19], v2, s[12:15], s60 offen offset:1024 sc1
    v_mfma_f32_16x16x32_bf16 v[92:95], v[244:247], v[52:55], v[92:95]
    ds_read_b128 v[52:55], v6 offset:38912
    v_mfma_f32_16x16x32_bf16 v[92:95], v[252:255], v[56:59], v[92:95]
    ds_read_b128 v[56:59], v7 offset:38912
    s_waitcnt lgkmcnt(4)
    v_mfma_f32_16x16x32_bf16 v[96:99], v[128:131], v[28:31], 0
    v_mfma_f32_16x16x32_bf16 v[96:99], v[136:139], v[32:35], v[96:99]
    v_mfma_f32_16x16x32_bf16 v[100:103], v[132:135], v[28:31], 0
    ds_read_b128 v[28:31], v6 offset:40960
    v_mfma_f32_16x16x32_bf16 v[100:103], v[140:143], v[32:35], v[100:103]
    ds_read_b128 v[32:35], v7 offset:40960
    v_mfma_f32_16x16x32_bf16 v[104:107], v[128:131], v[36:39], 0
    v_mfma_f32_16x16x32_bf16 v[104:107], v[136:139], v[40:43], v[104:107]
    v_mfma_f32_16x16x32_bf16 v[108:111], v[132:135], v[36:39], 0
    ds_read_b128 v[36:39], v6 offset:43008
    v_mfma_f32_16x16x32_bf16 v[108:111], v[140:143], v[40:43], v[108:111]
    ds_read_b128 v[40:43], v7 offset:43008
    s_waitcnt lgkmcnt(4)
    v_mfma_f32_16x16x32_bf16 v[96:99], v[144:147], v[44:47], v[96:99]
    v_mfma_f32_16x16x32_bf16 v[96:99], v[152:155], v[48:51], v[96:99]
    v_mfma_f32_16x16x32_bf16 v[100:103], v[148:151], v[44:47], v[100:103]
    ds_read_b128 v[44:47], v6 offset:45056
    v_mfma_f32_16x16x32_bf16 v[100:103], v[156:159], v[48:51], v[100:103]
    ds_read_b128 v[48:51], v7 offset:45056
    v_mfma_f32_16x16x32_bf16 v[104:107], v[144:147], v[52:55], v[104:107]
    v_mfma_f32_16x16x32_bf16 v[104:107], v[152:155], v[56:59], v[104:107]
    v_mfma_f32_16x16x32_bf16 v[108:111], v[148:151], v[52:55], v[108:111]
    ds_read_b128 v[52:55], v6 offset:47104
    v_mfma_f32_16x16x32_bf16 v[108:111], v[156:159], v[56:59], v[108:111]
    ds_read_b128 v[56:59], v7 offset:47104
    s_cmp_lg_u32 s40, 1
    s_cbranch_scc1 KFR_15
    s_waitcnt vmcnt(2)
    v_cmp_gt_u32 vcc, 0x100, v63
    s_nop 0
    s_cmp_eq_u32 vcc_lo, 0
    s_cbranch_scc0 KFS_14
KFR_15:
    s_barrier
    s_waitcnt lgkmcnt(4)
    v_mfma_f32_16x16x32_bf16 v[96:99], v[160:163], v[28:31], v[96:99]
    v_mfma_f32_16x16x32_bf16 v[96:99], v[168:171], v[32:35], v[96:99]
    s_add_u32 m0, s66, 65536
    s_add_u32 s59, s65, 2097152
    buffer_load_dwordx4 v5, s[16:19], s59 offen lds
    v_mfma_f32_16x16x32_bf16 v[100:103], v[164:167], v[28:31], v[100:103]
    ds_read_b128 v[28:31], v6 offset:49152
    v_mfma_f32_16x16x32_bf16 v[100:103], v[172:175], v[32:35], v[100:103]
    ds_read_b128 v[32:35], v7 offset:49152
    s_add_u32 m0, s66, 66560
    s_add_u32 s59, s65, 2097216
    buffer_load_dwordx4 v5, s[16:19], s59 offen lds
    v_mfma_f32_16x16x32_bf16 v[104:107], v[160:163], v[36:39], v[104:107]
    v_mfma_f32_16x16x32_bf16 v[104:107], v[168:171], v[40:43], v[104:107]
    s_add_u32 m0, s66, 67584
    s_add_u32 s59, s65, 2097280
    buffer_load_dwordx4 v5, s[16:19], s59 offen lds
    v_mfma_f32_16x16x32_bf16 v[108:111], v[164:167], v[36:39], v[108:111]
    ds_read_b128 v[36:39], v6 offset:51200
    v_mfma_f32_16x16x32_bf16 v[108:111], v[172:175], v[40:43], v[108:111]
    ds_read_b128 v[40:43], v7 offset:51200
    s_add_u32 m0, s66, 68608
    s_add_u32 s59, s65, 2097344
    buffer_load_dwordx4 v5, s[16:19], s59 offen lds
    s_waitcnt lgkmcnt(4)
    v_mfma_f32_16x16x32_bf16 v[96:99], v[176:179], v[44:47], v[96:99]
    v_mfma_f32_16x16x32_bf16 v[96:99], v[184:187], v[48:51], v[96:99]
    v_mfma_f32_16x16x32_bf16 v[100:103], v[180:183], v[44:47], v[100:103]
    ds_read_b128 v[44:47], v6 offset:53248
    v_mfma_f32_16x16x32_bf16 v[100:103], v[188:191], v[48:51], v[100:103]
    ds_read_b128 v[48:51], v7 offset:53248
    v_mul_f32 v80, 0x3e0293ee, v80
    v_mul_f32 v81, 0x3e0293ee, v81
    v_cvt_pk_bf16_f32 v20, v80, v81
    v_mul_f32 v82, 0x3e0293ee, v82
    v_mul_f32 v83, 0x3e0293ee, v83
    v_cvt_pk_bf16_f32 v21, v82, v83
    v_mfma_f32_16x16x32_bf16 v[104:107], v[176:179], v[52:55], v[104:107]
    v_mfma_f32_16x16x32_bf16 v[104:107], v[184:187], v[56:59], v[104:107]
    v_mul_f32 v84, 0x3e0293ee, v84
    v_mul_f32 v85, 0x3e0293ee, v85
    v_cvt_pk_bf16_f32 v22, v84, v85
    v_mul_f32 v86, 0x3e0293ee, v86
    v_mul_f32 v87, 0x3e0293ee, v87
    v_cvt_pk_bf16_f32 v23, v86, v87
    v_mfma_f32_16x16x32_bf16 v[108:111], v[180:183], v[52:55], v[108:111]
    ds_read_b128 v[52:55], v6 offset:55296
    v_mfma_f32_16x16x32_bf16 v[108:111], v[188:191], v[56:59], v[108:111]
    ds_read_b128 v[56:59], v7 offset:55296
    v_mul_f32 v88, 0x3e0293ee, v88
    v_mul_f32 v89, 0x3e0293ee, v89
    v_cvt_pk_bf16_f32 v24, v88, v89
    v_mul_f32 v90, 0x3e0293ee, v90
    v_mul_f32 v91, 0x3e0293ee, v91
    v_cvt_pk_bf16_f32 v25, v90, v91
    s_waitcnt lgkmcnt(4)
    v_mfma_f32_16x16x32_bf16 v[96:99], v[192:195], v[28:31], v[96:99]
    v_mfma_f32_16x16x32_bf16 v[96:99], v[200:203], v[32:35], v[96:99]
    v_mul_f32 v92, 0x3e0293ee, v92
    v_mul_f32 v93, 0x3e0293ee, v93
    v_cvt_pk_bf16_f32 v26, v92, v93
    v_mul_f32 v94, 0x3e0293ee, v94
    v_mul_f32 v95, 0x3e0293ee, v95
    v_cvt_pk_bf16_f32 v27, v94, v95
    s_add_u32 s60, s54, 40960
    buffer_store_dwordx4 v[20:23], v2, s[12:15], s60 offen offset:0 sc1
    v_mfma_f32_16x16x32_bf16 v[100:103], v[196:199], v[28:31], v[100:103]
    ds_read_b128 v[28:31], v6 offset:57344
    v_mfma_f32_16x16x32_bf16 v[100:103], v[204:207], v[32:35], v[100:103]
    ds_read_b128 v[32:35], v7 offset:57344
    v_mfma_f32_16x16x32_bf16 v[104:107], v[192:195], v[36:39], v[104:107]
    v_mfma_f32_16x16x32_bf16 v[104:107], v[200:203], v[40:43], v[104:107]
    v_mfma_f32_16x16x32_bf16 v[108:111], v[196:199], v[36:39], v[108:111]
    ds_read_b128 v[36:39], v6 offset:59392
    v_mfma_f32_16x16x32_bf16 v[108:111], v[204:207], v[40:43], v[108:111]
    ds_read_b128 v[40:43], v7 offset:59392
    s_add_u32 s60, s54, 40960
    buffer_store_dwordx4 v[24:27], v2, s[12:15], s60 offen offset:1024 sc1
    s_waitcnt lgkmcnt(4)
    v_mfma_f32_16x16x32_bf16 v[96:99], v[208:211], v[44:47], v[96:99]
    v_mfma_f32_16x16x32_bf16 v[96:99], v[216:219], v[48:51], v[96:99]
    v_mfma_f32_16x16x32_bf16 v[100:103], v[212:215], v[44:47], v[100:103]
    ds_read_b128 v[44:47], v6 offset:61440
    v_mfma_f32_16x16x32_bf16 v[100:103], v[220:223], v[48:51], v[100:103]
    ds_read_b128 v[48:51], v7 offset:61440
    v_mfma_f32_16x16x32_bf16 v[104:107], v[208:211], v[52:55], v[104:107]
    v_mfma_f32_16x16x32_bf16 v[104:107], v[216:219], v[56:59], v[104:107]
    v_mfma_f32_16x16x32_bf16 v[108:111], v[212:215], v[52:55], v[108:111]
    ds_read_b128 v[52:55], v6 offset:63488
    v_mfma_f32_16x16x32_bf16 v[108:111], v[220:223], v[56:59], v[108:111]
    ds_read_b128 v[56:59], v7 offset:63488
    s_waitcnt lgkmcnt(4)
    v_mfma_f32_16x16x32_bf16 v[96:99], v[224:227], v[28:31], v[96:99]
    v_mfma_f32_16x16x32_bf16 v[96:99], v[232:235], v[32:35], v[96:99]
    v_mfma_f32_16x16x32_bf16 v[100:103], v[228:231], v[28:31], v[100:103]
    v_add_u32 v6, 0x10000, v6
    v_add_u32 v7, 0x10000, v7
    ds_read_b128 v[28:31], v6 offset:0
    v_mfma_f32_16x16x32_bf16 v[100:103], v[236:239], v[32:35], v[100:103]
    ds_read_b128 v[32:35], v7 offset:0
    v_mfma_f32_16x16x32_bf16 v[104:107], v[224:227], v[36:39], v[104:107]
    v_mfma_f32_16x16x32_bf16 v[104:107], v[232:235], v[40:43], v[104:107]
    v_mfma_f32_16x16x32_bf16 v[108:111], v[228:231], v[36:39], v[108:111]
    ds_read_b128 v[36:39], v6 offset:2048
    v_mfma_f32_16x16x32_bf16 v[108:111], v[236:239], v[40:43], v[108:111]
    ds_read_b128 v[40:43], v7 offset:2048
    s_waitcnt lgkmcnt(4)
    v_mfma_f32_16x16x32_bf16 v[96:99], v[240:243], v[44:47], v[96:99]
    v_mfma_f32_16x16x32_bf16 v[96:99], v[248:251], v[48:51], v[96:99]
    v_mfma_f32_16x16x32_bf16 v[100:103], v[244:247], v[44:47], v[100:103]
    ds_read_b128 v[44:47], v6 offset:4096
    v_mfma_f32_16x16x32_bf16 v[100:103], v[252:255], v[48:51], v[100:103]
    ds_read_b128 v[48:51], v7 offset:4096
    v_mfma_f32_16x16x32_bf16 v[104:107], v[240:243], v[52:55], v[104:107]
    v_mfma_f32_16x16x32_bf16 v[104:107], v[248:251], v[56:59], v[104:107]
    v_mfma_f32_16x16x32_bf16 v[108:111], v[244:247], v[52:55], v[108:111]
    ds_read_b128 v[52:55], v6 offset:6144
    v_mfma_f32_16x16x32_bf16 v[108:111], v[252:255], v[56:59], v[108:111]
    ds_read_b128 v[56:59], v7 offset:6144
    s_waitcnt lgkmcnt(4)
    v_mfma_f32_16x16x32_bf16 v[112:115], v[128:131], v[28:31], 0
    v_mfma_f32_16x16x32_bf16 v[112:115], v[136:139], v[32:35], v[112:115]
    v_mfma_f32_16x16x32_bf16 v[116:119], v[132:135], v[28:31], 0
    ds_read_b128 v[28:31], v6 offset:8192
    v_mfma_f32_16x16x32_bf16 v[116:119], v[140:143], v[32:35], v[116:119]
    ds_read_b128 v[32:35], v7 offset:8192
    v_mfma_f32_16x16x32_bf16 v[120:123], v[128:131], v[36:39], 0
    v_mfma_f32_16x16x32_bf16 v[120:123], v[136:139], v[40:43], v[120:123]
    s_add_u32 s59, s67, 0
    buffer_load_dwordx4 v[128:131], v2, s[24:27], s59 offen offset:0 sc1
    v_mfma_f32_16x16x32_bf16 v[124:127], v[132:135], v[36:39], 0
    ds_read_b128 v[36:39], v6 offset:10240
    v_mfma_f32_16x16x32_bf16 v[124:127], v[140:143], v[40:43], v[124:127]
    ds_read_b128 v[40:43], v7 offset:10240
    s_add_u32 s59, s67, 0
    buffer_load_dwordx4 v[136:139], v2, s[24:27], s59 offen offset:1024 sc1
    s_waitcnt lgkmcnt(4)
    v_mfma_f32_16x16x32_bf16 v[112:115], v[144:147], v[44:47], v[112:115]
    v_mfma_f32_16x16x32_bf16 v[112:115], v[152:155], v[48:51], v[112:115]
    s_add_u32 s59, s67, 16384
    buffer_load_dwordx4 v[132:135], v2, s[24:27], s59 offen offset:0 sc1
    v_mfma_f32_16x16x32_bf16 v[116:119], v[148:151], v[44:47], v[116:119]
    ds_read_b128 v[44:47], v6 offset:12288
    v_mfma_f32_16x16x32_bf16 v[116:119], v[156:159], v[48:51], v[116:119]
    ds_read_b128 v[48:51], v7 offset:12288
    s_add_u32 s59, s67, 16384
    buffer_load_dwordx4 v[140:143], v2, s[24:27], s59 offen offset:1024 sc1
    v_mfma_f32_16x16x32_bf16 v[120:123], v[144:147], v[52:55], v[120:123]
    v_mfma_f32_16x16x32_bf16 v[120:123], v[152:155], v[56:59], v[120:123]
    s_add_u32 s59, s67, 0
    buffer_load_dwordx4 v[144:147], v2, s[24:27], s59 offen offset:2048 sc1
    v_mfma_f32_16x16x32_bf16 v[124:127], v[148:151], v[52:55], v[124:127]
    ds_read_b128 v[52:55], v6 offset:14336
    v_mfma_f32_16x16x32_bf16 v[124:127], v[156:159], v[56:59], v[124:127]
    ds_read_b128 v[56:59], v7 offset:14336
    s_add_u32 s59, s67, 0
    buffer_load_dwordx4 v[152:155], v2, s[24:27], s59 offen offset:3072 sc1
    s_waitcnt vmcnt(14)
    s_barrier
    s_cmp_lg_u32 s40, 0
    s_cbranch_scc1 KFG_16
    s_lshl_b32 s63, s42, 2
    v_mov_b32 v60, s63
    v_mov_b32 v61, 1
    s_mov_b64 exec, 1
    buffer_store_dword v61, v60, s[24:27], s76 offen sc1
    s_mov_b64 exec, -1
KFG_16:
    s_waitcnt lgkmcnt(4)
    v_mfma_f32_16x16x32_bf16 v[112:115], v[160:163], v[28:31], v[112:115]
    v_mfma_f32_16x16x32_bf16 v[112:115], v[168:171], v[32:35], v[112:115]
    s_add_u32 s59, s67, 16384
    buffer_load_dwordx4 v[148:151], v2, s[24:27], s59 offen offset:2048 sc1
    s_add_u32 m0, s66, 98304
    s_add_u32 s59, s65, 3145728
    buffer_load_dwordx4 v5, s[16:19], s59 offen lds
    v_mfma_f32_16x16x32_bf16 v[116:119], v[164:167], v[28:31], v[116:119]
    ds_read_b128 v[28:31], v6 offset:16384
    v_mfma_f32_16x16x32_bf16 v[116:119], v[172:175], v[32:35], v[116:119]
    ds_read_b128 v[32:35], v7 offset:16384
    s_add_u32 s59, s67, 16384
    buffer_load_dwordx4 v[156:159], v2, s[24:27], s59 offen offset:3072 sc1
    s_add_u32 m0, s66, 99328
    s_add_u32 s59, s65, 3145792
    buffer_load_dwordx4 v5, s[16:19], s59 offen lds
    v_mfma_f32_16x16x32_bf16 v[120:123], v[160:163], v[36:39], v[120:123]
    v_mfma_f32_16x16x32_bf16 v[120:123], v[168:171], v[40:43], v[120:123]
    s_add_u32 m0, s66, 100352
    s_add_u32 s59, s65, 3145856
    buffer_load_dwordx4 v5, s[16:19], s59 offen lds
    v_mfma_f32_16x16x32_bf16 v[124:127], v[164:167], v[36:39], v[124:127]
    ds_read_b128 v[36:39], v6 offset:18432
    v_mfma_f32_16x16x32_bf16 v[124:127], v[172:175], v[40:43], v[124:127]
    ds_read_b128 v[40:43], v7 offset:18432
    s_add_u32 m0, s66, 101376
    s_add_u32 s59, s65, 3145920
    buffer_load_dwordx4 v5, s[16:19], s59 offen lds
    s_waitcnt lgkmcnt(4)
    v_mfma_f32_16x16x32_bf16 v[112:115], v[176:179], v[44:47], v[112:115]
    v_mfma_f32_16x16x32_bf16 v[112:115], v[184:187], v[48:51], v[112:115]
    s_add_u32 s59, s67, 4096
    buffer_load_dwordx4 v[160:163], v2, s[24:27], s59 offen offset:0 sc1
    v_mfma_f32_16x16x32_bf16 v[116:119], v[180:183], v[44:47], v[116:119]
    ds_read_b128 v[44:47], v6 offset:20480
    v_mfma_f32_16x16x32_bf16 v[116:119], v[188:191], v[48:51], v[116:119]
    ds_read_b128 v[48:51], v7 offset:20480
    v_mul_f32 v96, 0x3e0293ee, v96
    v_mul_f32 v97, 0x3e0293ee, v97
    v_cvt_pk_bf16_f32 v12, v96, v97
    v_mul_f32 v98, 0x3e0293ee, v98
    v_mul_f32 v99, 0x3e0293ee, v99
    v_cvt_pk_bf16_f32 v13, v98, v99
    v_mfma_f32_16x16x32_bf16 v[120:123], v[176:179], v[52:55], v[120:123]
    v_mfma_f32_16x16x32_bf16 v[120:123], v[184:187], v[56:59], v[120:123]
    v_mul_f32 v100, 0x3e0293ee, v100
    v_mul_f32 v101, 0x3e0293ee, v101
    v_cvt_pk_bf16_f32 v14, v100, v101
    v_mul_f32 v102, 0x3e0293ee, v102
    v_mul_f32 v103, 0x3e0293ee, v103
    v_cvt_pk_bf16_f32 v15, v102, v103
    v_mfma_f32_16x16x32_bf16 v[124:127], v[180:183], v[52:55], v[124:127]
    ds_read_b128 v[52:55], v6 offset:22528
    v_mfma_f32_16x16x32_bf16 v[124:127], v[188:191], v[56:59], v[124:127]
    ds_read_b128 v[56:59], v7 offset:22528
    v_mul_f32 v104, 0x3e0293ee, v104
    v_mul_f32 v105, 0x3e0293ee, v105
    v_cvt_pk_bf16_f32 v16, v104, v105
    v_mul_f32 v106, 0x3e0293ee, v106
    v_mul_f32 v107, 0x3e0293ee, v107
    v_cvt_pk_bf16_f32 v17, v106, v107
    s_waitcnt lgkmcnt(4)
    v_mfma_f32_16x16x32_bf16 v[112:115], v[192:195], v[28:31], v[112:115]
    v_mfma_f32_16x16x32_bf16 v[112:115], v[200:203], v[32:35], v[112:115]
    s_add_u32 s59, s67, 4096
    buffer_load_dwordx4 v[168:171], v2, s[24:27], s59 offen offset:1024 sc1
    v_mul_f32 v108, 0x3e0293ee, v108
    v_mul_f32 v109, 0x3e0293ee, v109
    v_cvt_pk_bf16_f32 v18, v108, v109
    v_mul_f32 v110, 0x3e0293ee, v110
    v_mul_f32 v111, 0x3e0293ee, v111
    v_cvt_pk_bf16_f32 v19, v110, v111
    s_add_u32 s60, s54, 49152
    buffer_store_dwordx4 v[12:15], v2, s[12:15], s60 offen offset:0 sc1
    v_mfma_f32_16x16x32_bf16 v[116:119], v[196:199], v[28:31], v[116:119]
    ds_read_b128 v[28:31], v6 offset:24576
    v_mfma_f32_16x16x32_bf16 v[116:119], v[204:207], v[32:35], v[116:119]
    ds_read_b128 v[32:35], v7 offset:24576
    v_mfma_f32_16x16x32_bf16 v[120:123], v[192:195], v[36:39], v[120:123]
    v_mfma_f32_16x16x32_bf16 v[120:123], v[200:203], v[40:43], v[120:123]
    v_mfma_f32_16x16x32_bf16 v[124:127], v[196:199], v[36:39], v[124:127]
    ds_read_b128 v[36:39], v6 offset:26624
    v_mfma_f32_16x16x32_bf16 v[124:127], v[204:207], v[40:43], v[124:127]
    ds_read_b128 v[40:43], v7 offset:26624
    s_add_u32 s60, s54, 49152
    buffer_store_dwordx4 v[16:19], v2, s[12:15], s60 offen offset:1024 sc1
    s_waitcnt lgkmcnt(4)
    v_mfma_f32_16x16x32_bf16 v[112:115], v[208:211], v[44:47], v[112:115]
    v_mfma_f32_16x16x32_bf16 v[112:115], v[216:219], v[48:51], v[112:115]
    s_add_u32 s59, s67, 20480
    buffer_load_dwordx4 v[164:167], v2, s[24:27], s59 offen offset:0 sc1
    v_mfma_f32_16x16x32_bf16 v[116:119], v[212:215], v[44:47], v[116:119]
    ds_read_b128 v[44:47], v6 offset:28672
    v_mfma_f32_16x16x32_bf16 v[116:119], v[220:223], v[48:51], v[116:119]
    ds_read_b128 v[48:51], v7 offset:28672
    v_mfma_f32_16x16x32_bf16 v[120:123], v[208:211], v[52:55], v[120:123]
    v_mfma_f32_16x16x32_bf16 v[120:123], v[216:219], v[56:59], v[120:123]
    v_mfma_f32_16x16x32_bf16 v[124:127], v[212:215], v[52:55], v[124:127]
    ds_read_b128 v[52:55], v6 offset:30720
    v_mfma_f32_16x16x32_bf16 v[124:127], v[220:223], v[56:59], v[124:127]
    ds_read_b128 v[56:59], v7 offset:30720
    s_waitcnt lgkmcnt(4)
    v_mfma_f32_16x16x32_bf16 v[112:115], v[224:227], v[28:31], v[112:115]
    v_mfma_f32_16x16x32_bf16 v[112:115], v[232:235], v[32:35], v[112:115]
    s_add_u32 s59, s67, 20480
    buffer_load_dwordx4 v[172:175], v2, s[24:27], s59 offen offset:1024 sc1
    v_mfma_f32_16x16x32_bf16 v[116:119], v[228:231], v[28:31], v[116:119]
    v_mfma_f32_16x16x32_bf16 v[116:119], v[236:239], v[32:35], v[116:119]
    v_mfma_f32_16x16x32_bf16 v[120:123], v[224:227], v[36:39], v[120:123]
    v_mfma_f32_16x16x32_bf16 v[120:123], v[232:235], v[40:43], v[120:123]
    v_mfma_f32_16x16x32_bf16 v[124:127], v[228:231], v[36:39], v[124:127]
    v_mfma_f32_16x16x32_bf16 v[124:127], v[236:239], v[40:43], v[124:127]
    s_waitcnt lgkmcnt(0)
    v_mfma_f32_16x16x32_bf16 v[112:115], v[240:243], v[44:47], v[112:115]
    ds_read_b64_tr_b16 v[28:29], v8 offset:0
    v_mfma_f32_16x16x32_bf16 v[112:115], v[248:251], v[48:51], v[112:115]
    s_add_u32 s59, s67, 4096
    buffer_load_dwordx4 v[176:179], v2, s[24:27], s59 offen offset:2048 sc1
    ds_read_b64_tr_b16 v[30:31], v8 offset:256
    v_mfma_f32_16x16x32_bf16 v[116:119], v[244:247], v[44:47], v[116:119]
    ds_read_b64_tr_b16 v[32:33], v8 offset:8192
    v_mfma_f32_16x16x32_bf16 v[116:119], v[252:255], v[48:51], v[116:119]
    ds_read_b64_tr_b16 v[34:35], v8 offset:8448
    v_mfma_f32_16x16x32_bf16 v[120:123], v[240:243], v[52:55], v[120:123]
    ds_read_b64_tr_b16 v[36:37], v8 offset:16384
    v_mfma_f32_16x16x32_bf16 v[120:123], v[248:251], v[56:59], v[120:123]
    ds_read_b64_tr_b16 v[38:39], v8 offset:16640
    v_mfma_f32_16x16x32_bf16 v[124:127], v[244:247], v[52:55], v[124:127]
    ds_read_b64_tr_b16 v[40:41], v8 offset:24576
    v_mfma_f32_16x16x32_bf16 v[124:127], v[252:255], v[56:59], v[124:127]
    ds_read_b64_tr_b16 v[42:43], v8 offset:24832
    s_waitcnt lgkmcnt(0)
    s_waitcnt vmcnt(13)
    v_mfma_f32_16x16x32_bf16 v[64:67], v[28:31], v[128:131], 0
    ds_read_b64_tr_b16 v[44:45], v9 offset:0
    ds_read_b64_tr_b16 v[46:47], v9 offset:256
    v_mfma_f32_16x16x32_bf16 v[64:67], v[32:35], v[136:139], v[64:67]
    ds_read_b64_tr_b16 v[48:49], v9 offset:8192
    ds_read_b64_tr_b16 v[50:51], v9 offset:8448
    v_mfma_f32_16x16x32_bf16 v[64:67], v[36:39], v[144:147], v[64:67]
    ds_read_b64_tr_b16 v[52:53], v9 offset:16384
    ds_read_b64_tr_b16 v[54:55], v9 offset:16640
    v_mfma_f32_16x16x32_bf16 v[64:67], v[40:43], v[152:155], v[64:67]
    ds_read_b64_tr_b16 v[56:57], v9 offset:24576
    ds_read_b64_tr_b16 v[58:59], v9 offset:24832
    s_waitcnt vmcnt(10)
    v_mfma_f32_16x16x32_bf16 v[68:71], v[28:31], v[132:135], 0
    s_add_u32 s59, s67, 4096
    buffer_load_dwordx4 v[184:187], v2, s[24:27], s59 offen offset:3072 sc1
    v_mfma_f32_16x16x32_bf16 v[68:71], v[32:35], v[140:143], v[68:71]
    v_mfma_f32_16x16x32_bf16 v[68:71], v[36:39], v[148:151], v[68:71]
    v_mfma_f32_16x16x32_bf16 v[68:71], v[40:43], v[156:159], v[68:71]
    v_mul_f32 v112, 0x3e0293ee, v112
    v_mul_f32 v113, 0x3e0293ee, v113
    v_cvt_pk_bf16_f32 v20, v112, v113
    v_mul_f32 v114, 0x3e0293ee, v114
    v_mul_f32 v115, 0x3e0293ee, v115
    v_cvt_pk_bf16_f32 v21, v114, v115
    s_waitcnt lgkmcnt(0)
    v_mfma_f32_16x16x32_bf16 v[72:75], v[44:47], v[128:131], 0
    ds_read_b64_tr_b16 v[28:29], v8 offset:1024
    ds_read_b64_tr_b16 v[30:31], v8 offset:1280
    v_mfma_f32_16x16x32_bf16 v[72:75], v[48:51], v[136:139], v[72:75]
    ds_read_b64_tr_b16 v[32:33], v8 offset:9216
    ds_read_b64_tr_b16 v[34:35], v8 offset:9472
    v_mul_f32 v116, 0x3e0293ee, v116
    v_mul_f32 v117, 0x3e0293ee, v117
    v_cvt_pk_bf16_f32 v22, v116, v117
    v_mul_f32 v118, 0x3e0293ee, v118
    v_mul_f32 v119, 0x3e0293ee, v119
    v_cvt_pk_bf16_f32 v23, v118, v119
    v_mfma_f32_16x16x32_bf16 v[72:75], v[52:55], v[144:147], v[72:75]
    ds_read_b64_tr_b16 v[36:37], v8 offset:17408
    ds_read_b64_tr_b16 v[38:39], v8 offset:17664
    v_mfma_f32_16x16x32_bf16 v[72:75], v[56:59], v[152:155], v[72:75]
    ds_read_b64_tr_b16 v[40:41], v8 offset:25600
    ds_read_b64_tr_b16 v[42:43], v8 offset:25856
    v_mul_f32 v120, 0x3e0293ee, v120
    v_mul_f32 v121, 0x3e0293ee, v121
    v_cvt_pk_bf16_f32 v24, v120, v121
    v_mul_f32 v122, 0x3e0293ee, v122
    v_mul_f32 v123, 0x3e0293ee, v123
    v_cvt_pk_bf16_f32 v25, v122, v123
    v_mfma_f32_16x16x32_bf16 v[76:79], v[44:47], v[132:135], 0
    s_add_u32 s59, s67, 20480
    buffer_load_dwordx4 v[180:183], v2, s[24:27], s59 offen offset:2048 sc1
    v_mfma_f32_16x16x32_bf16 v[76:79], v[48:51], v[140:143], v[76:79]
    v_mul_f32 v124, 0x3e0293ee, v124
    v_mul_f32 v125, 0x3e0293ee, v125
    v_cvt_pk_bf16_f32 v26, v124, v125
    v_mul_f32 v126, 0x3e0293ee, v126
    v_mul_f32 v127, 0x3e0293ee, v127
    v_cvt_pk_bf16_f32 v27, v126, v127
    s_add_u32 s60, s54, 57344
    buffer_store_dwordx4 v[20:23], v2, s[12:15], s60 offen offset:0 sc1
    v_mfma_f32_16x16x32_bf16 v[76:79], v[52:55], v[148:151], v[76:79]
    v_mfma_f32_16x16x32_bf16 v[76:79], v[56:59], v[156:159], v[76:79]
    s_waitcnt lgkmcnt(0)
    v_mfma_f32_16x16x32_bf16 v[80:83], v[28:31], v[128:131], 0
    ds_read_b64_tr_b16 v[44:45], v9 offset:1024
    ds_read_b64_tr_b16 v[46:47], v9 offset:1280
    v_mfma_f32_16x16x32_bf16 v[80:83], v[32:35], v[136:139], v[80:83]
    ds_read_b64_tr_b16 v[48:49], v9 offset:9216
    ds_read_b64_tr_b16 v[50:51], v9 offset:9472
    v_mfma_f32_16x16x32_bf16 v[80:83], v[36:39], v[144:147], v[80:83]
    ds_read_b64_tr_b16 v[52:53], v9 offset:17408
    ds_read_b64_tr_b16 v[54:55], v9 offset:17664
    v_mfma_f32_16x16x32_bf16 v[80:83], v[40:43], v[152:155], v[80:83]
    ds_read_b64_tr_b16 v[56:57], v9 offset:25600
    ds_read_b64_tr_b16 v[58:59], v9 offset:25856
    s_add_u32 s60, s54, 57344
    buffer_store_dwordx4 v[24:27], v2, s[12:15], s60 offen offset:1024 sc1
    v_mfma_f32_16x16x32_bf16 v[84:87], v[28:31], v[132:135], 0
    s_add_u32 s59, s67, 20480
    buffer_load_dwordx4 v[188:191], v2, s[24:27], s59 offen offset:3072 sc1
    v_mfma_f32_16x16x32_bf16 v[84:87], v[32:35], v[140:143], v[84:87]
    v_mfma_f32_16x16x32_bf16 v[84:87], v[36:39], v[148:151], v[84:87]
    v_mfma_f32_16x16x32_bf16 v[84:87], v[40:43], v[156:159], v[84:87]
    s_waitcnt lgkmcnt(0)
    v_mfma_f32_16x16x32_bf16 v[88:91], v[44:47], v[128:131], 0
    ds_read_b64_tr_b16 v[28:29], v8 offset:2048
    ds_read_b64_tr_b16 v[30:31], v8 offset:2304
    v_mfma_f32_16x16x32_bf16 v[88:91], v[48:51], v[136:139], v[88:91]
    ds_read_b64_tr_b16 v[32:33], v8 offset:10240
    ds_read_b64_tr_b16 v[34:35], v8 offset:10496
    v_mfma_f32_16x16x32_bf16 v[88:91], v[52:55], v[144:147], v[88:91]
    ds_read_b64_tr_b16 v[36:37], v8 offset:18432
    ds_read_b64_tr_b16 v[38:39], v8 offset:18688
    v_mfma_f32_16x16x32_bf16 v[88:91], v[56:59], v[152:155], v[88:91]
    ds_read_b64_tr_b16 v[40:41], v8 offset:26624
    ds_read_b64_tr_b16 v[42:43], v8 offset:26880
    v_mfma_f32_16x16x32_bf16 v[92:95], v[44:47], v[132:135], 0
    s_add_u32 s59, s67, 8192
    buffer_load_dwordx4 v[192:195], v2, s[24:27], s59 offen offset:0 sc1
    v_mfma_f32_16x16x32_bf16 v[92:95], v[48:51], v[140:143], v[92:95]
    v_mfma_f32_16x16x32_bf16 v[92:95], v[52:55], v[148:151], v[92:95]
    v_mfma_f32_16x16x32_bf16 v[92:95], v[56:59], v[156:159], v[92:95]
    s_waitcnt lgkmcnt(0)
    v_mfma_f32_16x16x32_bf16 v[96:99], v[28:31], v[128:131], 0
    ds_read_b64_tr_b16 v[44:45], v9 offset:2048
    ds_read_b64_tr_b16 v[46:47], v9 offset:2304
    v_mfma_f32_16x16x32_bf16 v[96:99], v[32:35], v[136:139], v[96:99]
    ds_read_b64_tr_b16 v[48:49], v9 offset:10240
    ds_read_b64_tr_b16 v[50:51], v9 offset:10496
    v_mfma_f32_16x16x32_bf16 v[96:99], v[36:39], v[144:147], v[96:99]
    ds_read_b64_tr_b16 v[52:53], v9 offset:18432
    ds_read_b64_tr_b16 v[54:55], v9 offset:18688
    v_mfma_f32_16x16x32_bf16 v[96:99], v[40:43], v[152:155], v[96:99]
    ds_read_b64_tr_b16 v[56:57], v9 offset:26624
    ds_read_b64_tr_b16 v[58:59], v9 offset:26880
    v_mfma_f32_16x16x32_bf16 v[100:103], v[28:31], v[132:135], 0
    s_add_u32 s59, s67, 8192
    buffer_load_dwordx4 v[200:203], v2, s[24:27], s59 offen offset:1024 sc1
    v_mfma_f32_16x16x32_bf16 v[100:103], v[32:35], v[140:143], v[100:103]
    v_mfma_f32_16x16x32_bf16 v[100:103], v[36:39], v[148:151], v[100:103]
    v_mfma_f32_16x16x32_bf16 v[100:103], v[40:43], v[156:159], v[100:103]
    s_waitcnt lgkmcnt(0)
    v_mfma_f32_16x16x32_bf16 v[104:107], v[44:47], v[128:131], 0
    ds_read_b64_tr_b16 v[28:29], v8 offset:3072
    ds_read_b64_tr_b16 v[30:31], v8 offset:3328
    v_mfma_f32_16x16x32_bf16 v[104:107], v[48:51], v[136:139], v[104:107]
    ds_read_b64_tr_b16 v[32:33], v8 offset:11264
    ds_read_b64_tr_b16 v[34:35], v8 offset:11520
    v_mfma_f32_16x16x32_bf16 v[104:107], v[52:55], v[144:147], v[104:107]
    ds_read_b64_tr_b16 v[36:37], v8 offset:19456
    ds_read_b64_tr_b16 v[38:39], v8 offset:19712
    v_mfma_f32_16x16x32_bf16 v[104:107], v[56:59], v[152:155], v[104:107]
    ds_read_b64_tr_b16 v[40:41], v8 offset:27648
    ds_read_b64_tr_b16 v[42:43], v8 offset:27904
    v_mfma_f32_16x16x32_bf16 v[108:111], v[44:47], v[132:135], 0
    s_add_u32 s59, s67, 24576
    buffer_load_dwordx4 v[196:199], v2, s[24:27], s59 offen offset:0 sc1
    v_mfma_f32_16x16x32_bf16 v[108:111], v[48:51], v[140:143], v[108:111]
    v_mfma_f32_16x16x32_bf16 v[108:111], v[52:55], v[148:151], v[108:111]
    v_mfma_f32_16x16x32_bf16 v[108:111], v[56:59], v[156:159], v[108:111]
    s_waitcnt lgkmcnt(0)
    v_mfma_f32_16x16x32_bf16 v[112:115], v[28:31], v[128:131], 0
    ds_read_b64_tr_b16 v[44:45], v9 offset:3072
    ds_read_b64_tr_b16 v[46:47], v9 offset:3328
    v_mfma_f32_16x16x32_bf16 v[112:115], v[32:35], v[136:139], v[112:115]
    ds_read_b64_tr_b16 v[48:49], v9 offset:11264
    ds_read_b64_tr_b16 v[50:51], v9 offset:11520
    v_mfma_f32_16x16x32_bf16 v[112:115], v[36:39], v[144:147], v[112:115]
    ds_read_b64_tr_b16 v[52:53], v9 offset:19456
    ds_read_b64_tr_b16 v[54:55], v9 offset:19712
    v_mfma_f32_16x16x32_bf16 v[112:115], v[40:43], v[152:155], v[112:115]
    ds_read_b64_tr_b16 v[56:57], v9 offset:27648
    ds_read_b64_tr_b16 v[58:59], v9 offset:27904
    v_mfma_f32_16x16x32_bf16 v[116:119], v[28:31], v[132:135], 0
    s_add_u32 s59, s67, 24576
    buffer_load_dwordx4 v[204:207], v2, s[24:27], s59 offen offset:1024 sc1
    v_mfma_f32_16x16x32_bf16 v[116:119], v[32:35], v[140:143], v[116:119]
    v_mfma_f32_16x16x32_bf16 v[116:119], v[36:39], v[148:151], v[116:119]
    v_mfma_f32_16x16x32_bf16 v[116:119], v[40:43], v[156:159], v[116:119]
    s_waitcnt vmcnt(5)
    s_barrier
    s_cmp_lg_u32 s40, 0
    s_cbranch_scc1 KFG_17
    s_lshl_b32 s63, s42, 2
    v_mov_b32 v60, s63
    v_mov_b32 v61, 2
    s_mov_b64 exec, 1
    buffer_store_dword v61, v60, s[24:27], s76 offen sc1
    s_mov_b64 exec, -1
KFG_17:
    s_waitcnt lgkmcnt(0)
    v_mfma_f32_16x16x32_bf16 v[120:123], v[44:47], v[128:131], 0
    ds_read_b64_tr_b16 v[28:29], v8 offset:32768
    ds_read_b64_tr_b16 v[30:31], v8 offset:33024
    v_mfma_f32_16x16x32_bf16 v[120:123], v[48:51], v[136:139], v[120:123]
    ds_read_b64_tr_b16 v[32:33], v8 offset:40960
    ds_read_b64_tr_b16 v[34:35], v8 offset:41216
    v_mfma_f32_16x16x32_bf16 v[120:123], v[52:55], v[144:147], v[120:123]
    ds_read_b64_tr_b16 v[36:37], v8 offset:49152
    ds_read_b64_tr_b16 v[38:39], v8 offset:49408
    v_mfma_f32_16x16x32_bf16 v[120:123], v[56:59], v[152:155], v[120:123]
    ds_read_b64_tr_b16 v[40:41], v8 offset:57344
    ds_read_b64_tr_b16 v[42:43], v8 offset:57600
    v_mfma_f32_16x16x32_bf16 v[124:127], v[44:47], v[132:135], 0
    s_add_u32 s59, s67, 8192
    buffer_load_dwordx4 v[208:211], v2, s[24:27], s59 offen offset:2048 sc1
    v_mfma_f32_16x16x32_bf16 v[124:127], v[48:51], v[140:143], v[124:127]
    v_mfma_f32_16x16x32_bf16 v[124:127], v[52:55], v[148:151], v[124:127]
    v_mfma_f32_16x16x32_bf16 v[124:127], v[56:59], v[156:159], v[124:127]
    s_waitcnt lgkmcnt(0)
    v_mfma_f32_16x16x32_bf16 v[64:67], v[28:31], v[160:163], v[64:67]
    ds_read_b64_tr_b16 v[44:45], v9 offset:32768
    ds_read_b64_tr_b16 v[46:47], v9 offset:33024
    v_mfma_f32_16x16x32_bf16 v[64:67], v[32:35], v[168:171], v[64:67]
    ds_read_b64_tr_b16 v[48:49], v9 offset:40960
    ds_read_b64_tr_b16 v[50:51], v9 offset:41216
    v_mfma_f32_16x16x32_bf16 v[64:67], v[36:39], v[176:179], v[64:67]
    ds_read_b64_tr_b16 v[52:53], v9 offset:49152
    ds_read_b64_tr_b16 v[54:55], v9 offset:49408
    v_mfma_f32_16x16x32_bf16 v[64:67], v[40:43], v[184:187], v[64:67]
    ds_read_b64_tr_b16 v[56:57], v9 offset:57344
    ds_read_b64_tr_b16 v[58:59], v9 offset:57600
    s_waitcnt vmcnt(5)
    v_mfma_f32_16x16x32_bf16 v[68:71], v[28:31], v[164:167], v[68:71]
    s_add_u32 s59, s67, 8192
    buffer_load_dwordx4 v[216:219], v2, s[24:27], s59 offen offset:3072 sc1
    v_mfma_f32_16x16x32_bf16 v[68:71], v[32:35], v[172:175], v[68:71]
    v_mfma_f32_16x16x32_bf16 v[68:71], v[36:39], v[180:183], v[68:71]
    v_mfma_f32_16x16x32_bf16 v[68:71], v[40:43], v[188:191], v[68:71]
    v_lshlrev_b32 v60, 2, v1
    s_lshl_b32 s59, s40, 8
    s_add_u32 s59, s59, 147456
    v_add_u32 v14, s59, v60
    s_lshl_b32 s59, s43, 8
    s_add_u32 s59, s59, 149504
    v_add_u32 v19, s59, v60
    v_add_u32 v21, 1024, v19
    v_and_b32 v60, 3, v1
    v_mul_u32_u24 v60, 260, v60
    v_add_u32 v12, 149504, v60
    v_add_u32 v22, 150528, v60
    v_and_b32 v60, 7, v1
    v_mul_u32_u24 v60, 260, v60
    v_add_u32 v17, 147456, v60
    v_mov_b32 v16, 0
    v_mov_b32 v20, 0
    ds_write_b32 v14, v16
    s_waitcnt lgkmcnt(1)
    v_mfma_f32_16x16x32_bf16 v[72:75], v[44:47], v[160:163], v[72:75]
    ds_read_b64_tr_b16 v[28:29], v8 offset:33792
    ds_read_b64_tr_b16 v[30:31], v8 offset:34048
    v_mfma_f32_16x16x32_bf16 v[72:75], v[48:51], v[168:171], v[72:75]
    ds_read_b64_tr_b16 v[32:33], v8 offset:41984
    ds_read_b64_tr_b16 v[34:35], v8 offset:42240
    v_mfma_f32_16x16x32_bf16 v[72:75], v[52:55], v[176:179], v[72:75]
    ds_read_b64_tr_b16 v[36:37], v8 offset:50176
    ds_read_b64_tr_b16 v[38:39], v8 offset:50432
    v_mfma_f32_16x16x32_bf16 v[72:75], v[56:59], v[184:187], v[72:75]
    ds_read_b64_tr_b16 v[40:41], v8 offset:58368
    ds_read_b64_tr_b16 v[42:43], v8 offset:58624
    v_mfma_f32_16x16x32_bf16 v[76:79], v[44:47], v[164:167], v[76:79]
    s_add_u32 s59, s67, 24576
    buffer_load_dwordx4 v[212:215], v2, s[24:27], s59 offen offset:2048 sc1
    v_mfma_f32_16x16x32_bf16 v[76:79], v[48:51], v[172:175], v[76:79]
    v_mfma_f32_16x16x32_bf16 v[76:79], v[52:55], v[180:183], v[76:79]
    v_mfma_f32_16x16x32_bf16 v[76:79], v[56:59], v[188:191], v[76:79]
    s_waitcnt lgkmcnt(0)
    v_mfma_f32_16x16x32_bf16 v[80:83], v[28:31], v[160:163], v[80:83]
    ds_read_b64_tr_b16 v[44:45], v9 offset:33792
    ds_read_b64_tr_b16 v[46:47], v9 offset:34048
    v_mfma_f32_16x16x32_bf16 v[80:83], v[32:35], v[168:171], v[80:83]
    ds_read_b64_tr_b16 v[48:49], v9 offset:41984
    ds_read_b64_tr_b16 v[50:51], v9 offset:42240
    v_mfma_f32_16x16x32_bf16 v[80:83], v[36:39], v[176:179], v[80:83]
    ds_read_b64_tr_b16 v[52:53], v9 offset:50176
    ds_read_b64_tr_b16 v[54:55], v9 offset:50432
    v_mfma_f32_16x16x32_bf16 v[80:83], v[40:43], v[184:187], v[80:83]
    ds_read_b64_tr_b16 v[56:57], v9 offset:58368
    ds_read_b64_tr_b16 v[58:59], v9 offset:58624
    v_mfma_f32_16x16x32_bf16 v[84:87], v[28:31], v[164:167], v[84:87]
    s_add_u32 s59, s67, 24576
    buffer_load_dwordx4 v[220:223], v2, s[24:27], s59 offen offset:3072 sc1
    v_mfma_f32_16x16x32_bf16 v[84:87], v[32:35], v[172:175], v[84:87]
    v_mfma_f32_16x16x32_bf16 v[84:87], v[36:39], v[180:183], v[84:87]
    v_mfma_f32_16x16x32_bf16 v[84:87], v[40:43], v[188:191], v[84:87]
    s_waitcnt lgkmcnt(0)
    v_mfma_f32_16x16x32_bf16 v[88:91], v[44:47], v[160:163], v[88:91]
    ds_read_b64_tr_b16 v[28:29], v8 offset:34816
    ds_read_b64_tr_b16 v[30:31], v8 offset:35072
    v_mfma_f32_16x16x32_bf16 v[88:91], v[48:51], v[168:171], v[88:91]
    ds_read_b64_tr_b16 v[32:33], v8 offset:43008
    ds_read_b64_tr_b16 v[34:35], v8 offset:43264
    v_mfma_f32_16x16x32_bf16 v[88:91], v[52:55], v[176:179], v[88:91]
    ds_read_b64_tr_b16 v[36:37], v8 offset:51200
    ds_read_b64_tr_b16 v[38:39], v8 offset:51456
    v_mfma_f32_16x16x32_bf16 v[88:91], v[56:59], v[184:187], v[88:91]
    ds_read_b64_tr_b16 v[40:41], v8 offset:59392
    ds_read_b64_tr_b16 v[42:43], v8 offset:59648
    v_mfma_f32_16x16x32_bf16 v[92:95], v[44:47], v[164:167], v[92:95]
    s_add_u32 s59, s67, 12288
    buffer_load_dwordx4 v[224:227], v2, s[24:27], s59 offen offset:0 sc1
    v_mfma_f32_16x16x32_bf16 v[92:95], v[48:51], v[172:175], v[92:95]
    v_mfma_f32_16x16x32_bf16 v[92:95], v[52:55], v[180:183], v[92:95]
    v_mfma_f32_16x16x32_bf16 v[92:95], v[56:59], v[188:191], v[92:95]
    s_waitcnt lgkmcnt(0)
    v_mfma_f32_16x16x32_bf16 v[96:99], v[28:31], v[160:163], v[96:99]
    ds_read_b64_tr_b16 v[44:45], v9 offset:34816
    ds_read_b64_tr_b16 v[46:47], v9 offset:35072
    v_mfma_f32_16x16x32_bf16 v[96:99], v[32:35], v[168:171], v[96:99]
    ds_read_b64_tr_b16 v[48:49], v9 offset:43008
    ds_read_b64_tr_b16 v[50:51], v9 offset:43264
    v_mfma_f32_16x16x32_bf16 v[96:99], v[36:39], v[176:179], v[96:99]
    ds_read_b64_tr_b16 v[52:53], v9 offset:51200
    ds_read_b64_tr_b16 v[54:55], v9 offset:51456
    v_mfma_f32_16x16x32_bf16 v[96:99], v[40:43], v[184:187], v[96:99]
    ds_read_b64_tr_b16 v[56:57], v9 offset:59392
    ds_read_b64_tr_b16 v[58:59], v9 offset:59648
    v_mfma_f32_16x16x32_bf16 v[100:103], v[28:31], v[164:167], v[100:103]
    s_add_u32 s59, s67, 12288
    buffer_load_dwordx4 v[232:235], v2, s[24:27], s59 offen offset:1024 sc1
    v_mfma_f32_16x16x32_bf16 v[100:103], v[32:35], v[172:175], v[100:103]
    v_mfma_f32_16x16x32_bf16 v[100:103], v[36:39], v[180:183], v[100:103]
    v_mfma_f32_16x16x32_bf16 v[100:103], v[40:43], v[188:191], v[100:103]
    s_waitcnt lgkmcnt(0)
    v_mfma_f32_16x16x32_bf16 v[104:107], v[44:47], v[160:163], v[104:107]
    ds_read_b64_tr_b16 v[28:29], v8 offset:35840
    ds_read_b64_tr_b16 v[30:31], v8 offset:36096
    v_mfma_f32_16x16x32_bf16 v[104:107], v[48:51], v[168:171], v[104:107]
    ds_read_b64_tr_b16 v[32:33], v8 offset:44032
    ds_read_b64_tr_b16 v[34:35], v8 offset:44288
    v_mfma_f32_16x16x32_bf16 v[104:107], v[52:55], v[176:179], v[104:107]
    ds_read_b64_tr_b16 v[36:37], v8 offset:52224
    ds_read_b64_tr_b16 v[38:39], v8 offset:52480
    v_mfma_f32_16x16x32_bf16 v[104:107], v[56:59], v[184:187], v[104:107]
    ds_read_b64_tr_b16 v[40:41], v8 offset:60416
    ds_read_b64_tr_b16 v[42:43], v8 offset:60672
    v_mfma_f32_16x16x32_bf16 v[108:111], v[44:47], v[164:167], v[108:111]
    s_add_u32 s59, s67, 28672
    buffer_load_dwordx4 v[228:231], v2, s[24:27], s59 offen offset:0 sc1
    v_mfma_f32_16x16x32_bf16 v[108:111], v[48:51], v[172:175], v[108:111]
    v_mfma_f32_16x16x32_bf16 v[108:111], v[52:55], v[180:183], v[108:111]
    v_mfma_f32_16x16x32_bf16 v[108:111], v[56:59], v[188:191], v[108:111]
    s_waitcnt lgkmcnt(0)
    v_mfma_f32_16x16x32_bf16 v[112:115], v[28:31], v[160:163], v[112:115]
    ds_read_b64_tr_b16 v[44:45], v9 offset:35840
    ds_read_b64_tr_b16 v[46:47], v9 offset:36096
    v_mfma_f32_16x16x32_bf16 v[112:115], v[32:35], v[168:171], v[112:115]
    ds_read_b64_tr_b16 v[48:49], v9 offset:44032
    ds_read_b64_tr_b16 v[50:51], v9 offset:44288
    v_mfma_f32_16x16x32_bf16 v[112:115], v[36:39], v[176:179], v[112:115]
    ds_read_b64_tr_b16 v[52:53], v9 offset:52224
    ds_read_b64_tr_b16 v[54:55], v9 offset:52480
    v_mfma_f32_16x16x32_bf16 v[112:115], v[40:43], v[184:187], v[112:115]
    ds_read_b64_tr_b16 v[56:57], v9 offset:60416
    ds_read_b64_tr_b16 v[58:59], v9 offset:60672
    v_mfma_f32_16x16x32_bf16 v[116:119], v[28:31], v[164:167], v[116:119]
    s_add_u32 s59, s67, 28672
    buffer_load_dwordx4 v[236:239], v2, s[24:27], s59 offen offset:1024 sc1
    v_mfma_f32_16x16x32_bf16 v[116:119], v[32:35], v[172:175], v[116:119]
    v_mfma_f32_16x16x32_bf16 v[116:119], v[36:39], v[180:183], v[116:119]
    v_mfma_f32_16x16x32_bf16 v[116:119], v[40:43], v[188:191], v[116:119]
    s_barrier
    s_waitcnt lgkmcnt(0)
    v_mfma_f32_16x16x32_bf16 v[120:123], v[44:47], v[160:163], v[120:123]
    ds_read_b64_tr_b16 v[28:29], v10 offset:0
    ds_read_b64_tr_b16 v[30:31], v10 offset:256
    v_mfma_f32_16x16x32_bf16 v[120:123], v[48:51], v[168:171], v[120:123]
    ds_read_b64_tr_b16 v[32:33], v10 offset:8192
    ds_read_b64_tr_b16 v[34:35], v10 offset:8448
    v_mfma_f32_16x16x32_bf16 v[120:123], v[52:55], v[176:179], v[120:123]
    ds_read_b64_tr_b16 v[36:37], v10 offset:16384
    ds_read_b64_tr_b16 v[38:39], v10 offset:16640
    v_mfma_f32_16x16x32_bf16 v[120:123], v[56:59], v[184:187], v[120:123]
    ds_read_b64_tr_b16 v[40:41], v10 offset:24576
    ds_read_b64_tr_b16 v[42:43], v10 offset:24832
    v_mfma_f32_16x16x32_bf16 v[124:127], v[44:47], v[164:167], v[124:127]
    s_add_u32 s59, s67, 12288
    buffer_load_dwordx4 v[240:243], v2, s[24:27], s59 offen offset:2048 sc1
    v_mfma_f32_16x16x32_bf16 v[124:127], v[48:51], v[172:175], v[124:127]
    v_mfma_f32_16x16x32_bf16 v[124:127], v[52:55], v[180:183], v[124:127]
    v_mfma_f32_16x16x32_bf16 v[124:127], v[56:59], v[188:191], v[124:127]
    s_waitcnt lgkmcnt(0)
    s_waitcnt vmcnt(7)
    v_mfma_f32_16x16x32_bf16 v[64:67], v[28:31], v[192:195], v[64:67]
    ds_read_b64_tr_b16 v[44:45], v11 offset:0
    ds_read_b64_tr_b16 v[46:47], v11 offset:256
    v_mfma_f32_16x16x32_bf16 v[64:67], v[32:35], v[200:203], v[64:67]
    ds_read_b64_tr_b16 v[48:49], v11 offset:8192
    ds_read_b64_tr_b16 v[50:51], v11 offset:8448
    v_mfma_f32_16x16x32_bf16 v[64:67], v[36:39], v[208:211], v[64:67]
    ds_read_b64_tr_b16 v[52:53], v11 offset:16384
    ds_read_b64_tr_b16 v[54:55], v11 offset:16640
    v_mfma_f32_16x16x32_bf16 v[64:67], v[40:43], v[216:219], v[64:67]
    ds_read_b64_tr_b16 v[56:57], v11 offset:24576
    ds_read_b64_tr_b16 v[58:59], v11 offset:24832
    s_waitcnt vmcnt(5)
    v_mfma_f32_16x16x32_bf16 v[68:71], v[28:31], v[196:199], v[68:71]
    s_add_u32 s59, s67, 12288
    buffer_load_dwordx4 v[248:251], v2, s[24:27], s59 offen offset:3072 sc1
    v_mfma_f32_16x16x32_bf16 v[68:71], v[32:35], v[204:207], v[68:71]
    v_mfma_f32_16x16x32_bf16 v[68:71], v[36:39], v[212:215], v[68:71]
    v_mfma_f32_16x16x32_bf16 v[68:71], v[40:43], v[220:223], v[68:71]
    s_waitcnt lgkmcnt(0)
    v_mfma_f32_16x16x32_bf16 v[72:75], v[44:47], v[192:195], v[72:75]
    ds_read_b64_tr_b16 v[28:29], v10 offset:1024
    ds_read_b64_tr_b16 v[30:31], v10 offset:1280
    v_mfma_f32_16x16x32_bf16 v[72:75], v[48:51], v[200:203], v[72:75]
    ds_read_b64_tr_b16 v[32:33], v10 offset:9216
    ds_read_b64_tr_b16 v[34:35], v10 offset:9472
    v_mfma_f32_16x16x32_bf16 v[72:75], v[52:55], v[208:211], v[72:75]
    ds_read_b64_tr_b16 v[36:37], v10 offset:17408
    ds_read_b64_tr_b16 v[38:39], v10 offset:17664
    v_mfma_f32_16x16x32_bf16 v[72:75], v[56:59], v[216:219], v[72:75]
    ds_read_b64_tr_b16 v[40:41], v10 offset:25600
    ds_read_b64_tr_b16 v[42:43], v10 offset:25856
    v_mfma_f32_16x16x32_bf16 v[76:79], v[44:47], v[196:199], v[76:79]
    s_add_u32 s59, s67, 28672
    buffer_load_dwordx4 v[244:247], v2, s[24:27], s59 offen offset:2048 sc1
    v_mfma_f32_16x16x32_bf16 v[76:79], v[48:51], v[204:207], v[76:79]
    v_mfma_f32_16x16x32_bf16 v[76:79], v[52:55], v[212:215], v[76:79]
    v_mfma_f32_16x16x32_bf16 v[76:79], v[56:59], v[220:223], v[76:79]
    s_waitcnt lgkmcnt(0)
    v_mfma_f32_16x16x32_bf16 v[80:83], v[28:31], v[192:195], v[80:83]
    ds_read_b64_tr_b16 v[44:45], v11 offset:1024
    ds_read_b64_tr_b16 v[46:47], v11 offset:1280
    v_mfma_f32_16x16x32_bf16 v[80:83], v[32:35], v[200:203], v[80:83]
    ds_read_b64_tr_b16 v[48:49], v11 offset:9216
    ds_read_b64_tr_b16 v[50:51], v11 offset:9472
    v_mfma_f32_16x16x32_bf16 v[80:83], v[36:39], v[208:211], v[80:83]
    ds_read_b64_tr_b16 v[52:53], v11 offset:17408
    ds_read_b64_tr_b16 v[54:55], v11 offset:17664
    v_mfma_f32_16x16x32_bf16 v[80:83], v[40:43], v[216:219], v[80:83]
    ds_read_b64_tr_b16 v[56:57], v11 offset:25600
    ds_read_b64_tr_b16 v[58:59], v11 offset:25856
    v_mfma_f32_16x16x32_bf16 v[84:87], v[28:31], v[196:199], v[84:87]
    s_add_u32 s59, s67, 28672
    buffer_load_dwordx4 v[252:255], v2, s[24:27], s59 offen offset:3072 sc1
    v_mfma_f32_16x16x32_bf16 v[84:87], v[32:35], v[204:207], v[84:87]
    v_mfma_f32_16x16x32_bf16 v[84:87], v[36:39], v[212:215], v[84:87]
    v_mfma_f32_16x16x32_bf16 v[84:87], v[40:43], v[220:223], v[84:87]
    s_waitcnt lgkmcnt(0)
    v_mfma_f32_16x16x32_bf16 v[88:91], v[44:47], v[192:195], v[88:91]
    ds_read_b64_tr_b16 v[28:29], v10 offset:2048
    ds_read_b64_tr_b16 v[30:31], v10 offset:2304
    v_mfma_f32_16x16x32_bf16 v[88:91], v[48:51], v[200:203], v[88:91]
    ds_read_b64_tr_b16 v[32:33], v10 offset:10240
    ds_read_b64_tr_b16 v[34:35], v10 offset:10496
    v_mfma_f32_16x16x32_bf16 v[88:91], v[52:55], v[208:211], v[88:91]
    ds_read_b64_tr_b16 v[36:37], v10 offset:18432
    ds_read_b64_tr_b16 v[38:39], v10 offset:18688
    v_mfma_f32_16x16x32_bf16 v[88:91], v[56:59], v[216:219], v[88:91]
    ds_read_b64_tr_b16 v[40:41], v10 offset:26624
    ds_read_b64_tr_b16 v[42:43], v10 offset:26880
    v_mfma_f32_16x16x32_bf16 v[92:95], v[44:47], v[196:199], v[92:95]
    v_mfma_f32_16x16x32_bf16 v[92:95], v[48:51], v[204:207], v[92:95]
    v_mfma_f32_16x16x32_bf16 v[92:95], v[52:55], v[212:215], v[92:95]
    v_mfma_f32_16x16x32_bf16 v[92:95], v[56:59], v[220:223], v[92:95]
    s_waitcnt lgkmcnt(0)
    v_mfma_f32_16x16x32_bf16 v[96:99], v[28:31], v[192:195], v[96:99]
    ds_read_b64_tr_b16 v[44:45], v11 offset:2048
    ds_read_b64_tr_b16 v[46:47], v11 offset:2304
    v_mfma_f32_16x16x32_bf16 v[96:99], v[32:35], v[200:203], v[96:99]
    ds_read_b64_tr_b16 v[48:49], v11 offset:10240
    ds_read_b64_tr_b16 v[50:51], v11 offset:10496
    v_mfma_f32_16x16x32_bf16 v[96:99], v[36:39], v[208:211], v[96:99]
    ds_read_b64_tr_b16 v[52:53], v11 offset:18432
    ds_read_b64_tr_b16 v[54:55], v11 offset:18688
    v_mfma_f32_16x16x32_bf16 v[96:99], v[40:43], v[216:219], v[96:99]
    ds_read_b64_tr_b16 v[56:57], v11 offset:26624
    ds_read_b64_tr_b16 v[58:59], v11 offset:26880
    v_mfma_f32_16x16x32_bf16 v[100:103], v[28:31], v[196:199], v[100:103]
    v_mfma_f32_16x16x32_bf16 v[100:103], v[32:35], v[204:207], v[100:103]
    v_mfma_f32_16x16x32_bf16 v[100:103], v[36:39], v[212:215], v[100:103]
    v_mfma_f32_16x16x32_bf16 v[100:103], v[40:43], v[220:223], v[100:103]
    s_waitcnt lgkmcnt(0)
    v_mfma_f32_16x16x32_bf16 v[104:107], v[44:47], v[192:195], v[104:107]
    ds_read_b64_tr_b16 v[28:29], v10 offset:3072
    ds_read_b64_tr_b16 v[30:31], v10 offset:3328
    v_mfma_f32_16x16x32_bf16 v[104:107], v[48:51], v[200:203], v[104:107]
    ds_read_b64_tr_b16 v[32:33], v10 offset:11264
    ds_read_b64_tr_b16 v[34:35], v10 offset:11520
    v_mfma_f32_16x16x32_bf16 v[104:107], v[52:55], v[208:211], v[104:107]
    ds_read_b64_tr_b16 v[36:37], v10 offset:19456
    ds_read_b64_tr_b16 v[38:39], v10 offset:19712
    v_mfma_f32_16x16x32_bf16 v[104:107], v[56:59], v[216:219], v[104:107]
    ds_read_b64_tr_b16 v[40:41], v10 offset:27648
    ds_read_b64_tr_b16 v[42:43], v10 offset:27904
    v_mfma_f32_16x16x32_bf16 v[108:111], v[44:47], v[196:199], v[108:111]
    v_mfma_f32_16x16x32_bf16 v[108:111], v[48:51], v[204:207], v[108:111]
    v_mfma_f32_16x16x32_bf16 v[108:111], v[52:55], v[212:215], v[108:111]
    v_mfma_f32_16x16x32_bf16 v[108:111], v[56:59], v[220:223], v[108:111]
    s_waitcnt lgkmcnt(0)
    v_mfma_f32_16x16x32_bf16 v[112:115], v[28:31], v[192:195], v[112:115]
    ds_read_b64_tr_b16 v[44:45], v11 offset:3072
    ds_read_b64_tr_b16 v[46:47], v11 offset:3328
    v_mfma_f32_16x16x32_bf16 v[112:115], v[32:35], v[200:203], v[112:115]
    ds_read_b64_tr_b16 v[48:49], v11 offset:11264
    ds_read_b64_tr_b16 v[50:51], v11 offset:11520
    v_mfma_f32_16x16x32_bf16 v[112:115], v[36:39], v[208:211], v[112:115]
    ds_read_b64_tr_b16 v[52:53], v11 offset:19456
    ds_read_b64_tr_b16 v[54:55], v11 offset:19712
    v_mfma_f32_16x16x32_bf16 v[112:115], v[40:43], v[216:219], v[112:115]
    ds_read_b64_tr_b16 v[56:57], v11 offset:27648
    ds_read_b64_tr_b16 v[58:59], v11 offset:27904
    v_mfma_f32_16x16x32_bf16 v[116:119], v[28:31], v[196:199], v[116:119]
    v_mfma_f32_16x16x32_bf16 v[116:119], v[32:35], v[204:207], v[116:119]
    v_mfma_f32_16x16x32_bf16 v[116:119], v[36:39], v[212:215], v[116:119]
    v_mfma_f32_16x16x32_bf16 v[116:119], v[40:43], v[220:223], v[116:119]
    s_waitcnt lgkmcnt(0)
    s_barrier
    v_mfma_f32_16x16x32_bf16 v[120:123], v[44:47], v[192:195], v[120:123]
    ds_read_b64_tr_b16 v[28:29], v10 offset:32768
    ds_read_b64_tr_b16 v[30:31], v10 offset:33024
    v_mfma_f32_16x16x32_bf16 v[120:123], v[48:51], v[200:203], v[120:123]
    ds_read_b64_tr_b16 v[32:33], v10 offset:40960
    ds_read_b64_tr_b16 v[34:35], v10 offset:41216
    v_mfma_f32_16x16x32_bf16 v[120:123], v[52:55], v[208:211], v[120:123]
    ds_read_b64_tr_b16 v[36:37], v10 offset:49152
    ds_read_b64_tr_b16 v[38:39], v10 offset:49408
    v_mfma_f32_16x16x32_bf16 v[120:123], v[56:59], v[216:219], v[120:123]
    ds_read_b64_tr_b16 v[40:41], v10 offset:57344
    ds_read_b64_tr_b16 v[42:43], v10 offset:57600
    v_mfma_f32_16x16x32_bf16 v[124:127], v[44:47], v[196:199], v[124:127]
    v_mfma_f32_16x16x32_bf16 v[124:127], v[48:51], v[204:207], v[124:127]
    v_mfma_f32_16x16x32_bf16 v[124:127], v[52:55], v[212:215], v[124:127]
    v_mfma_f32_16x16x32_bf16 v[124:127], v[56:59], v[220:223], v[124:127]
    s_waitcnt lgkmcnt(0)
    s_waitcnt vmcnt(2)
    v_mfma_f32_16x16x32_bf16 v[64:67], v[28:31], v[224:227], v[64:67]
    ds_read_b64_tr_b16 v[208:209], v11 offset:32768
    ds_read_b64_tr_b16 v[210:211], v11 offset:33024
    v_mfma_f32_16x16x32_bf16 v[64:67], v[32:35], v[232:235], v[64:67]
    ds_read_b64_tr_b16 v[212:213], v11 offset:40960
    ds_read_b64_tr_b16 v[214:215], v11 offset:41216
    v_mfma_f32_16x16x32_bf16 v[64:67], v[36:39], v[240:243], v[64:67]
    ds_read_b64_tr_b16 v[216:217], v11 offset:49152
    ds_read_b64_tr_b16 v[218:219], v11 offset:49408
    v_mfma_f32_16x16x32_bf16 v[64:67], v[40:43], v[248:251], v[64:67]
    ds_read_b64_tr_b16 v[220:221], v11 offset:57344
    ds_read_b64_tr_b16 v[222:223], v11 offset:57600
    s_waitcnt vmcnt(0)
    v_mfma_f32_16x16x32_bf16 v[68:71], v[28:31], v[228:231], v[68:71]
    v_mfma_f32_16x16x32_bf16 v[68:71], v[32:35], v[236:239], v[68:71]
    v_mfma_f32_16x16x32_bf16 v[68:71], v[36:39], v[244:247], v[68:71]
    v_mfma_f32_16x16x32_bf16 v[68:71], v[40:43], v[252:255], v[68:71]
    s_waitcnt lgkmcnt(0)
    v_mfma_f32_16x16x32_bf16 v[72:75], v[208:211], v[224:227], v[72:75]
    ds_read_b64_tr_b16 v[192:193], v10 offset:33792
    ds_read_b64_tr_b16 v[194:195], v10 offset:34048
    v_mfma_f32_16x16x32_bf16 v[72:75], v[212:215], v[232:235], v[72:75]
    ds_read_b64_tr_b16 v[196:197], v10 offset:41984
    ds_read_b64_tr_b16 v[198:199], v10 offset:42240
    v_mfma_f32_16x16x32_bf16 v[72:75], v[216:219], v[240:243], v[72:75]
    ds_read_b64_tr_b16 v[200:201], v10 offset:50176
    ds_read_b64_tr_b16 v[202:203], v10 offset:50432
    v_mfma_f32_16x16x32_bf16 v[72:75], v[220:223], v[248:251], v[72:75]
    ds_read_b64_tr_b16 v[204:205], v10 offset:58368
    ds_read_b64_tr_b16 v[206:207], v10 offset:58624
    v_mfma_f32_16x16x32_bf16 v[76:79], v[208:211], v[228:231], v[76:79]
    v_mfma_f32_16x16x32_bf16 v[76:79], v[212:215], v[236:239], v[76:79]
    v_mfma_f32_16x16x32_bf16 v[76:79], v[216:219], v[244:247], v[76:79]
    v_mfma_f32_16x16x32_bf16 v[76:79], v[220:223], v[252:255], v[76:79]
    s_waitcnt lgkmcnt(0)
    v_mfma_f32_16x16x32_bf16 v[80:83], v[192:195], v[224:227], v[80:83]
    ds_read_b64_tr_b16 v[208:209], v11 offset:33792
    ds_read_b64_tr_b16 v[210:211], v11 offset:34048
    v_mfma_f32_16x16x32_bf16 v[80:83], v[196:199], v[232:235], v[80:83]
    ds_read_b64_tr_b16 v[212:213], v11 offset:41984
    ds_read_b64_tr_b16 v[214:215], v11 offset:42240
    v_mfma_f32_16x16x32_bf16 v[80:83], v[200:203], v[240:243], v[80:83]
    ds_read_b64_tr_b16 v[216:217], v11 offset:50176
    ds_read_b64_tr_b16 v[218:219], v11 offset:50432
    v_mfma_f32_16x16x32_bf16 v[80:83], v[204:207], v[248:251], v[80:83]
    ds_read_b64_tr_b16 v[220:221], v11 offset:58368
    ds_read_b64_tr_b16 v[222:223], v11 offset:58624
    v_mfma_f32_16x16x32_bf16 v[84:87], v[192:195], v[228:231], v[84:87]
    v_cvt_pk_bf16_f32 v28, v64, v65
    v_mfma_f32_16x16x32_bf16 v[84:87], v[196:199], v[236:239], v[84:87]
    v_cvt_pk_bf16_f32 v29, v66, v67
    v_mfma_f32_16x16x32_bf16 v[84:87], v[200:203], v[244:247], v[84:87]
    v_cvt_pk_bf16_f32 v44, v68, v69
    v_mfma_f32_16x16x32_bf16 v[84:87], v[204:207], v[252:255], v[84:87]
    v_cvt_pk_bf16_f32 v45, v70, v71
    s_waitcnt lgkmcnt(0)
    v_mfma_f32_16x16x32_bf16 v[88:91], v[208:211], v[224:227], v[88:91]
    ds_read_b64_tr_b16 v[192:193], v10 offset:34816
    ds_read_b64_tr_b16 v[194:195], v10 offset:35072
    v_mfma_f32_16x16x32_bf16 v[88:91], v[212:215], v[232:235], v[88:91]
    ds_read_b64_tr_b16 v[196:197], v10 offset:43008
    ds_read_b64_tr_b16 v[198:199], v10 offset:43264
    v_mfma_f32_16x16x32_bf16 v[88:91], v[216:219], v[240:243], v[88:91]
    ds_read_b64_tr_b16 v[200:201], v10 offset:51200
    ds_read_b64_tr_b16 v[202:203], v10 offset:51456
    v_mfma_f32_16x16x32_bf16 v[88:91], v[220:223], v[248:251], v[88:91]
    ds_read_b64_tr_b16 v[204:205], v10 offset:59392
    ds_read_b64_tr_b16 v[206:207], v10 offset:59648
    v_mfma_f32_16x16x32_bf16 v[92:95], v[208:211], v[228:231], v[92:95]
    v_cvt_pk_bf16_f32 v30, v72, v73
    v_mfma_f32_16x16x32_bf16 v[92:95], v[212:215], v[236:239], v[92:95]
    v_cvt_pk_bf16_f32 v31, v74, v75
    v_mfma_f32_16x16x32_bf16 v[92:95], v[216:219], v[244:247], v[92:95]
    v_cvt_pk_bf16_f32 v46, v76, v77
    v_mfma_f32_16x16x32_bf16 v[92:95], v[220:223], v[252:255], v[92:95]
    v_cvt_pk_bf16_f32 v47, v78, v79
    s_waitcnt lgkmcnt(0)
    v_mfma_f32_16x16x32_bf16 v[96:99], v[192:195], v[224:227], v[96:99]
    ds_read_b64_tr_b16 v[208:209], v11 offset:34816
    ds_read_b64_tr_b16 v[210:211], v11 offset:35072
    v_mfma_f32_16x16x32_bf16 v[96:99], v[196:199], v[232:235], v[96:99]
    ds_read_b64_tr_b16 v[212:213], v11 offset:43008
    ds_read_b64_tr_b16 v[214:215], v11 offset:43264
    v_mfma_f32_16x16x32_bf16 v[96:99], v[200:203], v[240:243], v[96:99]
    ds_read_b64_tr_b16 v[216:217], v11 offset:51200
    ds_read_b64_tr_b16 v[218:219], v11 offset:51456
    v_mfma_f32_16x16x32_bf16 v[96:99], v[204:207], v[248:251], v[96:99]
    ds_read_b64_tr_b16 v[220:221], v11 offset:59392
    ds_read_b64_tr_b16 v[222:223], v11 offset:59648
    v_mfma_f32_16x16x32_bf16 v[100:103], v[192:195], v[228:231], v[100:103]
    v_cvt_pk_bf16_f32 v32, v80, v81
    ds_read_b128 v[160:163], v3 offset:0
    v_mfma_f32_16x16x32_bf16 v[100:103], v[196:199], v[236:239], v[100:103]
    v_cvt_pk_bf16_f32 v33, v82, v83
    ds_read_b128 v[164:167], v3 offset:2048
    v_mfma_f32_16x16x32_bf16 v[100:103], v[200:203], v[244:247], v[100:103]
    v_cvt_pk_bf16_f32 v48, v84, v85
    ds_read_b128 v[168:171], v3 offset:4096
    v_mfma_f32_16x16x32_bf16 v[100:103], v[204:207], v[252:255], v[100:103]
    v_cvt_pk_bf16_f32 v49, v86, v87
    ds_read_b128 v[172:175], v3 offset:6144
    s_waitcnt lgkmcnt(4)
    v_mfma_f32_16x16x32_bf16 v[104:107], v[208:211], v[224:227], v[104:107]
    ds_read_b64_tr_b16 v[192:193], v10 offset:35840
    ds_read_b64_tr_b16 v[194:195], v10 offset:36096
    v_mfma_f32_16x16x32_bf16 v[104:107], v[212:215], v[232:235], v[104:107]
    ds_read_b64_tr_b16 v[196:197], v10 offset:44032
    ds_read_b64_tr_b16 v[198:199], v10 offset:44288
    v_mfma_f32_16x16x32_bf16 v[104:107], v[216:219], v[240:243], v[104:107]
    ds_read_b64_tr_b16 v[200:201], v10 offset:52224
    ds_read_b64_tr_b16 v[202:203], v10 offset:52480
    v_mfma_f32_16x16x32_bf16 v[104:107], v[220:223], v[248:251], v[104:107]
    ds_read_b64_tr_b16 v[204:205], v10 offset:60416
    ds_read_b64_tr_b16 v[206:207], v10 offset:60672
    v_mfma_f32_16x16x32_bf16 v[108:111], v[208:211], v[228:231], v[108:111]
    v_cvt_pk_bf16_f32 v34, v88, v89
    ds_read_b128 v[176:179], v3 offset:1024
    v_mfma_f32_16x16x32_bf16 v[108:111], v[212:215], v[236:239], v[108:111]
    v_cvt_pk_bf16_f32 v35, v90, v91
    ds_read_b128 v[180:183], v3 offset:3072
    v_mfma_f32_16x16x32_bf16 v[108:111], v[216:219], v[244:247], v[108:111]
    v_cvt_pk_bf16_f32 v50, v92, v93
    ds_read_b128 v[184:187], v3 offset:5120
    v_mfma_f32_16x16x32_bf16 v[108:111], v[220:223], v[252:255], v[108:111]
    v_cvt_pk_bf16_f32 v51, v94, v95
    ds_read_b128 v[188:191], v3 offset:7168
    s_waitcnt lgkmcnt(4)
    v_mfma_f32_16x16x32_bf16 v[112:115], v[192:195], v[224:227], v[112:115]
    ds_read_b64_tr_b16 v[208:209], v11 offset:35840
    ds_read_b64_tr_b16 v[210:211], v11 offset:36096
    v_mfma_f32_16x16x32_bf16 v[112:115], v[196:199], v[232:235], v[112:115]
    ds_read_b64_tr_b16 v[212:213], v11 offset:44032
    ds_read_b64_tr_b16 v[214:215], v11 offset:44288
    v_mfma_f32_16x16x32_bf16 v[112:115], v[200:203], v[240:243], v[112:115]
    ds_read_b64_tr_b16 v[216:217], v11 offset:52224
    ds_read_b64_tr_b16 v[218:219], v11 offset:52480
    v_mfma_f32_16x16x32_bf16 v[112:115], v[204:207], v[248:251], v[112:115]
    ds_read_b64_tr_b16 v[220:221], v11 offset:60416
    ds_read_b64_tr_b16 v[222:223], v11 offset:60672
    v_mfma_f32_16x16x32_bf16 v[116:119], v[192:195], v[228:231], v[116:119]
    v_cvt_pk_bf16_f32 v36, v96, v97
    ds_read_b128 v[128:131], v3 offset:8192
    v_mfma_f32_16x16x32_bf16 v[116:119], v[196:199], v[236:239], v[116:119]
    v_cvt_pk_bf16_f32 v37, v98, v99
    ds_read_b128 v[132:135], v3 offset:10240
    v_mfma_f32_16x16x32_bf16 v[116:119], v[200:203], v[244:247], v[116:119]
    v_cvt_pk_bf16_f32 v52, v100, v101
    ds_read_b128 v[136:139], v3 offset:12288
    v_mfma_f32_16x16x32_bf16 v[116:119], v[204:207], v[252:255], v[116:119]
    v_cvt_pk_bf16_f32 v53, v102, v103
    ds_read_b128 v[140:143], v3 offset:14336
    s_waitcnt lgkmcnt(4)
    v_mfma_f32_16x16x32_bf16 v[120:123], v[208:211], v[224:227], v[120:123]
    v_mfma_f32_16x16x32_bf16 v[120:123], v[212:215], v[232:235], v[120:123]
    v_mfma_f32_16x16x32_bf16 v[120:123], v[216:219], v[240:243], v[120:123]
    v_mfma_f32_16x16x32_bf16 v[120:123], v[220:223], v[248:251], v[120:123]
    v_mfma_f32_16x16x32_bf16 v[124:127], v[208:211], v[228:231], v[124:127]
    v_cvt_pk_bf16_f32 v38, v104, v105
    ds_read_b128 v[144:147], v3 offset:9216
    v_mfma_f32_16x16x32_bf16 v[124:127], v[212:215], v[236:239], v[124:127]
    v_cvt_pk_bf16_f32 v39, v106, v107
    ds_read_b128 v[148:151], v3 offset:11264
    v_mfma_f32_16x16x32_bf16 v[124:127], v[216:219], v[244:247], v[124:127]
    v_cvt_pk_bf16_f32 v54, v108, v109
    ds_read_b128 v[152:155], v3 offset:13312
    v_mfma_f32_16x16x32_bf16 v[124:127], v[220:223], v[252:255], v[124:127]
    v_cvt_pk_bf16_f32 v55, v110, v111
    ds_read_b128 v[156:159], v3 offset:15360
    s_cmp_eq_u32 s43, 3
    s_cbranch_scc1 KFL_18
    s_cmp_eq_u32 s43, 0
    s_cselect_b32 s4, s92, s94
    s_cselect_b32 s5, s93, s95
    s_cmp_eq_u32 s43, 2
    s_cselect_b32 s4, s96, s4
    s_cselect_b32 s5, s97, s5
    s_and_b32 s5, s5, 0xffff
    s_mov_b32 s6, 0x1c0000
    s_mov_b32 s7, 0x00020000
    v_lshlrev_b32 v4, 7, v1
    s_mul_i32 s59, s2, 7168
    s_mov_b32 exec_hi, 0x00ffffff
    buffer_load_dword v15, v4, s[4:7], s59 offen
    s_mov_b64 exec, -1
    s_branch KFL_19
KFL_18:
    s_mov_b32 s4, s90
    s_and_b32 s5, s91, 0xffff
    s_mov_b32 s6, 0x400000
    s_mov_b32 s7, 0x00020000
    v_lshlrev_b32 v4, 7, v1
    s_and_b32 s59, s2, 7
    s_lshl_b32 s59, s59, 19
    s_lshr_b32 s60, s2, 3
    s_lshl_b32 s60, s60, 14
    s_add_u32 s59, s59, s60
    buffer_load_dword v15, v4, s[4:7], s59 offen
    s_add_u32 s59, s59, 8192
    buffer_load_dword v15, v4, s[4:7], s59 offen
KFL_19:
    v_mov_b32 v96, 0
    v_mov_b32 v97, 0
    v_mov_b32 v98, 0
    v_mov_b32 v99, 0
    v_mov_b32 v100, 0
    v_mov_b32 v101, 0
    v_mov_b32 v102, 0
    v_mov_b32 v103, 0
    v_mov_b32 v104, 0
    v_mov_b32 v105, 0
    v_mov_b32 v106, 0
    v_mov_b32 v107, 0
    v_mov_b32 v108, 0
    v_mov_b32 v109, 0
    v_mov_b32 v110, 0
    v_mov_b32 v111, 0
    v_mov_b32 v60, 0
    v_mov_b32 v61, 0
    v_mov_b32 v62, 0xf149f2ca
    v_cvt_pk_bf16_f32 v40, v112, v113
    v_cvt_pk_bf16_f32 v41, v114, v115
    v_cvt_pk_bf16_f32 v56, v116, v117
    v_cvt_pk_bf16_f32 v57, v118, v119
    v_cvt_pk_bf16_f32 v42, v120, v121
    v_cvt_pk_bf16_f32 v43, v122, v123
    v_cvt_pk_bf16_f32 v58, v124, v125
    v_cvt_pk_bf16_f32 v59, v126, v127
    s_cmp_lg_u32 s44, 0
    s_cbranch_scc1 KFL_20
    v_cndmask_b32 v96, v62, v60, s[78:79]
    v_cndmask_b32 v108, v62, v61, s[78:79]
    v_mov_b32 v100, v62
    v_cndmask_b32 v97, v62, v60, s[80:81]
    v_cndmask_b32 v109, v62, v61, s[80:81]
    v_mov_b32 v101, v62
    v_cndmask_b32 v98, v62, v60, s[82:83]
    v_cndmask_b32 v110, v62, v61, s[82:83]
    v_mov_b32 v102, v62
    v_cndmask_b32 v99, v62, v60, s[84:85]
    v_cndmask_b32 v111, v62, v61, s[84:85]
    v_mov_b32 v103, v62
KFL_20:
    s_waitcnt lgkmcnt(0)
    v_mov_b32 v16, 1
    ds_write_b32 v14, v16
    v_mfma_f32_16x16x32_bf16 v[64:67], v[160:163], v[28:31], v[96:99]
    v_mov_b32 v192, 0
    v_mov_b32 v193, 0
    v_mov_b32 v194, 0
    v_mfma_f32_16x16x32_bf16 v[64:67], v[164:167], v[32:35], v[64:67]
    v_mov_b32 v195, 0
    v_mov_b32 v196, 0
    v_mov_b32 v197, 0
    v_mfma_f32_16x16x32_bf16 v[64:67], v[168:171], v[36:39], v[64:67]
    v_mov_b32 v198, 0
    v_mov_b32 v199, 0
    v_mov_b32 v200, 0
    v_mfma_f32_16x16x32_bf16 v[64:67], v[172:175], v[40:43], v[64:67]
    v_mov_b32 v201, 0
    v_mov_b32 v202, 0
    v_mov_b32 v203, 0
    v_mfma_f32_16x16x32_bf16 v[72:75], v[160:163], v[44:47], v[104:107]
    v_mov_b32 v204, 0
    v_mov_b32 v205, 0
    v_mov_b32 v206, 0
    v_mfma_f32_16x16x32_bf16 v[72:75], v[164:167], v[48:51], v[72:75]
    v_mov_b32 v207, 0
    v_mov_b32 v208, 0
    v_mov_b32 v209, 0
    v_mfma_f32_16x16x32_bf16 v[72:75], v[168:171], v[52:55], v[72:75]
    v_mov_b32 v210, 0
    v_mov_b32 v211, 0
    v_mov_b32 v212, 0
    v_mfma_f32_16x16x32_bf16 v[72:75], v[172:175], v[56:59], v[72:75]
    v_mov_b32 v213, 0
    v_mov_b32 v214, 0
    v_mov_b32 v215, 0
    v_mfma_f32_16x16x32_bf16 v[68:71], v[176:179], v[28:31], v[100:103]
    v_mov_b32 v216, 0
    v_mov_b32 v217, 0
    v_mov_b32 v218, 0
    v_mfma_f32_16x16x32_bf16 v[68:71], v[180:183], v[32:35], v[68:71]
    v_mov_b32 v219, 0
    v_mov_b32 v220, 0
    v_mov_b32 v221, 0
    v_mfma_f32_16x16x32_bf16 v[68:71], v[184:187], v[36:39], v[68:71]
    v_mov_b32 v222, 0
    v_mov_b32 v223, 0
    v_mov_b32 v224, 0
    v_mfma_f32_16x16x32_bf16 v[68:71], v[188:191], v[40:43], v[68:71]
    v_mov_b32 v225, 0
    v_mov_b32 v226, 0
    v_mov_b32 v227, 0
    v_mfma_f32_16x16x32_bf16 v[76:79], v[176:179], v[44:47], v[108:111]
    v_mov_b32 v228, 0
    v_mov_b32 v229, 0
    v_mov_b32 v230, 0
    v_mfma_f32_16x16x32_bf16 v[76:79], v[180:183], v[48:51], v[76:79]
    v_mov_b32 v231, 0
    v_mov_b32 v232, 0
    v_mov_b32 v233, 0
    v_mfma_f32_16x16x32_bf16 v[76:79], v[184:187], v[52:55], v[76:79]
    v_mov_b32 v234, 0
    v_mov_b32 v235, 0
    v_mov_b32 v236, 0
    v_mfma_f32_16x16x32_bf16 v[76:79], v[188:191], v[56:59], v[76:79]
    v_mov_b32 v237, 0
    v_mov_b32 v238, 0
    v_mov_b32 v239, 0
    s_mov_b32 s47, 0
    s_mov_b32 s71, 0
    s_mov_b32 s70, 0x18000
    v_mov_b32 v240, 0
    v_mov_b32 v241, 0
    v_mov_b32 v242, 0
    v_mov_b32 v243, 0
    v_mov_b32 v244, 0
    v_mov_b32 v245, 0
    v_mov_b32 v246, 0
    v_mov_b32 v247, 0
    v_max3_f32 v60, v64, v65, v66
    v_max3_f32 v60, v60, v67, v68
    v_max3_f32 v60, v60, v69, v70
    v_max_f32 v60, v60, v71
    v_max3_f32 v61, v72, v73, v74
    v_max3_f32 v61, v61, v75, v76
    v_max3_f32 v61, v61, v77, v78
    v_max_f32 v61, v61, v79
    v_mov_b32 v10, v60
    v_mov_b32 v11, v61
    s_nop 1
    v_permlane16_swap_b32 v60, v10
    v_permlane16_swap_b32 v61, v11
    s_nop 0
    v_max_f32 v60, v60, v10
    v_max_f32 v61, v61, v11
    v_mov_b32 v10, v60
    v_mov_b32 v11, v61
    s_nop 1
    v_permlane32_swap_b32 v60, v10
    v_permlane32_swap_b32 v61, v11
    s_nop 0
    v_max_f32 v60, v60, v10
    v_max_f32 v61, v61, v11
    v_sub_f32 v60, 0, v60
    v_sub_f32 v61, 0, v61
    v_mov_b32 v96, v60
    v_add_f32 v64, v64, v60
    v_mov_b32 v97, v60
    v_add_f32 v65, v65, v60
    v_mov_b32 v98, v60
    v_add_f32 v66, v66, v60
    v_mov_b32 v99, v60
    v_add_f32 v67, v67, v60
    v_mov_b32 v100, v60
    v_add_f32 v68, v68, v60
    v_mov_b32 v101, v60
    v_add_f32 v69, v69, v60
    v_mov_b32 v102, v60
    v_add_f32 v70, v70, v60
    v_mov_b32 v103, v60
    v_add_f32 v71, v71, v60
    v_mov_b32 v104, v61
    v_add_f32 v72, v72, v61
    v_mov_b32 v105, v61
    v_add_f32 v73, v73, v61
    v_mov_b32 v106, v61
    v_add_f32 v74, v74, v61
    v_mov_b32 v107, v61
    v_add_f32 v75, v75, v61
    v_mov_b32 v108, v61
    v_add_f32 v76, v76, v61
    v_mov_b32 v109, v61
    v_add_f32 v77, v77, v61
    v_mov_b32 v110, v61
    v_add_f32 v78, v78, v61
    v_mov_b32 v111, v61
    v_add_f32 v79, v79, v61
    v_exp_f32 v64, v64
    v_exp_f32 v65, v65
    v_exp_f32 v66, v66
    v_exp_f32 v67, v67
    v_exp_f32 v68, v68
    v_exp_f32 v69, v69
    v_mov_b32 v248, 0
    v_mov_b32 v249, 0
    v_mov_b32 v250, 0
    v_mov_b32 v251, 0
    v_mov_b32 v252, 0
    v_mov_b32 v253, 0
    v_mov_b32 v254, 0
    v_mov_b32 v255, 0
    v_mov_b32 v112, 0
    v_mov_b32 v113, 0
    v_mov_b32 v114, 0
    v_mov_b32 v115, 0
    v_mov_b32 v116, 0
    v_mov_b32 v117, 0
    v_mov_b32 v118, 0
    v_mov_b32 v119, 0
    v_mov_b32 v120, 0x3f803f80
    v_mov_b32 v121, 0x3f803f80
    v_mov_b32 v122, 0x3f803f80
    v_mov_b32 v123, 0x3f803f80
    v_cvt_pk_bf16_f32 v64, v64, v65
    v_cvt_pk_bf16_f32 v65, v66, v67
    v_cvt_pk_bf16_f32 v66, v68, v69
    s_setprio 1
    s_mov_b32 s66, 0
KFN_21:
    ds_read_b32 v13, v12
    s_add_u32 s66, s66, 1
    s_cmp_gt_u32 s66, 200000
    s_waitcnt lgkmcnt(0)
    v_cmp_gt_u32 vcc, 1, v13
    s_cbranch_scc1 KFN_22
    s_cbranch_vccz KFN_22
    s_sleep 1
    s_branch KFN_21
KFN_22:
    s_cmp_eq_u32 s47, s45
    v_add_u32 v3, s71, v2
    s_cbranch_scc1 KF_B_TAIL
KF_B_BODY:
    v_mfma_f32_16x16x32_bf16 v[80:83], v[128:131], v[28:31], v[96:99]
    v_exp_f32 v70, v70
    v_mfma_f32_16x16x32_bf16 v[80:83], v[132:135], v[32:35], v[80:83]
    ds_read_b128 v[164:167], v3 offset:1024
    ds_read_b128 v[160:163], v3 offset:0
    v_mfma_f32_16x16x32_bf16 v[80:83], v[136:139], v[36:39], v[80:83]
    v_exp_f32 v71, v71
    v_mfma_f32_16x16x32_bf16 v[80:83], v[140:143], v[40:43], v[80:83]
    ds_read_b128 v[168:171], v3 offset:2048
    v_cvt_pk_bf16_f32 v67, v70, v71
    v_mfma_f32_16x16x32_bf16 v[88:91], v[128:131], v[44:47], v[104:107]
    v_exp_f32 v72, v72
    v_mfma_f32_16x16x32_bf16 v[88:91], v[132:135], v[48:51], v[88:91]
    ds_read_b128 v[176:179], v3 offset:4096
    ds_read_b128 v[172:175], v3 offset:3072
    v_mfma_f32_16x16x32_bf16 v[88:91], v[136:139], v[52:55], v[88:91]
    v_exp_f32 v73, v73
    v_mfma_f32_16x16x32_bf16 v[88:91], v[140:143], v[56:59], v[88:91]
    ds_read_b128 v[180:183], v3 offset:5120
    v_cvt_pk_bf16_f32 v72, v72, v73
    v_mfma_f32_16x16x32_bf16 v[84:87], v[144:147], v[28:31], v[100:103]
    v_exp_f32 v74, v74
    v_mfma_f32_16x16x32_bf16 v[84:87], v[148:151], v[32:35], v[84:87]
    ds_read_b128 v[188:191], v3 offset:7168
    ds_read_b128 v[184:187], v3 offset:6144
    v_mfma_f32_16x16x32_bf16 v[84:87], v[152:155], v[36:39], v[84:87]
    v_exp_f32 v75, v75
    v_mfma_f32_16x16x32_bf16 v[84:87], v[156:159], v[40:43], v[84:87]
    v_cvt_pk_bf16_f32 v73, v74, v75
    s_add_u32 s47, s47, 1
    v_mfma_f32_16x16x32_bf16 v[92:95], v[144:147], v[44:47], v[108:111]
    v_exp_f32 v76, v76
    v_mfma_f32_16x16x32_bf16 v[92:95], v[148:151], v[48:51], v[92:95]
    s_lshl_b32 s59, s47, 1
    s_cmp_eq_u32 s59, s44
    v_mfma_f32_16x16x32_bf16 v[92:95], v[152:155], v[52:55], v[92:95]
    v_exp_f32 v77, v77
    v_mfma_f32_16x16x32_bf16 v[92:95], v[156:159], v[56:59], v[92:95]
    v_cvt_pk_bf16_f32 v74, v76, v77
    s_waitcnt lgkmcnt(0)
    v_mfma_f32_16x16x32_bf16 v[192:195], v[160:163], v[64:67], v[192:195]
    v_exp_f32 v78, v78
    v_mfma_f32_16x16x32_bf16 v[196:199], v[164:167], v[64:67], v[196:199]
    ds_read_b128 v[132:135], v3 offset:18432
    ds_read_b128 v[128:131], v3 offset:16384
    v_mfma_f32_16x16x32_bf16 v[200:203], v[168:171], v[64:67], v[200:203]
    v_exp_f32 v79, v79
    v_mfma_f32_16x16x32_bf16 v[204:207], v[172:175], v[64:67], v[204:207]
    ds_read_b128 v[136:139], v3 offset:20480
    v_cvt_pk_bf16_f32 v75, v78, v79
    v_mfma_f32_16x16x32_bf16 v[208:211], v[176:179], v[64:67], v[208:211]
    v_exp_f32 v80, v80
    v_mfma_f32_16x16x32_bf16 v[212:215], v[180:183], v[64:67], v[212:215]
    ds_read_b128 v[144:147], v3 offset:17408
    ds_read_b128 v[140:143], v3 offset:22528
    v_mfma_f32_16x16x32_bf16 v[216:219], v[184:187], v[64:67], v[216:219]
    v_exp_f32 v81, v81
    v_mfma_f32_16x16x32_bf16 v[220:223], v[188:191], v[64:67], v[220:223]
    ds_read_b128 v[148:151], v3 offset:19456
    v_cvt_pk_bf16_f32 v80, v80, v81
    v_mfma_f32_16x16x32_bf16 v[112:115], v[120:123], v[64:67], v[112:115]
    v_exp_f32 v82, v82
    v_mfma_f32_16x16x32_bf16 v[224:227], v[160:163], v[72:75], v[224:227]
    ds_read_b128 v[156:159], v3 offset:23552
    ds_read_b128 v[152:155], v3 offset:21504
    v_mfma_f32_16x16x32_bf16 v[228:231], v[164:167], v[72:75], v[228:231]
    v_exp_f32 v83, v83
    v_mfma_f32_16x16x32_bf16 v[232:235], v[168:171], v[72:75], v[232:235]
    v_cvt_pk_bf16_f32 v81, v82, v83
    ds_read_b32 v13, v12
    v_mfma_f32_16x16x32_bf16 v[236:239], v[172:175], v[72:75], v[236:239]
    v_exp_f32 v84, v84
    v_mfma_f32_16x16x32_bf16 v[240:243], v[176:179], v[72:75], v[240:243]
    v_mfma_f32_16x16x32_bf16 v[244:247], v[180:183], v[72:75], v[244:247]
    v_exp_f32 v85, v85
    v_mfma_f32_16x16x32_bf16 v[248:251], v[184:187], v[72:75], v[248:251]
    v_cvt_pk_bf16_f32 v82, v84, v85
    v_mfma_f32_16x16x32_bf16 v[252:255], v[188:191], v[72:75], v[252:255]
    v_mfma_f32_16x16x32_bf16 v[116:119], v[120:123], v[72:75], v[116:119]
    s_waitcnt lgkmcnt(0)
    s_cbranch_scc1 KF_B_MSK
KF_B_MSKR:
    v_mfma_f32_16x16x32_bf16 v[64:67], v[128:131], v[28:31], v[96:99]
    v_exp_f32 v86, v86
    v_mfma_f32_16x16x32_bf16 v[64:67], v[132:135], v[32:35], v[64:67]
    ds_read_b128 v[164:167], v3 offset:9216
    ds_read_b128 v[160:163], v3 offset:8192
    v_mfma_f32_16x16x32_bf16 v[64:67], v[136:139], v[36:39], v[64:67]
    v_exp_f32 v87, v87
    v_mfma_f32_16x16x32_bf16 v[64:67], v[140:143], v[40:43], v[64:67]
    ds_read_b128 v[168:171], v3 offset:10240
    v_cvt_pk_bf16_f32 v83, v86, v87
    v_mfma_f32_16x16x32_bf16 v[72:75], v[128:131], v[44:47], v[104:107]
    v_exp_f32 v88, v88
    v_mfma_f32_16x16x32_bf16 v[72:75], v[132:135], v[48:51], v[72:75]
    ds_read_b128 v[176:179], v3 offset:12288
    ds_read_b128 v[172:175], v3 offset:11264
    v_mfma_f32_16x16x32_bf16 v[72:75], v[136:139], v[52:55], v[72:75]
    v_exp_f32 v89, v89
    v_mfma_f32_16x16x32_bf16 v[72:75], v[140:143], v[56:59], v[72:75]
    ds_read_b128 v[180:183], v3 offset:13312
    v_cvt_pk_bf16_f32 v88, v88, v89
    v_mfma_f32_16x16x32_bf16 v[68:71], v[144:147], v[28:31], v[100:103]
    v_exp_f32 v90, v90
    v_mfma_f32_16x16x32_bf16 v[68:71], v[148:151], v[32:35], v[68:71]
    ds_read_b128 v[188:191], v3 offset:15360
    ds_read_b128 v[184:187], v3 offset:14336
    v_mfma_f32_16x16x32_bf16 v[68:71], v[152:155], v[36:39], v[68:71]
    v_exp_f32 v91, v91
    v_mfma_f32_16x16x32_bf16 v[68:71], v[156:159], v[40:43], v[68:71]
    v_cvt_pk_bf16_f32 v89, v90, v91
    v_add_u32 v16, 1, v16
    v_mfma_f32_16x16x32_bf16 v[76:79], v[144:147], v[44:47], v[108:111]
    v_exp_f32 v92, v92
    v_mfma_f32_16x16x32_bf16 v[76:79], v[148:151], v[48:51], v[76:79]
    s_add_u32 s71, s71, 0x8000
    s_and_b32 s71, s71, 0x1ffff
    v_mfma_f32_16x16x32_bf16 v[76:79], v[152:155], v[52:55], v[76:79]
    v_exp_f32 v93, v93
    v_mfma_f32_16x16x32_bf16 v[76:79], v[156:159], v[56:59], v[76:79]
    v_cvt_pk_bf16_f32 v90, v92, v93
    s_waitcnt lgkmcnt(0)
    v_mfma_f32_16x16x32_bf16 v[192:195], v[160:163], v[80:83], v[192:195]
    v_exp_f32 v94, v94
    v_mfma_f32_16x16x32_bf16 v[196:199], v[164:167], v[80:83], v[196:199]
    ds_read_b128 v[132:135], v3 offset:26624
    ds_read_b128 v[128:131], v3 offset:24576
    v_mfma_f32_16x16x32_bf16 v[200:203], v[168:171], v[80:83], v[200:203]
    v_exp_f32 v95, v95
    v_mfma_f32_16x16x32_bf16 v[204:207], v[172:175], v[80:83], v[204:207]
    ds_read_b128 v[136:139], v3 offset:28672
    v_cvt_pk_bf16_f32 v91, v94, v95
    v_mfma_f32_16x16x32_bf16 v[208:211], v[176:179], v[80:83], v[208:211]
    v_exp_f32 v64, v64
    v_mfma_f32_16x16x32_bf16 v[212:215], v[180:183], v[80:83], v[212:215]
    ds_read_b128 v[144:147], v3 offset:25600
    ds_read_b128 v[140:143], v3 offset:30720
    v_mfma_f32_16x16x32_bf16 v[216:219], v[184:187], v[80:83], v[216:219]
    v_exp_f32 v65, v65
    v_mfma_f32_16x16x32_bf16 v[220:223], v[188:191], v[80:83], v[220:223]
    ds_read_b128 v[148:151], v3 offset:27648
    v_cvt_pk_bf16_f32 v64, v64, v65
    v_mfma_f32_16x16x32_bf16 v[112:115], v[120:123], v[80:83], v[112:115]
    v_exp_f32 v66, v66
    v_mfma_f32_16x16x32_bf16 v[224:227], v[160:163], v[88:91], v[224:227]
    ds_read_b128 v[156:159], v3 offset:31744
    ds_read_b128 v[152:155], v3 offset:29696
    v_mfma_f32_16x16x32_bf16 v[228:231], v[164:167], v[88:91], v[228:231]
    v_exp_f32 v67, v67
    v_mfma_f32_16x16x32_bf16 v[232:235], v[168:171], v[88:91], v[232:235]
    v_cvt_pk_bf16_f32 v65, v66, v67
    v_cmp_ge_u32 vcc, s47, v13
    v_mfma_f32_16x16x32_bf16 v[236:239], v[172:175], v[88:91], v[236:239]
    v_exp_f32 v68, v68
    v_mfma_f32_16x16x32_bf16 v[240:243], v[176:179], v[88:91], v[240:243]
    s_cmp_eq_u32 s47, s45
    s_cselect_b32 s59, 1, 0
    v_mfma_f32_16x16x32_bf16 v[244:247], v[180:183], v[88:91], v[244:247]
    v_exp_f32 v69, v69
    v_mfma_f32_16x16x32_bf16 v[248:251], v[184:187], v[88:91], v[248:251]
    v_cvt_pk_bf16_f32 v66, v68, v69
    v_add_u32 v3, s71, v2
    v_mfma_f32_16x16x32_bf16 v[252:255], v[188:191], v[88:91], v[252:255]
    s_or_b32 s59, s59, vcc_lo
    v_mfma_f32_16x16x32_bf16 v[116:119], v[120:123], v[88:91], v[116:119]
    s_waitcnt lgkmcnt(0)
    ds_write_b32 v14, v16
    s_cbranch_scc0 KF_B_BODY
    s_mov_b32 s66, 0
KFN_23:
    ds_read_b32 v13, v12
    s_add_u32 s66, s66, 1
    s_cmp_gt_u32 s66, 200000
    s_waitcnt lgkmcnt(0)
    v_cmp_ge_u32 vcc, s47, v13
    s_cbranch_scc1 KFN_24
    s_cbranch_vccz KFN_24
    s_sleep 1
    s_branch KFN_23
KFN_24:
    s_cmp_lg_u32 s47, s45
    s_cbranch_scc1 KF_B_BODY
KF_B_TAIL:
    s_bitcmp0_b32 s44, 0
    s_cbranch_scc1 KF_B_TEVEN
    v_cndmask_b32 v96, v62, v60, s[78:79]
    v_cndmask_b32 v108, v62, v61, s[78:79]
    v_mov_b32 v100, v62
    v_cndmask_b32 v97, v62, v60, s[80:81]
    v_cndmask_b32 v109, v62, v61, s[80:81]
    v_mov_b32 v101, v62
    v_cndmask_b32 v98, v62, v60, s[82:83]
    v_cndmask_b32 v110, v62, v61, s[82:83]
    v_mov_b32 v102, v62
    v_cndmask_b32 v99, v62, v60, s[84:85]
    v_cndmask_b32 v111, v62, v61, s[84:85]
    v_mov_b32 v103, v62
    s_nop 1
    v_mfma_f32_16x16x32_bf16 v[80:83], v[128:131], v[28:31], v[96:99]
    v_exp_f32 v70, v70
    v_mfma_f32_16x16x32_bf16 v[80:83], v[132:135], v[32:35], v[80:83]
    ds_read_b128 v[164:167], v3 offset:1024
    ds_read_b128 v[160:163], v3 offset:0
    v_mfma_f32_16x16x32_bf16 v[80:83], v[136:139], v[36:39], v[80:83]
    v_exp_f32 v71, v71
    v_mfma_f32_16x16x32_bf16 v[80:83], v[140:143], v[40:43], v[80:83]
    ds_read_b128 v[168:171], v3 offset:2048
    v_cvt_pk_bf16_f32 v67, v70, v71
    v_mfma_f32_16x16x32_bf16 v[88:91], v[128:131], v[44:47], v[104:107]
    v_exp_f32 v72, v72
    v_mfma_f32_16x16x32_bf16 v[88:91], v[132:135], v[48:51], v[88:91]
    ds_read_b128 v[176:179], v3 offset:4096
    ds_read_b128 v[172:175], v3 offset:3072
    v_mfma_f32_16x16x32_bf16 v[88:91], v[136:139], v[52:55], v[88:91]
    v_exp_f32 v73, v73
    v_mfma_f32_16x16x32_bf16 v[88:91], v[140:143], v[56:59], v[88:91]
    ds_read_b128 v[180:183], v3 offset:5120
    v_cvt_pk_bf16_f32 v72, v72, v73
    v_mfma_f32_16x16x32_bf16 v[84:87], v[144:147], v[28:31], v[100:103]
    v_exp_f32 v74, v74
    v_mfma_f32_16x16x32_bf16 v[84:87], v[148:151], v[32:35], v[84:87]
    ds_read_b128 v[188:191], v3 offset:7168
    ds_read_b128 v[184:187], v3 offset:6144
    v_mfma_f32_16x16x32_bf16 v[84:87], v[152:155], v[36:39], v[84:87]
    v_exp_f32 v75, v75
    v_mfma_f32_16x16x32_bf16 v[84:87], v[156:159], v[40:43], v[84:87]
    v_cvt_pk_bf16_f32 v73, v74, v75
    v_mfma_f32_16x16x32_bf16 v[92:95], v[144:147], v[44:47], v[108:111]
    v_exp_f32 v76, v76
    v_mfma_f32_16x16x32_bf16 v[92:95], v[148:151], v[48:51], v[92:95]
    v_mfma_f32_16x16x32_bf16 v[92:95], v[152:155], v[52:55], v[92:95]
    v_exp_f32 v77, v77
    v_mfma_f32_16x16x32_bf16 v[92:95], v[156:159], v[56:59], v[92:95]
    v_cvt_pk_bf16_f32 v74, v76, v77
    s_waitcnt lgkmcnt(0)
    v_mfma_f32_16x16x32_bf16 v[192:195], v[160:163], v[64:67], v[192:195]
    v_exp_f32 v78, v78
    v_mfma_f32_16x16x32_bf16 v[196:199], v[164:167], v[64:67], v[196:199]
    ds_read_b128 v[132:135], v3 offset:9216
    ds_read_b128 v[128:131], v3 offset:8192
    v_mfma_f32_16x16x32_bf16 v[200:203], v[168:171], v[64:67], v[200:203]
    v_exp_f32 v79, v79
    v_mfma_f32_16x16x32_bf16 v[204:207], v[172:175], v[64:67], v[204:207]
    ds_read_b128 v[136:139], v3 offset:10240
    v_cvt_pk_bf16_f32 v75, v78, v79
    v_mfma_f32_16x16x32_bf16 v[208:211], v[176:179], v[64:67], v[208:211]
    v_exp_f32 v80, v80
    v_mfma_f32_16x16x32_bf16 v[212:215], v[180:183], v[64:67], v[212:215]
    ds_read_b128 v[144:147], v3 offset:12288
    ds_read_b128 v[140:143], v3 offset:11264
    v_mfma_f32_16x16x32_bf16 v[216:219], v[184:187], v[64:67], v[216:219]
    v_exp_f32 v81, v81
    v_mfma_f32_16x16x32_bf16 v[220:223], v[188:191], v[64:67], v[220:223]
    ds_read_b128 v[148:151], v3 offset:13312
    v_cvt_pk_bf16_f32 v80, v80, v81
    v_mfma_f32_16x16x32_bf16 v[112:115], v[120:123], v[64:67], v[112:115]
    v_exp_f32 v82, v82
    v_mfma_f32_16x16x32_bf16 v[224:227], v[160:163], v[72:75], v[224:227]
    ds_read_b128 v[156:159], v3 offset:15360
    ds_read_b128 v[152:155], v3 offset:14336
    v_mfma_f32_16x16x32_bf16 v[228:231], v[164:167], v[72:75], v[228:231]
    v_exp_f32 v83, v83
    v_mfma_f32_16x16x32_bf16 v[232:235], v[168:171], v[72:75], v[232:235]
    v_cvt_pk_bf16_f32 v81, v82, v83
    v_mfma_f32_16x16x32_bf16 v[236:239], v[172:175], v[72:75], v[236:239]
    v_exp_f32 v84, v84
    v_mfma_f32_16x16x32_bf16 v[240:243], v[176:179], v[72:75], v[240:243]
    v_mfma_f32_16x16x32_bf16 v[244:247], v[180:183], v[72:75], v[244:247]
    v_exp_f32 v85, v85
    v_mfma_f32_16x16x32_bf16 v[248:251], v[184:187], v[72:75], v[248:251]
    v_cvt_pk_bf16_f32 v82, v84, v85
    v_mfma_f32_16x16x32_bf16 v[252:255], v[188:191], v[72:75], v[252:255]
    v_mfma_f32_16x16x32_bf16 v[116:119], v[120:123], v[72:75], v[116:119]
    s_waitcnt lgkmcnt(0)
    v_exp_f32 v86, v86
    v_exp_f32 v87, v87
    s_nop 0
    v_cvt_pk_bf16_f32 v83, v86, v87
    s_waitcnt lgkmcnt(0)
    v_mov_b32 v16, 0x7ffffff0
    ds_write_b32 v14, v16
    v_mfma_f32_16x16x32_bf16 v[192:195], v[128:131], v[80:83], v[192:195]
    v_exp_f32 v88, v88
    v_mfma_f32_16x16x32_bf16 v[196:199], v[132:135], v[80:83], v[196:199]
    v_exp_f32 v89, v89
    v_mfma_f32_16x16x32_bf16 v[200:203], v[136:139], v[80:83], v[200:203]
    v_exp_f32 v90, v90
    v_cvt_pk_bf16_f32 v88, v88, v89
    v_mfma_f32_16x16x32_bf16 v[204:207], v[140:143], v[80:83], v[204:207]
    v_exp_f32 v91, v91
    v_mfma_f32_16x16x32_bf16 v[208:211], v[144:147], v[80:83], v[208:211]
    v_exp_f32 v92, v92
    v_cvt_pk_bf16_f32 v89, v90, v91
    v_mfma_f32_16x16x32_bf16 v[212:215], v[148:151], v[80:83], v[212:215]
    v_exp_f32 v93, v93
    v_mfma_f32_16x16x32_bf16 v[216:219], v[152:155], v[80:83], v[216:219]
    v_exp_f32 v94, v94
    v_cvt_pk_bf16_f32 v90, v92, v93
    v_mfma_f32_16x16x32_bf16 v[220:223], v[156:159], v[80:83], v[220:223]
    v_exp_f32 v95, v95
    v_mfma_f32_16x16x32_bf16 v[112:115], v[120:123], v[80:83], v[112:115]
    v_cvt_pk_bf16_f32 v91, v94, v95
    s_nop 1
    v_mfma_f32_16x16x32_bf16 v[224:227], v[128:131], v[88:91], v[224:227]
    v_mfma_f32_16x16x32_bf16 v[228:231], v[132:135], v[88:91], v[228:231]
    v_mfma_f32_16x16x32_bf16 v[232:235], v[136:139], v[88:91], v[232:235]
    v_mfma_f32_16x16x32_bf16 v[236:239], v[140:143], v[88:91], v[236:239]
    v_mfma_f32_16x16x32_bf16 v[240:243], v[144:147], v[88:91], v[240:243]
    v_mfma_f32_16x16x32_bf16 v[244:247], v[148:151], v[88:91], v[244:247]
    v_mfma_f32_16x16x32_bf16 v[248:251], v[152:155], v[88:91], v[248:251]
    v_mfma_f32_16x16x32_bf16 v[252:255], v[156:159], v[88:91], v[252:255]
    v_mfma_f32_16x16x32_bf16 v[116:119], v[120:123], v[88:91], v[116:119]
    s_branch KF_B_EPI
KF_B_MSK:
    v_cndmask_b32 v96, v62, v60, s[78:79]
    v_cndmask_b32 v108, v62, v61, s[78:79]
    v_mov_b32 v100, v62
    v_cndmask_b32 v97, v62, v60, s[80:81]
    v_cndmask_b32 v109, v62, v61, s[80:81]
    v_mov_b32 v101, v62
    v_cndmask_b32 v98, v62, v60, s[82:83]
    v_cndmask_b32 v110, v62, v61, s[82:83]
    v_mov_b32 v102, v62
    v_cndmask_b32 v99, v62, v60, s[84:85]
    v_cndmask_b32 v111, v62, v61, s[84:85]
    v_mov_b32 v103, v62
    s_nop 0
    s_branch KF_B_MSKR
KF_B_TEVEN:
    ds_read_b128 v[160:163], v3 offset:0
    ds_read_b128 v[164:167], v3 offset:1024
    ds_read_b128 v[168:171], v3 offset:2048
    ds_read_b128 v[172:175], v3 offset:3072
    ds_read_b128 v[176:179], v3 offset:4096
    ds_read_b128 v[180:183], v3 offset:5120
    ds_read_b128 v[184:187], v3 offset:6144
    ds_read_b128 v[188:191], v3 offset:7168
    v_exp_f32 v70, v70
    v_exp_f32 v71, v71
    s_nop 0
    v_cvt_pk_bf16_f32 v67, v70, v71
    s_waitcnt lgkmcnt(0)
    v_mov_b32 v16, 0x7ffffff0
    ds_write_b32 v14, v16
    v_mfma_f32_16x16x32_bf16 v[192:195], v[160:163], v[64:67], v[192:195]
    v_exp_f32 v72, v72
    v_mfma_f32_16x16x32_bf16 v[196:199], v[164:167], v[64:67], v[196:199]
    v_exp_f32 v73, v73
    v_mfma_f32_16x16x32_bf16 v[200:203], v[168:171], v[64:67], v[200:203]
    v_exp_f32 v74, v74
    v_cvt_pk_bf16_f32 v72, v72, v73
    v_mfma_f32_16x16x32_bf16 v[204:207], v[172:175], v[64:67], v[204:207]
    v_exp_f32 v75, v75
    v_mfma_f32_16x16x32_bf16 v[208:211], v[176:179], v[64:67], v[208:211]
    v_exp_f32 v76, v76
    v_cvt_pk_bf16_f32 v73, v74, v75
    v_mfma_f32_16x16x32_bf16 v[212:215], v[180:183], v[64:67], v[212:215]
    v_exp_f32 v77, v77
    v_mfma_f32_16x16x32_bf16 v[216:219], v[184:187], v[64:67], v[216:219]
    v_exp_f32 v78, v78
    v_cvt_pk_bf16_f32 v74, v76, v77
    v_mfma_f32_16x16x32_bf16 v[220:223], v[188:191], v[64:67], v[220:223]
    v_exp_f32 v79, v79
    v_mfma_f32_16x16x32_bf16 v[112:115], v[120:123], v[64:67], v[112:115]
    v_cvt_pk_bf16_f32 v75, v78, v79
    s_nop 1
    v_mfma_f32_16x16x32_bf16 v[224:227], v[160:163], v[72:75], v[224:227]
    v_mfma_f32_16x16x32_bf16 v[228:231], v[164:167], v[72:75], v[228:231]
    v_mfma_f32_16x16x32_bf16 v[232:235], v[168:171], v[72:75], v[232:235]
    v_mfma_f32_16x16x32_bf16 v[236:239], v[172:175], v[72:75], v[236:239]
    v_mfma_f32_16x16x32_bf16 v[240:243], v[176:179], v[72:75], v[240:243]
    v_mfma_f32_16x16x32_bf16 v[244:247], v[180:183], v[72:75], v[244:247]
    v_mfma_f32_16x16x32_bf16 v[248:251], v[184:187], v[72:75], v[248:251]
    v_mfma_f32_16x16x32_bf16 v[252:255], v[188:191], v[72:75], v[252:255]
    v_mfma_f32_16x16x32_bf16 v[116:119], v[120:123], v[72:75], v[116:119]
KF_B_EPI:
    s_nop 7
    v_maximum3_f32 v10, |v192|, |v193|, |v194|
    v_maximum3_f32 v11, |v195|, |v196|, |v197|
    v_maximum3_f32 v10, v10, |v198|, |v199|
    v_maximum3_f32 v11, v11, |v200|, |v201|
    v_maximum3_f32 v10, v10, |v202|, |v203|
    v_maximum3_f32 v11, v11, |v204|, |v205|
    v_maximum3_f32 v10, v10, |v206|, |v207|
    v_maximum3_f32 v11, v11, |v208|, |v209|
    v_maximum3_f32 v10, v10, |v210|, |v211|
    v_maximum3_f32 v11, v11, |v212|, |v213|
    v_maximum3_f32 v10, v10, |v214|, |v215|
    v_maximum3_f32 v11, v11, |v216|, |v217|
    v_maximum3_f32 v10, v10, |v218|, |v219|
    v_maximum3_f32 v11, v11, |v220|, |v221|
    v_maximum3_f32 v10, v10, |v222|, |v223|
    v_maximum3_f32 v11, v11, |v224|, |v225|
    v_maximum3_f32 v10, v10, |v226|, |v227|
    v_maximum3_f32 v11, v11, |v228|, |v229|
    v_maximum3_f32 v10, v10, |v230|, |v231|
    v_maximum3_f32 v11, v11, |v232|, |v233|
    v_maximum3_f32 v10, v10, |v234|, |v235|
    v_maximum3_f32 v11, v11, |v236|, |v237|
    v_maximum3_f32 v10, v10, |v238|, |v239|
    v_maximum3_f32 v11, v11, |v240|, |v241|
    v_maximum3_f32 v10, v10, |v242|, |v243|
    v_maximum3_f32 v11, v11, |v244|, |v245|
    v_maximum3_f32 v10, v10, |v246|, |v247|
    v_maximum3_f32 v11, v11, |v248|, |v249|
    v_maximum3_f32 v10, v10, |v250|, |v251|
    v_maximum3_f32 v11, v11, |v252|, |v253|
    v_maximum3_f32 v10, v10, |v254|, |v255|
    v_maximum3_f32 v10, v10, v11, v11
    v_maximum3_f32 v11, v112, v116, v116
    v_mov_b32 v4, 0x7f7fffff
    v_mov_b32 v5, 0x5f800000
    v_cmp_nle_f32 vcc, v10, v4
    v_cmp_nle_f32 s[62:63], v11, v5
    s_nop 0
    s_or_b64 vcc, vcc, s[62:63]
    s_cselect_b32 s72, 1, 0
    s_cbranch_scc1 KF_FB
    v_rcp_f32 v10, v112
    v_rcp_f32 v11, v116
    s_lshr_b32 s59, s44, 2
    s_lshl_b32 s59, s59, 20
    s_lshl_b32 s60, s41, 15
    s_add_u32 s59, s59, s60
    s_and_b32 s60, s44, 3
    s_lshl_b32 s60, s60, 11
    s_add_u32 s59, s59, s60
    v_mul_f32 v192, v192, v10
    v_mul_f32 v193, v193, v10
    v_mul_f32 v194, v194, v10
    v_mul_f32 v195, v195, v10
    v_mul_f32 v196, v196, v10
    v_mul_f32 v197, v197, v10
    v_mul_f32 v198, v198, v10
    v_mul_f32 v199, v199, v10
    v_cvt_pk_bf16_f32 v192, v192, v193
    v_cvt_pk_bf16_f32 v193, v194, v195
    v_cvt_pk_bf16_f32 v194, v196, v197
    v_cvt_pk_bf16_f32 v195, v198, v199
    buffer_store_dwordx4 v[192:195], v2, s[20:23], s59 offen offset:0 sc1
    v_mul_f32 v224, v224, v11
    v_mul_f32 v225, v225, v11
    v_mul_f32 v226, v226, v11
    v_mul_f32 v227, v227, v11
    v_mul_f32 v228, v228, v11
    v_mul_f32 v229, v229, v11
    v_mul_f32 v230, v230, v11
    v_mul_f32 v231, v231, v11
    v_cvt_pk_bf16_f32 v224, v224, v225
    v_cvt_pk_bf16_f32 v225, v226, v227
    v_cvt_pk_bf16_f32 v226, v228, v229
    v_cvt_pk_bf16_f32 v227, v230, v231
    buffer_store_dwordx4 v[224:227], v2, s[20:23], s59 offen offset:1024 sc1
    s_add_u32 s59, s59, 8192
    v_mul_f32 v200, v200, v10
    v_mul_f32 v201, v201, v10
    v_mul_f32 v202, v202, v10
    v_mul_f32 v203, v203, v10
    v_mul_f32 v204, v204, v10
    v_mul_f32 v205, v205, v10
    v_mul_f32 v206, v206, v10
    v_mul_f32 v207, v207, v10
    v_cvt_pk_bf16_f32 v200, v200, v201
    v_cvt_pk_bf16_f32 v201, v202, v203
    v_cvt_pk_bf16_f32 v202, v204, v205
    v_cvt_pk_bf16_f32 v203, v206, v207
    buffer_store_dwordx4 v[200:203], v2, s[20:23], s59 offen offset:0 sc1
    v_mul_f32 v232, v232, v11
    v_mul_f32 v233, v233, v11
    v_mul_f32 v234, v234, v11
    v_mul_f32 v235, v235, v11
    v_mul_f32 v236, v236, v11
    v_mul_f32 v237, v237, v11
    v_mul_f32 v238, v238, v11
    v_mul_f32 v239, v239, v11
    v_cvt_pk_bf16_f32 v232, v232, v233
    v_cvt_pk_bf16_f32 v233, v234, v235
    v_cvt_pk_bf16_f32 v234, v236, v237
    v_cvt_pk_bf16_f32 v235, v238, v239
    buffer_store_dwordx4 v[232:235], v2, s[20:23], s59 offen offset:1024 sc1
    s_add_u32 s59, s59, 8192
    v_mul_f32 v208, v208, v10
    v_mul_f32 v209, v209, v10
    v_mul_f32 v210, v210, v10
    v_mul_f32 v211, v211, v10
    v_mul_f32 v212, v212, v10
    v_mul_f32 v213, v213, v10
    v_mul_f32 v214, v214, v10
    v_mul_f32 v215, v215, v10
    v_cvt_pk_bf16_f32 v208, v208, v209
    v_cvt_pk_bf16_f32 v209, v210, v211
    v_cvt_pk_bf16_f32 v210, v212, v213
    v_cvt_pk_bf16_f32 v211, v214, v215
    buffer_store_dwordx4 v[208:211], v2, s[20:23], s59 offen offset:0 sc1
    v_mul_f32 v240, v240, v11
    v_mul_f32 v241, v241, v11
    v_mul_f32 v242, v242, v11
    v_mul_f32 v243, v243, v11
    v_mul_f32 v244, v244, v11
    v_mul_f32 v245, v245, v11
    v_mul_f32 v246, v246, v11
    v_mul_f32 v247, v247, v11
    v_cvt_pk_bf16_f32 v240, v240, v241
    v_cvt_pk_bf16_f32 v241, v242, v243
    v_cvt_pk_bf16_f32 v242, v244, v245
    v_cvt_pk_bf16_f32 v243, v246, v247
    buffer_store_dwordx4 v[240:243], v2, s[20:23], s59 offen offset:1024 sc1
    s_add_u32 s59, s59, 8192
    v_mul_f32 v216, v216, v10
    v_mul_f32 v217, v217, v10
    v_mul_f32 v218, v218, v10
    v_mul_f32 v219, v219, v10
    v_mul_f32 v220, v220, v10
    v_mul_f32 v221, v221, v10
    v_mul_f32 v222, v222, v10
    v_mul_f32 v223, v223, v10
    v_cvt_pk_bf16_f32 v216, v216, v217
    v_cvt_pk_bf16_f32 v217, v218, v219
    v_cvt_pk_bf16_f32 v218, v220, v221
    v_cvt_pk_bf16_f32 v219, v222, v223
    buffer_store_dwordx4 v[216:219], v2, s[20:23], s59 offen offset:0 sc1
    v_mul_f32 v248, v248, v11
    v_mul_f32 v249, v249, v11
    v_mul_f32 v250, v250, v11
    v_mul_f32 v251, v251, v11
    v_mul_f32 v252, v252, v11
    v_mul_f32 v253, v253, v11
    v_mul_f32 v254, v254, v11
    v_mul_f32 v255, v255, v11
    v_cvt_pk_bf16_f32 v248, v248, v249
    v_cvt_pk_bf16_f32 v249, v250, v251
    v_cvt_pk_bf16_f32 v250, v252, v253
    v_cvt_pk_bf16_f32 v251, v254, v255
    buffer_store_dwordx4 v[248:251], v2, s[20:23], s59 offen offset:1024 sc1
    s_branch KF_D
KFS_14:
    s_mov_b32 s64, 0
KFL_25:
    s_sleep 8
    v_mov_b32 v63, 0
    buffer_load_dword v63, v63, s[36:39], 0 offen sc1
    s_add_u32 s64, s64, 1
    s_cmp_gt_u32 s64, 100000
    s_waitcnt vmcnt(0)
    s_cbranch_scc1 KFR_15
    v_cmp_gt_u32 vcc, 0x100, v63
    s_nop 0
    s_cmp_eq_u32 vcc_lo, 0
    s_cbranch_scc0 KFL_25
    s_branch KFR_15
KF_A:
    s_waitcnt vmcnt(6)
    s_barrier
    ds_read_b128 v[240:243], v60 offset:16384
    ds_read_b64_tr_b16 v[128:129], v8 offset:32768
    ds_read_b64_tr_b16 v[130:131], v8 offset:33024
    ds_read_b64_tr_b16 v[132:133], v8 offset:32800
    ds_read_b64_tr_b16 v[134:135], v8 offset:33056
    ds_read_b64_tr_b16 v[136:137], v8 offset:34816
    ds_read_b64_tr_b16 v[138:139], v8 offset:35072
    ds_read_b64_tr_b16 v[140:141], v8 offset:34848
    ds_read_b64_tr_b16 v[142:143], v8 offset:35104
    ds_read_b128 v[28:31], v6 offset:32768
    ds_read_b128 v[32:35], v7 offset:32768
    ds_read_b128 v[36:39], v6 offset:34816
    ds_read_b128 v[40:43], v7 offset:34816
    ds_read_b128 v[44:47], v6 offset:36864
    ds_read_b128 v[48:51], v7 offset:36864
    s_waitcnt lgkmcnt(14)
    buffer_store_dwordx4 v[240:243], v10, s[24:27], s57 offen sc1
    ds_read_b128 v[52:55], v6 offset:38912
    ds_read_b128 v[56:59], v7 offset:38912
    s_waitcnt lgkmcnt(4)
    v_mfma_f32_16x16x32_bf16 v[64:67], v[28:31], v[128:131], 0
    v_mfma_f32_16x16x32_bf16 v[64:67], v[32:35], v[136:139], v[64:67]
    s_add_u32 m0, s48, 0
    s_add_u32 s59, s53, 1048576
    buffer_load_dwordx4 v5, s[8:11], s59 offen lds
    v_mov_b32 v248, 0
    v_lshlrev_b32 v250, 16, v232
    v_lshlrev_b32 v251, 16, v236
    v_fmac_f32 v248, v250, v251
    v_and_b32 v250, 0xffff0000, v232
    v_mfma_f32_16x16x32_bf16 v[72:75], v[28:31], v[132:135], 0
    ds_read_b128 v[28:31], v6 offset:40960
    v_mfma_f32_16x16x32_bf16 v[72:75], v[32:35], v[140:143], v[72:75]
    ds_read_b128 v[32:35], v7 offset:40960
    s_add_u32 m0, s48, 1024
    s_add_u32 s59, s53, 1179648
    buffer_load_dwordx4 v5, s[8:11], s59 offen lds
    v_and_b32 v251, 0xffff0000, v236
    v_fmac_f32 v248, v250, v251
    v_lshlrev_b32 v250, 16, v233
    v_lshlrev_b32 v251, 16, v237
    v_fmac_f32 v248, v250, v251
    v_mfma_f32_16x16x32_bf16 v[68:71], v[36:39], v[128:131], 0
    v_mfma_f32_16x16x32_bf16 v[68:71], v[40:43], v[136:139], v[68:71]
    s_add_u32 m0, s48, 2048
    s_add_u32 s59, s53, 1310720
    buffer_load_dwordx4 v5, s[8:11], s59 offen lds
    v_and_b32 v250, 0xffff0000, v233
    v_and_b32 v251, 0xffff0000, v237
    v_fmac_f32 v248, v250, v251
    v_lshlrev_b32 v250, 16, v234
    v_lshlrev_b32 v251, 16, v238
    v_mfma_f32_16x16x32_bf16 v[76:79], v[36:39], v[132:135], 0
    ds_read_b128 v[36:39], v6 offset:43008
    v_mfma_f32_16x16x32_bf16 v[76:79], v[40:43], v[140:143], v[76:79]
    ds_read_b128 v[40:43], v7 offset:43008
    s_add_u32 m0, s48, 3072
    s_add_u32 s59, s53, 1441792
    buffer_load_dwordx4 v5, s[8:11], s59 offen lds
    v_fmac_f32 v248, v250, v251
    v_and_b32 v250, 0xffff0000, v234
    v_and_b32 v251, 0xffff0000, v238
    v_fmac_f32 v248, v250, v251
    v_lshlrev_b32 v250, 16, v235
    s_waitcnt lgkmcnt(4)
    v_mfma_f32_16x16x32_bf16 v[80:83], v[44:47], v[128:131], 0
    v_mfma_f32_16x16x32_bf16 v[80:83], v[48:51], v[136:139], v[80:83]
    s_add_u32 m0, s52, 0
    s_add_u32 s59, s49, 256
    buffer_load_dwordx4 v3, s[4:7], s59 offen lds
    buffer_load_dwordx4 v4, s[4:7], s59 offen offset:1024 lds
    v_lshlrev_b32 v251, 16, v239
    v_fmac_f32 v248, v250, v251
    v_and_b32 v250, 0xffff0000, v235
    v_and_b32 v251, 0xffff0000, v239
    v_fmac_f32 v248, v250, v251
    v_mfma_f32_16x16x32_bf16 v[88:91], v[44:47], v[132:135], 0
    ds_read_b128 v[44:47], v6 offset:45056
    v_mfma_f32_16x16x32_bf16 v[88:91], v[48:51], v[140:143], v[88:91]
    ds_read_b128 v[48:51], v7 offset:45056
    s_nop 1
    v_add_f32_dpp v248, v248, v248 quad_perm:[1,0,3,2] row_mask:0xf bank_mask:0xf
    s_nop 1
    v_add_f32_dpp v248, v248, v248 quad_perm:[2,3,0,1] row_mask:0xf bank_mask:0xf
    s_nop 1
    v_mfma_f32_16x16x32_bf16 v[84:87], v[52:55], v[128:131], 0
    v_mfma_f32_16x16x32_bf16 v[84:87], v[56:59], v[136:139], v[84:87]
    v_add_f32_dpp v248, v248, v248 row_half_mirror row_mask:0xf bank_mask:0xf
    s_nop 1
    v_add_f32_dpp v248, v248, v248 row_mirror row_mask:0xf bank_mask:0xf
    s_nop 0
    v_readlane_b32 s61, v248, 0
    v_mfma_f32_16x16x32_bf16 v[92:95], v[52:55], v[132:135], 0
    ds_read_b128 v[52:55], v6 offset:47104
    v_mfma_f32_16x16x32_bf16 v[92:95], v[56:59], v[140:143], v[92:95]
    ds_read_b128 v[56:59], v7 offset:47104
    v_readlane_b32 s62, v248, 16
    v_readlane_b32 s63, v248, 32
    v_readlane_b32 s64, v248, 48
    s_nop 1
    v_mov_b32 v248, s61
    s_waitcnt vmcnt(7)
    s_barrier
    s_waitcnt lgkmcnt(4)
    v_mfma_f32_16x16x32_bf16 v[96:99], v[28:31], v[128:131], 0
    v_mfma_f32_16x16x32_bf16 v[96:99], v[32:35], v[136:139], v[96:99]
    ds_read_b64_tr_b16 v[144:145], v9 offset:0
    v_add_f32 v248, s62, v248
    v_add_f32 v248, s63, v248
    v_add_f32 v248, s64, v248
    v_cvt_pk_bf16_f32 v248, v248, v248
    v_lshlrev_b32 v248, 16, v248
    v_mfma_f32_16x16x32_bf16 v[104:107], v[28:31], v[132:135], 0
    ds_read_b128 v[28:31], v6 offset:49152
    v_mfma_f32_16x16x32_bf16 v[104:107], v[32:35], v[140:143], v[104:107]
    ds_read_b128 v[32:35], v7 offset:49152
    ds_read_b64_tr_b16 v[146:147], v9 offset:256
    v_ashrrev_i32 v250, 31, v248
    v_or_b32 v250, 0x80000000, v250
    v_xor_b32 v248, v248, v250
    v_and_b32 v248, 0xffff0000, v248
    v_or_b32 v248, s56, v248
    s_mov_b64 exec, 1
    buffer_store_dword v248, v11, s[24:27], s58 offen sc1
    s_mov_b64 exec, -1
    s_mov_b32 exec_lo, 0xffff0000
    s_mov_b32 exec_hi, 0
    s_and_b32 s59, s41, 3
    s_cmp_eq_u32 s59, 1
    s_cbranch_scc1 KFT_27
    s_cmp_eq_u32 s41, 31
    s_cbranch_scc1 KFT_27
    s_add_u32 s60, s70, 0x8000
    s_cmp_eq_u32 s59, 0
    s_cbranch_scc1 KFT_28
    s_add_u32 s60, s70, 32768
    s_cmp_lg_u32 s41, 30
    s_cbranch_scc1 KFT_26
KFT_28:
    buffer_load_dword v15, v12, s[8:11], s60 offen
KFT_26:
    buffer_load_dword v15, v12, s[8:11], s70 offen
KFT_27:
    s_mov_b64 exec, -1
    v_mfma_f32_16x16x32_bf16 v[100:103], v[36:39], v[128:131], 0
    v_mfma_f32_16x16x32_bf16 v[100:103], v[40:43], v[136:139], v[100:103]
    ds_read_b64_tr_b16 v[148:149], v9 offset:32
    v_mfma_f32_16x16x32_bf16 v[108:111], v[36:39], v[132:135], 0
    ds_read_b128 v[36:39], v6 offset:51200
    v_mfma_f32_16x16x32_bf16 v[108:111], v[40:43], v[140:143], v[108:111]
    ds_read_b128 v[40:43], v7 offset:51200
    ds_read_b64_tr_b16 v[150:151], v9 offset:288
    s_waitcnt lgkmcnt(8)
    v_mfma_f32_16x16x32_bf16 v[112:115], v[44:47], v[128:131], 0
    v_mfma_f32_16x16x32_bf16 v[112:115], v[48:51], v[136:139], v[112:115]
    ds_read_b64_tr_b16 v[152:153], v9 offset:2048
    v_mfma_f32_16x16x32_bf16 v[120:123], v[44:47], v[132:135], 0
    ds_read_b128 v[44:47], v6 offset:53248
    v_mfma_f32_16x16x32_bf16 v[120:123], v[48:51], v[140:143], v[120:123]
    ds_read_b128 v[48:51], v7 offset:53248
    ds_read_b64_tr_b16 v[154:155], v9 offset:2304
    v_mfma_f32_16x16x32_bf16 v[116:119], v[52:55], v[128:131], 0
    v_mfma_f32_16x16x32_bf16 v[116:119], v[56:59], v[136:139], v[116:119]
    ds_read_b64_tr_b16 v[156:157], v9 offset:2080
    s_add_u32 m0, s48, 32768
    s_add_u32 s59, s53, 1572864
    buffer_load_dwordx4 v5, s[8:11], s59 offen lds
    v_mfma_f32_16x16x32_bf16 v[124:127], v[52:55], v[132:135], 0
    ds_read_b128 v[52:55], v6 offset:55296
    v_mfma_f32_16x16x32_bf16 v[124:127], v[56:59], v[140:143], v[124:127]
    ds_read_b128 v[56:59], v7 offset:55296
    ds_read_b64_tr_b16 v[158:159], v9 offset:2336
    s_add_u32 m0, s48, 33792
    s_add_u32 s59, s53, 1703936
    buffer_load_dwordx4 v5, s[8:11], s59 offen lds
    s_waitcnt lgkmcnt(0)
    v_mfma_f32_16x16x32_bf16 v[64:67], v[28:31], v[144:147], v[64:67]
    v_mfma_f32_16x16x32_bf16 v[64:67], v[32:35], v[152:155], v[64:67]
    s_add_u32 m0, s48, 34816
    s_add_u32 s59, s53, 1835008
    buffer_load_dwordx4 v5, s[8:11], s59 offen lds
    v_mfma_f32_16x16x32_bf16 v[72:75], v[28:31], v[148:151], v[72:75]
    ds_read_b128 v[28:31], v6 offset:57344
    v_mfma_f32_16x16x32_bf16 v[72:75], v[32:35], v[156:159], v[72:75]
    ds_read_b128 v[32:35], v7 offset:57344
    s_add_u32 m0, s48, 35840
    s_add_u32 s59, s53, 1966080
    buffer_load_dwordx4 v5, s[8:11], s59 offen lds
    v_mfma_f32_16x16x32_bf16 v[68:71], v[36:39], v[144:147], v[68:71]
    v_mfma_f32_16x16x32_bf16 v[68:71], v[40:43], v[152:155], v[68:71]
    s_add_u32 m0, s52, 16384
    s_add_u32 s59, s49, 384
    buffer_load_dwordx4 v3, s[4:7], s59 offen lds
    buffer_load_dwordx4 v4, s[4:7], s59 offen offset:1024 lds
    v_mfma_f32_16x16x32_bf16 v[76:79], v[36:39], v[148:151], v[76:79]
    ds_read_b128 v[36:39], v6 offset:59392
    v_mfma_f32_16x16x32_bf16 v[76:79], v[40:43], v[156:159], v[76:79]
    ds_read_b128 v[40:43], v7 offset:59392
    v_mfma_f32_16x16x32_bf16 v[80:83], v[44:47], v[144:147], v[80:83]
    v_mfma_f32_16x16x32_bf16 v[80:83], v[48:51], v[152:155], v[80:83]
    v_mfma_f32_16x16x32_bf16 v[88:91], v[44:47], v[148:151], v[88:91]
    ds_read_b128 v[44:47], v6 offset:61440
    v_mfma_f32_16x16x32_bf16 v[88:91], v[48:51], v[156:159], v[88:91]
    ds_read_b128 v[48:51], v7 offset:61440
    v_mfma_f32_16x16x32_bf16 v[84:87], v[52:55], v[144:147], v[84:87]
    v_mfma_f32_16x16x32_bf16 v[84:87], v[56:59], v[152:155], v[84:87]
    v_mfma_f32_16x16x32_bf16 v[92:95], v[52:55], v[148:151], v[92:95]
    ds_read_b128 v[52:55], v6 offset:63488
    v_mfma_f32_16x16x32_bf16 v[92:95], v[56:59], v[156:159], v[92:95]
    ds_read_b128 v[56:59], v7 offset:63488
    s_waitcnt vmcnt(7)
    s_barrier
    s_waitcnt lgkmcnt(4)
    v_mfma_f32_16x16x32_bf16 v[96:99], v[28:31], v[144:147], v[96:99]
    v_mfma_f32_16x16x32_bf16 v[96:99], v[32:35], v[152:155], v[96:99]
    ds_read_b64_tr_b16 v[160:161], v8 offset:0
    v_mfma_f32_16x16x32_bf16 v[104:107], v[28:31], v[148:151], v[104:107]
    ds_read_b128 v[28:31], v6 offset:0
    v_mfma_f32_16x16x32_bf16 v[104:107], v[32:35], v[156:159], v[104:107]
    ds_read_b128 v[32:35], v7 offset:0
    ds_read_b64_tr_b16 v[162:163], v8 offset:256
    v_mfma_f32_16x16x32_bf16 v[100:103], v[36:39], v[144:147], v[100:103]
    v_mfma_f32_16x16x32_bf16 v[100:103], v[40:43], v[152:155], v[100:103]
    ds_read_b64_tr_b16 v[164:165], v8 offset:32
    v_mfma_f32_16x16x32_bf16 v[108:111], v[36:39], v[148:151], v[108:111]
    ds_read_b128 v[36:39], v6 offset:2048
    v_mfma_f32_16x16x32_bf16 v[108:111], v[40:43], v[156:159], v[108:111]
    ds_read_b128 v[40:43], v7 offset:2048
    ds_read_b64_tr_b16 v[166:167], v8 offset:288
    s_waitcnt lgkmcnt(8)
    v_mfma_f32_16x16x32_bf16 v[112:115], v[44:47], v[144:147], v[112:115]
    v_mfma_f32_16x16x32_bf16 v[112:115], v[48:51], v[152:155], v[112:115]
    ds_read_b64_tr_b16 v[168:169], v8 offset:2048
    v_mfma_f32_16x16x32_bf16 v[120:123], v[44:47], v[148:151], v[120:123]
    ds_read_b128 v[44:47], v6 offset:4096
    v_mfma_f32_16x16x32_bf16 v[120:123], v[48:51], v[156:159], v[120:123]
    ds_read_b128 v[48:51], v7 offset:4096
    ds_read_b64_tr_b16 v[170:171], v8 offset:2304
    v_mfma_f32_16x16x32_bf16 v[116:119], v[52:55], v[144:147], v[116:119]
    v_mfma_f32_16x16x32_bf16 v[116:119], v[56:59], v[152:155], v[116:119]
    ds_read_b64_tr_b16 v[172:173], v8 offset:2080
    s_add_u32 m0, s48, 65536
    s_add_u32 s59, s53, 2097152
    buffer_load_dwordx4 v5, s[8:11], s59 offen lds
    s_bitcmp1_b32 s41, 0
    s_cbranch_scc1 KFT_29
    s_lshl_b32 s59, s55, 10
    s_bitcmp1_b32 s41, 1
    s_cselect_b32 s60, 0, 196608
    s_add_u32 s59, s59, s60
    s_mov_b32 exec_lo, 0xff
    s_mov_b32 exec_hi, 0
    buffer_load_dword v14, v13, s[4:7], s59 offen
    s_mov_b64 exec, -1
KFT_29:
    v_mfma_f32_16x16x32_bf16 v[124:127], v[52:55], v[148:151], v[124:127]
    ds_read_b128 v[52:55], v6 offset:6144
    v_mfma_f32_16x16x32_bf16 v[124:127], v[56:59], v[156:159], v[124:127]
    ds_read_b128 v[56:59], v7 offset:6144
    ds_read_b64_tr_b16 v[174:175], v8 offset:2336
    s_add_u32 m0, s48, 66560
    s_add_u32 s59, s53, 2228224
    buffer_load_dwordx4 v5, s[8:11], s59 offen lds
    s_waitcnt lgkmcnt(0)
    v_mfma_f32_16x16x32_bf16 v[64:67], v[28:31], v[160:163], v[64:67]
    v_mfma_f32_16x16x32_bf16 v[64:67], v[32:35], v[168:171], v[64:67]
    s_add_u32 m0, s48, 67584
    s_add_u32 s59, s53, 2359296
    buffer_load_dwordx4 v5, s[8:11], s59 offen lds
    v_mfma_f32_16x16x32_bf16 v[72:75], v[28:31], v[164:167], v[72:75]
    ds_read_b128 v[28:31], v6 offset:8192
    v_mfma_f32_16x16x32_bf16 v[72:75], v[32:35], v[172:175], v[72:75]
    ds_read_b128 v[32:35], v7 offset:8192
    s_add_u32 m0, s48, 68608
    s_add_u32 s59, s53, 2490368
    buffer_load_dwordx4 v5, s[8:11], s59 offen lds
    v_mfma_f32_16x16x32_bf16 v[68:71], v[36:39], v[160:163], v[68:71]
    v_mfma_f32_16x16x32_bf16 v[68:71], v[40:43], v[168:171], v[68:71]
    s_add_u32 m0, s52, 32768
    s_add_u32 s59, s49, 512
    buffer_load_dwordx4 v3, s[4:7], s59 offen lds
    buffer_load_dwordx4 v4, s[4:7], s59 offen offset:1024 lds
    v_mfma_f32_16x16x32_bf16 v[76:79], v[36:39], v[164:167], v[76:79]
    ds_read_b128 v[36:39], v6 offset:10240
    v_mfma_f32_16x16x32_bf16 v[76:79], v[40:43], v[172:175], v[76:79]
    ds_read_b128 v[40:43], v7 offset:10240
    v_mfma_f32_16x16x32_bf16 v[80:83], v[44:47], v[160:163], v[80:83]
    v_mfma_f32_16x16x32_bf16 v[80:83], v[48:51], v[168:171], v[80:83]
    v_mfma_f32_16x16x32_bf16 v[88:91], v[44:47], v[164:167], v[88:91]
    ds_read_b128 v[44:47], v6 offset:12288
    v_mfma_f32_16x16x32_bf16 v[88:91], v[48:51], v[172:175], v[88:91]
    ds_read_b128 v[48:51], v7 offset:12288
    v_mfma_f32_16x16x32_bf16 v[84:87], v[52:55], v[160:163], v[84:87]
    v_mfma_f32_16x16x32_bf16 v[84:87], v[56:59], v[168:171], v[84:87]
    v_mfma_f32_16x16x32_bf16 v[92:95], v[52:55], v[164:167], v[92:95]
    ds_read_b128 v[52:55], v6 offset:14336
    v_mfma_f32_16x16x32_bf16 v[92:95], v[56:59], v[172:175], v[92:95]
    ds_read_b128 v[56:59], v7 offset:14336
    s_waitcnt vmcnt(6)
    s_barrier
    s_waitcnt lgkmcnt(4)
    v_mfma_f32_16x16x32_bf16 v[96:99], v[28:31], v[160:163], v[96:99]
    v_mfma_f32_16x16x32_bf16 v[96:99], v[32:35], v[168:171], v[96:99]
    ds_read_b64_tr_b16 v[176:177], v8 offset:32768
    v_mfma_f32_16x16x32_bf16 v[104:107], v[28:31], v[164:167], v[104:107]
    ds_read_b128 v[28:31], v6 offset:16384
    v_mfma_f32_16x16x32_bf16 v[104:107], v[32:35], v[172:175], v[104:107]
    ds_read_b128 v[32:35], v7 offset:16384
    ds_read_b64_tr_b16 v[178:179], v8 offset:33024
    v_mfma_f32_16x16x32_bf16 v[100:103], v[36:39], v[160:163], v[100:103]
    v_mfma_f32_16x16x32_bf16 v[100:103], v[40:43], v[168:171], v[100:103]
    ds_read_b64_tr_b16 v[180:181], v8 offset:32800
    v_mfma_f32_16x16x32_bf16 v[108:111], v[36:39], v[164:167], v[108:111]
    ds_read_b128 v[36:39], v6 offset:18432
    v_mfma_f32_16x16x32_bf16 v[108:111], v[40:43], v[172:175], v[108:111]
    ds_read_b128 v[40:43], v7 offset:18432
    ds_read_b64_tr_b16 v[182:183], v8 offset:33056
    s_waitcnt lgkmcnt(8)
    v_mfma_f32_16x16x32_bf16 v[112:115], v[44:47], v[160:163], v[112:115]
    v_mfma_f32_16x16x32_bf16 v[112:115], v[48:51], v[168:171], v[112:115]
    ds_read_b64_tr_b16 v[184:185], v8 offset:34816
    v_mfma_f32_16x16x32_bf16 v[120:123], v[44:47], v[164:167], v[120:123]
    ds_read_b128 v[44:47], v6 offset:20480
    v_mfma_f32_16x16x32_bf16 v[120:123], v[48:51], v[172:175], v[120:123]
    ds_read_b128 v[48:51], v7 offset:20480
    ds_read_b64_tr_b16 v[186:187], v8 offset:35072
    v_mfma_f32_16x16x32_bf16 v[116:119], v[52:55], v[160:163], v[116:119]
    v_mfma_f32_16x16x32_bf16 v[116:119], v[56:59], v[168:171], v[116:119]
    ds_read_b64_tr_b16 v[188:189], v8 offset:34848
    s_add_u32 m0, s48, 0
    s_add_u32 s59, s53, 2621440
    buffer_load_dwordx4 v5, s[8:11], s59 offen lds
    v_mfma_f32_16x16x32_bf16 v[124:127], v[52:55], v[164:167], v[124:127]
    ds_read_b128 v[52:55], v6 offset:22528
    v_mfma_f32_16x16x32_bf16 v[124:127], v[56:59], v[172:175], v[124:127]
    ds_read_b128 v[56:59], v7 offset:22528
    ds_read_b64_tr_b16 v[190:191], v8 offset:35104
    s_add_u32 m0, s48, 1024
    s_add_u32 s59, s53, 2752512
    buffer_load_dwordx4 v5, s[8:11], s59 offen lds
    s_waitcnt lgkmcnt(0)
    v_mfma_f32_16x16x32_bf16 v[64:67], v[28:31], v[176:179], v[64:67]
    v_mfma_f32_16x16x32_bf16 v[64:67], v[32:35], v[184:187], v[64:67]
    s_add_u32 m0, s48, 2048
    s_add_u32 s59, s53, 2883584
    buffer_load_dwordx4 v5, s[8:11], s59 offen lds
    v_mfma_f32_16x16x32_bf16 v[72:75], v[28:31], v[180:183], v[72:75]
    ds_read_b128 v[28:31], v6 offset:24576
    v_mfma_f32_16x16x32_bf16 v[72:75], v[32:35], v[188:191], v[72:75]
    ds_read_b128 v[32:35], v7 offset:24576
    s_add_u32 m0, s48, 3072
    s_add_u32 s59, s53, 3014656
    buffer_load_dwordx4 v5, s[8:11], s59 offen lds
    v_mfma_f32_16x16x32_bf16 v[68:71], v[36:39], v[176:179], v[68:71]
    v_mfma_f32_16x16x32_bf16 v[68:71], v[40:43], v[184:187], v[68:71]
    s_add_u32 m0, s52, 49152
    s_add_u32 s59, s49, 640
    buffer_load_dwordx4 v3, s[4:7], s59 offen lds
    buffer_load_dwordx4 v4, s[4:7], s59 offen offset:1024 lds
    v_mfma_f32_16x16x32_bf16 v[76:79], v[36:39], v[180:183], v[76:79]
    ds_read_b128 v[36:39], v6 offset:26624
    v_mfma_f32_16x16x32_bf16 v[76:79], v[40:43], v[188:191], v[76:79]
    ds_read_b128 v[40:43], v7 offset:26624
    v_mfma_f32_16x16x32_bf16 v[80:83], v[44:47], v[176:179], v[80:83]
    v_mfma_f32_16x16x32_bf16 v[80:83], v[48:51], v[184:187], v[80:83]
    v_mfma_f32_16x16x32_bf16 v[88:91], v[44:47], v[180:183], v[88:91]
    ds_read_b128 v[44:47], v6 offset:28672
    v_mfma_f32_16x16x32_bf16 v[88:91], v[48:51], v[188:191], v[88:91]
    ds_read_b128 v[48:51], v7 offset:28672
    v_mfma_f32_16x16x32_bf16 v[84:87], v[52:55], v[176:179], v[84:87]
    v_mfma_f32_16x16x32_bf16 v[84:87], v[56:59], v[184:187], v[84:87]
    v_mfma_f32_16x16x32_bf16 v[92:95], v[52:55], v[180:183], v[92:95]
    ds_read_b128 v[52:55], v6 offset:30720
    v_mfma_f32_16x16x32_bf16 v[92:95], v[56:59], v[188:191], v[92:95]
    ds_read_b128 v[56:59], v7 offset:30720
    s_waitcnt vmcnt(6)
    s_barrier
    s_waitcnt lgkmcnt(4)
    v_mfma_f32_16x16x32_bf16 v[96:99], v[28:31], v[176:179], v[96:99]
    v_mfma_f32_16x16x32_bf16 v[96:99], v[32:35], v[184:187], v[96:99]
    ds_read_b64_tr_b16 v[192:193], v9 offset:0
    v_mfma_f32_16x16x32_bf16 v[104:107], v[28:31], v[180:183], v[104:107]
    ds_read_b128 v[28:31], v6 offset:32768
    v_mfma_f32_16x16x32_bf16 v[104:107], v[32:35], v[188:191], v[104:107]
    ds_read_b128 v[32:35], v7 offset:32768
    ds_read_b64_tr_b16 v[194:195], v9 offset:256
    v_mfma_f32_16x16x32_bf16 v[100:103], v[36:39], v[176:179], v[100:103]
    v_mfma_f32_16x16x32_bf16 v[100:103], v[40:43], v[184:187], v[100:103]
    ds_read_b64_tr_b16 v[196:197], v9 offset:32
    v_mfma_f32_16x16x32_bf16 v[108:111], v[36:39], v[180:183], v[108:111]
    ds_read_b128 v[36:39], v6 offset:34816
    v_mfma_f32_16x16x32_bf16 v[108:111], v[40:43], v[188:191], v[108:111]
    ds_read_b128 v[40:43], v7 offset:34816
    ds_read_b64_tr_b16 v[198:199], v9 offset:288
    s_waitcnt lgkmcnt(8)
    v_mfma_f32_16x16x32_bf16 v[112:115], v[44:47], v[176:179], v[112:115]
    v_mfma_f32_16x16x32_bf16 v[112:115], v[48:51], v[184:187], v[112:115]
    ds_read_b64_tr_b16 v[200:201], v9 offset:2048
    s_mov_b32 s16, s88
    s_and_b32 s17, s89, 0xffff
    s_mov_b32 s18, 0x400000
    s_mov_b32 s19, 0x00020000
    s_mov_b32 exec_lo, 0xffff0000
    s_mov_b32 exec_hi, 0
    s_and_b32 s59, s41, 3
    s_cmp_eq_u32 s59, 1
    s_cbranch_scc1 KFT_31
    s_cmp_eq_u32 s41, 31
    s_cbranch_scc1 KFT_31
    s_add_u32 s60, s70, 0xffff8000
    s_cmp_eq_u32 s59, 2
    s_cbranch_scc1 KFT_32
    s_add_u32 s60, s70, 98304
    s_cmp_lg_u32 s41, 28
    s_cbranch_scc1 KFT_30
KFT_32:
    buffer_load_dword v15, v12, s[16:19], s60 offen
KFT_30:
    buffer_load_dword v15, v12, s[16:19], s70 offen
KFT_31:
    s_mov_b64 exec, -1
    v_mfma_f32_16x16x32_bf16 v[120:123], v[44:47], v[180:183], v[120:123]
    ds_read_b128 v[44:47], v6 offset:36864
    v_mfma_f32_16x16x32_bf16 v[120:123], v[48:51], v[188:191], v[120:123]
    ds_read_b128 v[48:51], v7 offset:36864
    ds_read_b64_tr_b16 v[202:203], v9 offset:2304
    v_mfma_f32_16x16x32_bf16 v[116:119], v[52:55], v[176:179], v[116:119]
    v_mfma_f32_16x16x32_bf16 v[116:119], v[56:59], v[184:187], v[116:119]
    ds_read_b64_tr_b16 v[204:205], v9 offset:2080
    s_add_u32 m0, s48, 32768
    s_add_u32 s59, s53, 3145728
    buffer_load_dwordx4 v5, s[8:11], s59 offen lds
    v_mfma_f32_16x16x32_bf16 v[124:127], v[52:55], v[180:183], v[124:127]
    ds_read_b128 v[52:55], v6 offset:38912
    v_mfma_f32_16x16x32_bf16 v[124:127], v[56:59], v[188:191], v[124:127]
    ds_read_b128 v[56:59], v7 offset:38912
    ds_read_b64_tr_b16 v[206:207], v9 offset:2336
    s_add_u32 m0, s48, 33792
    s_add_u32 s59, s53, 3276800
    buffer_load_dwordx4 v5, s[8:11], s59 offen lds
    s_waitcnt lgkmcnt(0)
    v_mfma_f32_16x16x32_bf16 v[64:67], v[28:31], v[192:195], v[64:67]
    v_mfma_f32_16x16x32_bf16 v[64:67], v[32:35], v[200:203], v[64:67]
    s_add_u32 m0, s48, 34816
    s_add_u32 s59, s53, 3407872
    buffer_load_dwordx4 v5, s[8:11], s59 offen lds
    v_mfma_f32_16x16x32_bf16 v[72:75], v[28:31], v[196:199], v[72:75]
    ds_read_b128 v[28:31], v6 offset:40960
    v_mfma_f32_16x16x32_bf16 v[72:75], v[32:35], v[204:207], v[72:75]
    ds_read_b128 v[32:35], v7 offset:40960
    s_add_u32 m0, s48, 35840
    s_add_u32 s59, s53, 3538944
    buffer_load_dwordx4 v5, s[8:11], s59 offen lds
    v_mfma_f32_16x16x32_bf16 v[68:71], v[36:39], v[192:195], v[68:71]
    v_mfma_f32_16x16x32_bf16 v[68:71], v[40:43], v[200:203], v[68:71]
    s_add_u32 m0, s52, 0
    s_add_u32 s59, s49, 768
    buffer_load_dwordx4 v3, s[4:7], s59 offen lds
    buffer_load_dwordx4 v4, s[4:7], s59 offen offset:1024 lds
    v_mfma_f32_16x16x32_bf16 v[76:79], v[36:39], v[196:199], v[76:79]
    ds_read_b128 v[36:39], v6 offset:43008
    v_mfma_f32_16x16x32_bf16 v[76:79], v[40:43], v[204:207], v[76:79]
    ds_read_b128 v[40:43], v7 offset:43008
    v_mfma_f32_16x16x32_bf16 v[80:83], v[44:47], v[192:195], v[80:83]
    v_mfma_f32_16x16x32_bf16 v[80:83], v[48:51], v[200:203], v[80:83]
    v_mfma_f32_16x16x32_bf16 v[88:91], v[44:47], v[196:199], v[88:91]
    ds_read_b128 v[44:47], v6 offset:45056
    v_mfma_f32_16x16x32_bf16 v[88:91], v[48:51], v[204:207], v[88:91]
    ds_read_b128 v[48:51], v7 offset:45056
    v_mfma_f32_16x16x32_bf16 v[84:87], v[52:55], v[192:195], v[84:87]
    v_mfma_f32_16x16x32_bf16 v[84:87], v[56:59], v[200:203], v[84:87]
    v_mfma_f32_16x16x32_bf16 v[92:95], v[52:55], v[196:199], v[92:95]
    ds_read_b128 v[52:55], v6 offset:47104
    v_mfma_f32_16x16x32_bf16 v[92:95], v[56:59], v[204:207], v[92:95]
    ds_read_b128 v[56:59], v7 offset:47104
    s_waitcnt vmcnt(6)
    s_barrier
    s_waitcnt lgkmcnt(4)
    v_mfma_f32_16x16x32_bf16 v[96:99], v[28:31], v[192:195], v[96:99]
    v_mfma_f32_16x16x32_bf16 v[96:99], v[32:35], v[200:203], v[96:99]
    ds_read_b64_tr_b16 v[208:209], v8 offset:0
    v_mfma_f32_16x16x32_bf16 v[104:107], v[28:31], v[196:199], v[104:107]
    ds_read_b128 v[28:31], v6 offset:49152
    v_mfma_f32_16x16x32_bf16 v[104:107], v[32:35], v[204:207], v[104:107]
    ds_read_b128 v[32:35], v7 offset:49152
    ds_read_b64_tr_b16 v[210:211], v8 offset:256
    v_mfma_f32_16x16x32_bf16 v[100:103], v[36:39], v[192:195], v[100:103]
    v_mfma_f32_16x16x32_bf16 v[100:103], v[40:43], v[200:203], v[100:103]
    ds_read_b64_tr_b16 v[212:213], v8 offset:32
    v_mfma_f32_16x16x32_bf16 v[108:111], v[36:39], v[196:199], v[108:111]
    ds_read_b128 v[36:39], v6 offset:51200
    v_mfma_f32_16x16x32_bf16 v[108:111], v[40:43], v[204:207], v[108:111]
    ds_read_b128 v[40:43], v7 offset:51200
    ds_read_b64_tr_b16 v[214:215], v8 offset:288
    s_waitcnt lgkmcnt(8)
    v_mfma_f32_16x16x32_bf16 v[112:115], v[44:47], v[192:195], v[112:115]
    v_mfma_f32_16x16x32_bf16 v[112:115], v[48:51], v[200:203], v[112:115]
    ds_read_b64_tr_b16 v[216:217], v8 offset:2048
    v_mfma_f32_16x16x32_bf16 v[120:123], v[44:47], v[196:199], v[120:123]
    ds_read_b128 v[44:47], v6 offset:53248
    v_mfma_f32_16x16x32_bf16 v[120:123], v[48:51], v[204:207], v[120:123]
    ds_read_b128 v[48:51], v7 offset:53248
    ds_read_b64_tr_b16 v[218:219], v8 offset:2304
    v_mfma_f32_16x16x32_bf16 v[116:119], v[52:55], v[192:195], v[116:119]
    v_mfma_f32_16x16x32_bf16 v[116:119], v[56:59], v[200:203], v[116:119]
    ds_read_b64_tr_b16 v[220:221], v8 offset:2080
    s_add_u32 m0, s48, 65536
    s_add_u32 s59, s53, 3670016
    buffer_load_dwordx4 v5, s[8:11], s59 offen lds
    v_mfma_f32_16x16x32_bf16 v[124:127], v[52:55], v[196:199], v[124:127]
    ds_read_b128 v[52:55], v6 offset:55296
    v_mfma_f32_16x16x32_bf16 v[124:127], v[56:59], v[204:207], v[124:127]
    ds_read_b128 v[56:59], v7 offset:55296
    ds_read_b64_tr_b16 v[222:223], v8 offset:2336
    s_add_u32 m0, s48, 66560
    s_add_u32 s59, s53, 3801088
    buffer_load_dwordx4 v5, s[8:11], s59 offen lds
    s_waitcnt lgkmcnt(0)
    v_mfma_f32_16x16x32_bf16 v[64:67], v[28:31], v[208:211], v[64:67]
    v_mfma_f32_16x16x32_bf16 v[64:67], v[32:35], v[216:219], v[64:67]
    s_add_u32 m0, s48, 67584
    s_add_u32 s59, s53, 3932160
    buffer_load_dwordx4 v5, s[8:11], s59 offen lds
    v_mfma_f32_16x16x32_bf16 v[72:75], v[28:31], v[212:215], v[72:75]
    ds_read_b128 v[28:31], v6 offset:57344
    v_mfma_f32_16x16x32_bf16 v[72:75], v[32:35], v[220:223], v[72:75]
    ds_read_b128 v[32:35], v7 offset:57344
    s_add_u32 m0, s48, 68608
    s_add_u32 s59, s53, 4063232
    buffer_load_dwordx4 v5, s[8:11], s59 offen lds
    v_mfma_f32_16x16x32_bf16 v[68:71], v[36:39], v[208:211], v[68:71]
    v_mfma_f32_16x16x32_bf16 v[68:71], v[40:43], v[216:219], v[68:71]
    s_add_u32 m0, s52, 16384
    s_add_u32 s59, s49, 896
    buffer_load_dwordx4 v3, s[4:7], s59 offen lds
    buffer_load_dwordx4 v4, s[4:7], s59 offen offset:1024 lds
    v_mfma_f32_16x16x32_bf16 v[76:79], v[36:39], v[212:215], v[76:79]
    ds_read_b128 v[36:39], v6 offset:59392
    v_mfma_f32_16x16x32_bf16 v[76:79], v[40:43], v[220:223], v[76:79]
    ds_read_b128 v[40:43], v7 offset:59392
    v_mfma_f32_16x16x32_bf16 v[80:83], v[44:47], v[208:211], v[80:83]
    v_mfma_f32_16x16x32_bf16 v[80:83], v[48:51], v[216:219], v[80:83]
    v_mfma_f32_16x16x32_bf16 v[88:91], v[44:47], v[212:215], v[88:91]
    ds_read_b128 v[44:47], v6 offset:61440
    v_mfma_f32_16x16x32_bf16 v[88:91], v[48:51], v[220:223], v[88:91]
    ds_read_b128 v[48:51], v7 offset:61440
    v_mfma_f32_16x16x32_bf16 v[84:87], v[52:55], v[208:211], v[84:87]
    v_mfma_f32_16x16x32_bf16 v[84:87], v[56:59], v[216:219], v[84:87]
    v_mfma_f32_16x16x32_bf16 v[92:95], v[52:55], v[212:215], v[92:95]
    ds_read_b128 v[52:55], v6 offset:63488
    v_mfma_f32_16x16x32_bf16 v[92:95], v[56:59], v[220:223], v[92:95]
    ds_read_b128 v[56:59], v7 offset:63488
    s_waitcnt vmcnt(6)
    s_barrier
    s_waitcnt lgkmcnt(4)
    v_mfma_f32_16x16x32_bf16 v[96:99], v[28:31], v[208:211], v[96:99]
    v_mfma_f32_16x16x32_bf16 v[96:99], v[32:35], v[216:219], v[96:99]
    ds_read_b64_tr_b16 v[224:225], v8 offset:32768
    v_mfma_f32_16x16x32_bf16 v[104:107], v[28:31], v[212:215], v[104:107]
    ds_read_b128 v[28:31], v6 offset:0
    v_mfma_f32_16x16x32_bf16 v[104:107], v[32:35], v[220:223], v[104:107]
    ds_read_b128 v[32:35], v7 offset:0
    ds_read_b64_tr_b16 v[226:227], v8 offset:33024
    v_mfma_f32_16x16x32_bf16 v[100:103], v[36:39], v[208:211], v[100:103]
    v_mfma_f32_16x16x32_bf16 v[100:103], v[40:43], v[216:219], v[100:103]
    ds_read_b64_tr_b16 v[228:229], v8 offset:32800
    v_mfma_f32_16x16x32_bf16 v[108:111], v[36:39], v[212:215], v[108:111]
    ds_read_b128 v[36:39], v6 offset:2048
    v_mfma_f32_16x16x32_bf16 v[108:111], v[40:43], v[220:223], v[108:111]
    ds_read_b128 v[40:43], v7 offset:2048
    ds_read_b64_tr_b16 v[230:231], v8 offset:33056
    s_waitcnt lgkmcnt(8)
    v_mfma_f32_16x16x32_bf16 v[112:115], v[44:47], v[208:211], v[112:115]
    v_mfma_f32_16x16x32_bf16 v[112:115], v[48:51], v[216:219], v[112:115]
    ds_read_b64_tr_b16 v[232:233], v8 offset:34816
    v_mfma_f32_16x16x32_bf16 v[120:123], v[44:47], v[212:215], v[120:123]
    ds_read_b128 v[44:47], v6 offset:4096
    v_mfma_f32_16x16x32_bf16 v[120:123], v[48:51], v[220:223], v[120:123]
    ds_read_b128 v[48:51], v7 offset:4096
    ds_read_b64_tr_b16 v[234:235], v8 offset:35072
    v_mfma_f32_16x16x32_bf16 v[116:119], v[52:55], v[208:211], v[116:119]
    v_mfma_f32_16x16x32_bf16 v[116:119], v[56:59], v[216:219], v[116:119]
    ds_read_b64_tr_b16 v[236:237], v8 offset:34848
    s_add_u32 m0, s52, 32768
    s_add_u32 s59, s50, 131072
    buffer_load_dwordx4 v3, s[4:7], s59 offen lds
    buffer_load_dwordx4 v4, s[4:7], s59 offen offset:1024 lds
    v_mfma_f32_16x16x32_bf16 v[124:127], v[52:55], v[212:215], v[124:127]
    ds_read_b128 v[52:55], v6 offset:6144
    v_mfma_f32_16x16x32_bf16 v[124:127], v[56:59], v[220:223], v[124:127]
    ds_read_b128 v[56:59], v7 offset:6144
    ds_read_b64_tr_b16 v[238:239], v8 offset:35104
    s_add_u32 m0, s48, 0
    s_add_u32 s59, s51, 163840
    buffer_load_dwordx4 v3, s[4:7], s59 offen lds
    buffer_load_dwordx4 v4, s[4:7], s59 offen offset:1024 lds
    s_waitcnt lgkmcnt(0)
    v_mfma_f32_16x16x32_bf16 v[64:67], v[28:31], v[224:227], v[64:67]
    v_mfma_f32_16x16x32_bf16 v[64:67], v[32:35], v[232:235], v[64:67]
    s_add_u32 m0, s48, 2048
    s_add_u32 s59, s51, 180224
    buffer_load_dwordx4 v3, s[4:7], s59 offen lds
    buffer_load_dwordx4 v4, s[4:7], s59 offen offset:1024 lds
    v_mfma_f32_16x16x32_bf16 v[72:75], v[28:31], v[228:231], v[72:75]
    ds_read_b128 v[28:31], v6 offset:8192
    v_mfma_f32_16x16x32_bf16 v[72:75], v[32:35], v[236:239], v[72:75]
    ds_read_b128 v[32:35], v7 offset:8192
    v_mfma_f32_16x16x32_bf16 v[68:71], v[36:39], v[224:227], v[68:71]
    v_mfma_f32_16x16x32_bf16 v[68:71], v[40:43], v[232:235], v[68:71]
    v_mfma_f32_16x16x32_bf16 v[76:79], v[36:39], v[228:231], v[76:79]
    ds_read_b128 v[36:39], v6 offset:10240
    v_mfma_f32_16x16x32_bf16 v[76:79], v[40:43], v[236:239], v[76:79]
    ds_read_b128 v[40:43], v7 offset:10240
    v_mfma_f32_16x16x32_bf16 v[80:83], v[44:47], v[224:227], v[80:83]
    v_mfma_f32_16x16x32_bf16 v[80:83], v[48:51], v[232:235], v[80:83]
    v_mfma_f32_16x16x32_bf16 v[88:91], v[44:47], v[228:231], v[88:91]
    ds_read_b128 v[44:47], v6 offset:12288
    v_mfma_f32_16x16x32_bf16 v[88:91], v[48:51], v[236:239], v[88:91]
    ds_read_b128 v[48:51], v7 offset:12288
    v_mfma_f32_16x16x32_bf16 v[84:87], v[52:55], v[224:227], v[84:87]
    v_mfma_f32_16x16x32_bf16 v[84:87], v[56:59], v[232:235], v[84:87]
    v_mfma_f32_16x16x32_bf16 v[92:95], v[52:55], v[228:231], v[92:95]
    ds_read_b128 v[52:55], v6 offset:14336
    v_mfma_f32_16x16x32_bf16 v[92:95], v[56:59], v[236:239], v[92:95]
    ds_read_b128 v[56:59], v7 offset:14336
    s_waitcnt vmcnt(6)
    s_barrier
    s_waitcnt lgkmcnt(4)
    v_mfma_f32_16x16x32_bf16 v[96:99], v[28:31], v[224:227], v[96:99]
    v_mfma_f32_16x16x32_bf16 v[96:99], v[32:35], v[232:235], v[96:99]
    ds_read_b64_tr_b16 v[240:241], v9 offset:0
    v_mfma_f32_16x16x32_bf16 v[104:107], v[28:31], v[228:231], v[104:107]
    ds_read_b128 v[28:31], v6 offset:16384
    v_mfma_f32_16x16x32_bf16 v[104:107], v[32:35], v[236:239], v[104:107]
    ds_read_b128 v[32:35], v7 offset:16384
    ds_read_b64_tr_b16 v[242:243], v9 offset:256
    v_mfma_f32_16x16x32_bf16 v[100:103], v[36:39], v[224:227], v[100:103]
    v_mfma_f32_16x16x32_bf16 v[100:103], v[40:43], v[232:235], v[100:103]
    ds_read_b64_tr_b16 v[244:245], v9 offset:32
    v_mfma_f32_16x16x32_bf16 v[108:111], v[36:39], v[228:231], v[108:111]
    ds_read_b128 v[36:39], v6 offset:18432
    v_mfma_f32_16x16x32_bf16 v[108:111], v[40:43], v[236:239], v[108:111]
    ds_read_b128 v[40:43], v7 offset:18432
    ds_read_b64_tr_b16 v[246:247], v9 offset:288
    s_waitcnt lgkmcnt(8)
    v_mfma_f32_16x16x32_bf16 v[112:115], v[44:47], v[224:227], v[112:115]
    v_mfma_f32_16x16x32_bf16 v[112:115], v[48:51], v[232:235], v[112:115]
    ds_read_b64_tr_b16 v[248:249], v9 offset:2048
    v_mfma_f32_16x16x32_bf16 v[120:123], v[44:47], v[228:231], v[120:123]
    ds_read_b128 v[44:47], v6 offset:20480
    v_mfma_f32_16x16x32_bf16 v[120:123], v[48:51], v[236:239], v[120:123]
    ds_read_b128 v[48:51], v7 offset:20480
    ds_read_b64_tr_b16 v[250:251], v9 offset:2304
    v_mfma_f32_16x16x32_bf16 v[116:119], v[52:55], v[224:227], v[116:119]
    v_mfma_f32_16x16x32_bf16 v[116:119], v[56:59], v[232:235], v[116:119]
    ds_read_b64_tr_b16 v[252:253], v9 offset:2080
    s_add_u32 m0, s52, 49152
    s_add_u32 s59, s50, 131584
    buffer_load_dwordx4 v3, s[4:7], s59 offen lds
    buffer_load_dwordx4 v4, s[4:7], s59 offen offset:1024 lds
    v_mfma_f32_16x16x32_bf16 v[124:127], v[52:55], v[228:231], v[124:127]
    ds_read_b128 v[52:55], v6 offset:22528
    v_mfma_f32_16x16x32_bf16 v[124:127], v[56:59], v[236:239], v[124:127]
    ds_read_b128 v[56:59], v7 offset:22528
    ds_read_b64_tr_b16 v[254:255], v9 offset:2336
    s_add_u32 m0, s48, 32768
    s_add_u32 s59, s51, 196608
    buffer_load_dwordx4 v3, s[4:7], s59 offen lds
    buffer_load_dwordx4 v4, s[4:7], s59 offen offset:1024 lds
    s_waitcnt lgkmcnt(0)
    v_mfma_f32_16x16x32_bf16 v[64:67], v[28:31], v[240:243], v[64:67]
    v_mfma_f32_16x16x32_bf16 v[64:67], v[32:35], v[248:251], v[64:67]
    s_add_u32 m0, s48, 34816
    s_add_u32 s59, s51, 212992
    buffer_load_dwordx4 v3, s[4:7], s59 offen lds
    buffer_load_dwordx4 v4, s[4:7], s59 offen offset:1024 lds
    v_mfma_f32_16x16x32_bf16 v[72:75], v[28:31], v[244:247], v[72:75]
    ds_read_b128 v[28:31], v6 offset:24576
    v_mfma_f32_16x16x32_bf16 v[72:75], v[32:35], v[252:255], v[72:75]
    ds_read_b128 v[32:35], v7 offset:24576
    v_mfma_f32_16x16x32_bf16 v[68:71], v[36:39], v[240:243], v[68:71]
    v_mfma_f32_16x16x32_bf16 v[68:71], v[40:43], v[248:251], v[68:71]
    v_mfma_f32_16x16x32_bf16 v[76:79], v[36:39], v[244:247], v[76:79]
    ds_read_b128 v[36:39], v6 offset:26624
    v_mfma_f32_16x16x32_bf16 v[76:79], v[40:43], v[252:255], v[76:79]
    ds_read_b128 v[40:43], v7 offset:26624
    v_mfma_f32_16x16x32_bf16 v[80:83], v[44:47], v[240:243], v[80:83]
    v_mfma_f32_16x16x32_bf16 v[80:83], v[48:51], v[248:251], v[80:83]
    v_mfma_f32_16x16x32_bf16 v[88:91], v[44:47], v[244:247], v[88:91]
    ds_read_b128 v[44:47], v6 offset:28672
    v_mfma_f32_16x16x32_bf16 v[88:91], v[48:51], v[252:255], v[88:91]
    ds_read_b128 v[48:51], v7 offset:28672
    v_mfma_f32_16x16x32_bf16 v[84:87], v[52:55], v[240:243], v[84:87]
    v_mfma_f32_16x16x32_bf16 v[84:87], v[56:59], v[248:251], v[84:87]
    v_mfma_f32_16x16x32_bf16 v[92:95], v[52:55], v[244:247], v[92:95]
    ds_read_b128 v[52:55], v6 offset:30720
    v_mfma_f32_16x16x32_bf16 v[92:95], v[56:59], v[252:255], v[92:95]
    ds_read_b128 v[56:59], v7 offset:30720
    s_waitcnt vmcnt(10)
    s_barrier
    s_waitcnt lgkmcnt(4)
    v_mfma_f32_16x16x32_bf16 v[96:99], v[28:31], v[240:243], v[96:99]
    v_mfma_f32_16x16x32_bf16 v[96:99], v[32:35], v[248:251], v[96:99]
    v_mfma_f32_16x16x32_bf16 v[104:107], v[28:31], v[244:247], v[104:107]
    ds_read_b128 v[28:31], v6 offset:32768
    v_mfma_f32_16x16x32_bf16 v[104:107], v[32:35], v[252:255], v[104:107]
    ds_read_b128 v[32:35], v7 offset:32768
    v_mfma_f32_16x16x32_bf16 v[100:103], v[36:39], v[240:243], v[100:103]
    v_mfma_f32_16x16x32_bf16 v[100:103], v[40:43], v[248:251], v[100:103]
    v_mfma_f32_16x16x32_bf16 v[108:111], v[36:39], v[244:247], v[108:111]
    ds_read_b128 v[36:39], v6 offset:34816
    v_mfma_f32_16x16x32_bf16 v[108:111], v[40:43], v[252:255], v[108:111]
    ds_read_b128 v[40:43], v7 offset:34816
    v_cvt_pk_bf16_f32 v12, v64, v65
    v_cvt_pk_bf16_f32 v13, v66, v67
    s_waitcnt lgkmcnt(4)
    v_mfma_f32_16x16x32_bf16 v[112:115], v[44:47], v[240:243], v[112:115]
    v_mfma_f32_16x16x32_bf16 v[112:115], v[48:51], v[248:251], v[112:115]
    v_cvt_pk_bf16_f32 v14, v68, v69
    v_cvt_pk_bf16_f32 v15, v70, v71
    v_mfma_f32_16x16x32_bf16 v[120:123], v[44:47], v[244:247], v[120:123]
    ds_read_b128 v[44:47], v6 offset:36864
    v_mfma_f32_16x16x32_bf16 v[120:123], v[48:51], v[252:255], v[120:123]
    ds_read_b128 v[48:51], v7 offset:36864
    v_cvt_pk_bf16_f32 v16, v72, v73
    v_cvt_pk_bf16_f32 v17, v74, v75
    v_mfma_f32_16x16x32_bf16 v[116:119], v[52:55], v[240:243], v[116:119]
    v_mfma_f32_16x16x32_bf16 v[116:119], v[56:59], v[248:251], v[116:119]
    s_add_u32 m0, s48, 65536
    s_add_u32 s59, s51, 229376
    buffer_load_dwordx4 v3, s[4:7], s59 offen lds
    buffer_load_dwordx4 v4, s[4:7], s59 offen offset:1024 lds
    v_cvt_pk_bf16_f32 v18, v76, v77
    v_cvt_pk_bf16_f32 v19, v78, v79
    s_add_u32 s60, s54, 0
    buffer_store_dwordx4 v[12:15], v2, s[12:15], s60 offen offset:0 sc1
    v_mfma_f32_16x16x32_bf16 v[124:127], v[52:55], v[244:247], v[124:127]
    ds_read_b128 v[52:55], v6 offset:38912
    v_mfma_f32_16x16x32_bf16 v[124:127], v[56:59], v[252:255], v[124:127]
    ds_read_b128 v[56:59], v7 offset:38912
    s_add_u32 m0, s48, 67584
    s_add_u32 s59, s51, 245760
    buffer_load_dwordx4 v3, s[4:7], s59 offen lds
    buffer_load_dwordx4 v4, s[4:7], s59 offen offset:1024 lds
    s_waitcnt lgkmcnt(4)
    v_mfma_f32_16x16x32_bf16 v[64:67], v[28:31], v[128:131], 0
    v_mfma_f32_16x16x32_bf16 v[64:67], v[32:35], v[136:139], v[64:67]
    v_mfma_f32_16x16x32_bf16 v[72:75], v[28:31], v[132:135], 0
    ds_read_b128 v[28:31], v6 offset:40960
    v_mfma_f32_16x16x32_bf16 v[72:75], v[32:35], v[140:143], v[72:75]
    ds_read_b128 v[32:35], v7 offset:40960
    s_add_u32 s60, s54, 0
    buffer_store_dwordx4 v[16:19], v2, s[12:15], s60 offen offset:1024 sc1
    v_mfma_f32_16x16x32_bf16 v[68:71], v[36:39], v[128:131], 0
    v_mfma_f32_16x16x32_bf16 v[68:71], v[40:43], v[136:139], v[68:71]
    s_mov_b32 s16, s88
    s_and_b32 s17, s89, 0xffff
    s_mov_b32 s18, 0x400000
    s_mov_b32 s19, 0x00020000
    s_add_u32 s20, s86, 50331648
    s_addc_u32 s21, s87, 0
    s_and_b32 s21, s21, 0xffff
    s_mov_b32 s22, 0x1000000
    s_mov_b32 s23, 0x00020000
    v_lshrrev_b32 v60, 5, v1
    v_lshlrev_b32 v60, 5, v60
    v_xor_b32 v5, v5, v60
    v_lshrrev_b32 v8, 5, v1
    v_lshlrev_b32 v8, 12, v8
    v_bfe_u32 v60, v1, 4, 1
    v_lshl_add_u32 v8, v60, 9, v8
    v_lshl_add_u32 v8, v60, 5, v8
    v_bfe_u32 v60, v1, 2, 2
    v_lshl_add_u32 v8, v60, 6, v8
    v_and_b32 v60, 3, v1
    v_lshl_add_u32 v8, v60, 3, v8
    v_xor_b32 v9, 32, v8
    v_add_u32 v10, 0x10000, v8
    v_add_u32 v11, 0x10000, v9
    v_add_u32 v3, 131072, v2
    v_mfma_f32_16x16x32_bf16 v[76:79], v[36:39], v[132:135], 0
    ds_read_b128 v[36:39], v6 offset:43008
    v_mfma_f32_16x16x32_bf16 v[76:79], v[40:43], v[140:143], v[76:79]
    ds_read_b128 v[40:43], v7 offset:43008
    s_waitcnt lgkmcnt(4)
    v_mfma_f32_16x16x32_bf16 v[64:67], v[44:47], v[144:147], v[64:67]
    v_mfma_f32_16x16x32_bf16 v[64:67], v[48:51], v[152:155], v[64:67]
    v_mfma_f32_16x16x32_bf16 v[72:75], v[44:47], v[148:151], v[72:75]
    ds_read_b128 v[44:47], v6 offset:45056
    v_mfma_f32_16x16x32_bf16 v[72:75], v[48:51], v[156:159], v[72:75]
    ds_read_b128 v[48:51], v7 offset:45056
    v_mfma_f32_16x16x32_bf16 v[68:71], v[52:55], v[144:147], v[68:71]
    v_mfma_f32_16x16x32_bf16 v[68:71], v[56:59], v[152:155], v[68:71]
    v_mfma_f32_16x16x32_bf16 v[76:79], v[52:55], v[148:151], v[76:79]
    ds_read_b128 v[52:55], v6 offset:47104
    v_mfma_f32_16x16x32_bf16 v[76:79], v[56:59], v[156:159], v[76:79]
    ds_read_b128 v[56:59], v7 offset:47104
    s_waitcnt vmcnt(10)
    s_barrier
    s_waitcnt lgkmcnt(4)
    v_mfma_f32_16x16x32_bf16 v[64:67], v[28:31], v[160:163], v[64:67]
    v_mfma_f32_16x16x32_bf16 v[64:67], v[32:35], v[168:171], v[64:67]
    v_mfma_f32_16x16x32_bf16 v[72:75], v[28:31], v[164:167], v[72:75]
    ds_read_b128 v[28:31], v6 offset:49152
    v_mfma_f32_16x16x32_bf16 v[72:75], v[32:35], v[172:175], v[72:75]
    ds_read_b128 v[32:35], v7 offset:49152
    v_mfma_f32_16x16x32_bf16 v[68:71], v[36:39], v[160:163], v[68:71]
    v_mfma_f32_16x16x32_bf16 v[68:71], v[40:43], v[168:171], v[68:71]
    v_mfma_f32_16x16x32_bf16 v[76:79], v[36:39], v[164:167], v[76:79]
    ds_read_b128 v[36:39], v6 offset:51200
    v_mfma_f32_16x16x32_bf16 v[76:79], v[40:43], v[172:175], v[76:79]
    ds_read_b128 v[40:43], v7 offset:51200
    s_waitcnt lgkmcnt(4)
    v_mfma_f32_16x16x32_bf16 v[64:67], v[44:47], v[176:179], v[64:67]
    v_mfma_f32_16x16x32_bf16 v[64:67], v[48:51], v[184:187], v[64:67]
    v_mfma_f32_16x16x32_bf16 v[72:75], v[44:47], v[180:183], v[72:75]
    ds_read_b128 v[44:47], v6 offset:53248
    v_mfma_f32_16x16x32_bf16 v[72:75], v[48:51], v[188:191], v[72:75]
    ds_read_b128 v[48:51], v7 offset:53248
    v_cvt_pk_bf16_f32 v20, v80, v81
    v_cvt_pk_bf16_f32 v21, v82, v83
    v_mfma_f32_16x16x32_bf16 v[68:71], v[52:55], v[176:179], v[68:71]
    v_mfma_f32_16x16x32_bf16 v[68:71], v[56:59], v[184:187], v[68:71]
    s_add_u32 m0, s66, 0
    s_add_u32 s59, s65, 0
    buffer_load_dwordx4 v5, s[16:19], s59 offen lds
    v_cvt_pk_bf16_f32 v22, v84, v85
    v_cvt_pk_bf16_f32 v23, v86, v87
    v_mfma_f32_16x16x32_bf16 v[76:79], v[52:55], v[180:183], v[76:79]
    ds_read_b128 v[52:55], v6 offset:55296
    v_mfma_f32_16x16x32_bf16 v[76:79], v[56:59], v[188:191], v[76:79]
    ds_read_b128 v[56:59], v7 offset:55296
    s_add_u32 m0, s66, 1024
    s_add_u32 s59, s65, 64
    buffer_load_dwordx4 v5, s[16:19], s59 offen lds
    v_cvt_pk_bf16_f32 v24, v88, v89
    v_cvt_pk_bf16_f32 v25, v90, v91
    s_waitcnt lgkmcnt(4)
    v_mfma_f32_16x16x32_bf16 v[64:67], v[28:31], v[192:195], v[64:67]
    v_mfma_f32_16x16x32_bf16 v[64:67], v[32:35], v[200:203], v[64:67]
    s_add_u32 m0, s66, 2048
    s_add_u32 s59, s65, 128
    buffer_load_dwordx4 v5, s[16:19], s59 offen lds
    v_cvt_pk_bf16_f32 v26, v92, v93
    v_cvt_pk_bf16_f32 v27, v94, v95
    s_add_u32 s60, s54, 8192
    buffer_store_dwordx4 v[20:23], v2, s[12:15], s60 offen offset:0 sc1
    v_mfma_f32_16x16x32_bf16 v[72:75], v[28:31], v[196:199], v[72:75]
    ds_read_b128 v[28:31], v6 offset:57344
    v_mfma_f32_16x16x32_bf16 v[72:75], v[32:35], v[204:207], v[72:75]
    ds_read_b128 v[32:35], v7 offset:57344
    s_add_u32 m0, s66, 3072
    s_add_u32 s59, s65, 192
    buffer_load_dwordx4 v5, s[16:19], s59 offen lds
    v_mfma_f32_16x16x32_bf16 v[68:71], v[36:39], v[192:195], v[68:71]
    v_mfma_f32_16x16x32_bf16 v[68:71], v[40:43], v[200:203], v[68:71]
    v_mfma_f32_16x16x32_bf16 v[76:79], v[36:39], v[196:199], v[76:79]
    ds_read_b128 v[36:39], v6 offset:59392
    v_mfma_f32_16x16x32_bf16 v[76:79], v[40:43], v[204:207], v[76:79]
    ds_read_b128 v[40:43], v7 offset:59392
    s_add_u32 s60, s54, 8192
    buffer_store_dwordx4 v[24:27], v2, s[12:15], s60 offen offset:1024 sc1
    s_waitcnt lgkmcnt(4)
    v_mfma_f32_16x16x32_bf16 v[64:67], v[44:47], v[208:211], v[64:67]
    v_mfma_f32_16x16x32_bf16 v[64:67], v[48:51], v[216:219], v[64:67]
    v_mfma_f32_16x16x32_bf16 v[72:75], v[44:47], v[212:215], v[72:75]
    ds_read_b128 v[44:47], v6 offset:61440
    v_mfma_f32_16x16x32_bf16 v[72:75], v[48:51], v[220:223], v[72:75]
    ds_read_b128 v[48:51], v7 offset:61440
    v_mfma_f32_16x16x32_bf16 v[68:71], v[52:55], v[208:211], v[68:71]
    v_mfma_f32_16x16x32_bf16 v[68:71], v[56:59], v[216:219], v[68:71]
    v_mfma_f32_16x16x32_bf16 v[76:79], v[52:55], v[212:215], v[76:79]
    ds_read_b128 v[52:55], v6 offset:63488
    v_mfma_f32_16x16x32_bf16 v[76:79], v[56:59], v[220:223], v[76:79]
    ds_read_b128 v[56:59], v7 offset:63488
    s_waitcnt vmcnt(7)
    s_barrier
    s_waitcnt lgkmcnt(4)
    v_mfma_f32_16x16x32_bf16 v[64:67], v[28:31], v[224:227], v[64:67]
    v_mfma_f32_16x16x32_bf16 v[64:67], v[32:35], v[232:235], v[64:67]
    v_mfma_f32_16x16x32_bf16 v[72:75], v[28:31], v[228:231], v[72:75]
    v_add_u32 v6, 0x10000, v6
    v_add_u32 v7, 0x10000, v7
    ds_read_b128 v[28:31], v6 offset:0
    v_mfma_f32_16x16x32_bf16 v[72:75], v[32:35], v[236:239], v[72:75]
    ds_read_b128 v[32:35], v7 offset:0
    v_mfma_f32_16x16x32_bf16 v[68:71], v[36:39], v[224:227], v[68:71]
    v_mfma_f32_16x16x32_bf16 v[68:71], v[40:43], v[232:235], v[68:71]
    v_cvt_pk_bf16_f32 v12, v96, v97
    v_cvt_pk_bf16_f32 v13, v98, v99
    v_mfma_f32_16x16x32_bf16 v[76:79], v[36:39], v[228:231], v[76:79]
    ds_read_b128 v[36:39], v6 offset:2048
    v_mfma_f32_16x16x32_bf16 v[76:79], v[40:43], v[236:239], v[76:79]
    ds_read_b128 v[40:43], v7 offset:2048
    v_cvt_pk_bf16_f32 v14, v100, v101
    v_cvt_pk_bf16_f32 v15, v102, v103
    s_waitcnt lgkmcnt(4)
    v_mfma_f32_16x16x32_bf16 v[64:67], v[44:47], v[240:243], v[64:67]
    v_mfma_f32_16x16x32_bf16 v[64:67], v[48:51], v[248:251], v[64:67]
    v_cvt_pk_bf16_f32 v16, v104, v105
    v_cvt_pk_bf16_f32 v17, v106, v107
    v_mfma_f32_16x16x32_bf16 v[72:75], v[44:47], v[244:247], v[72:75]
    ds_read_b128 v[44:47], v6 offset:4096
    v_mfma_f32_16x16x32_bf16 v[72:75], v[48:51], v[252:255], v[72:75]
    ds_read_b128 v[48:51], v7 offset:4096
    v_cvt_pk_bf16_f32 v18, v108, v109
    v_cvt_pk_bf16_f32 v19, v110, v111
    s_add_u32 s60, s54, 16384
    buffer_store_dwordx4 v[12:15], v2, s[12:15], s60 offen offset:0 sc1
    v_mfma_f32_16x16x32_bf16 v[68:71], v[52:55], v[240:243], v[68:71]
    v_mfma_f32_16x16x32_bf16 v[68:71], v[56:59], v[248:251], v[68:71]
    v_mfma_f32_16x16x32_bf16 v[76:79], v[52:55], v[244:247], v[76:79]
    ds_read_b128 v[52:55], v6 offset:6144
    v_mfma_f32_16x16x32_bf16 v[76:79], v[56:59], v[252:255], v[76:79]
    ds_read_b128 v[56:59], v7 offset:6144
    s_waitcnt lgkmcnt(4)
    v_mfma_f32_16x16x32_bf16 v[80:83], v[28:31], v[128:131], 0
    v_mfma_f32_16x16x32_bf16 v[80:83], v[32:35], v[136:139], v[80:83]
    s_add_u32 s60, s54, 16384
    buffer_store_dwordx4 v[16:19], v2, s[12:15], s60 offen offset:1024 sc1
    v_mfma_f32_16x16x32_bf16 v[88:91], v[28:31], v[132:135], 0
    ds_read_b128 v[28:31], v6 offset:8192
    v_mfma_f32_16x16x32_bf16 v[88:91], v[32:35], v[140:143], v[88:91]
    ds_read_b128 v[32:35], v7 offset:8192
    v_mfma_f32_16x16x32_bf16 v[84:87], v[36:39], v[128:131], 0
    v_mfma_f32_16x16x32_bf16 v[84:87], v[40:43], v[136:139], v[84:87]
    v_mfma_f32_16x16x32_bf16 v[92:95], v[36:39], v[132:135], 0
    ds_read_b128 v[36:39], v6 offset:10240
    v_mfma_f32_16x16x32_bf16 v[92:95], v[40:43], v[140:143], v[92:95]
    ds_read_b128 v[40:43], v7 offset:10240
    s_waitcnt lgkmcnt(4)
    v_mfma_f32_16x16x32_bf16 v[80:83], v[44:47], v[144:147], v[80:83]
    v_mfma_f32_16x16x32_bf16 v[80:83], v[48:51], v[152:155], v[80:83]
    v_mfma_f32_16x16x32_bf16 v[88:91], v[44:47], v[148:151], v[88:91]
    ds_read_b128 v[44:47], v6 offset:12288
    v_mfma_f32_16x16x32_bf16 v[88:91], v[48:51], v[156:159], v[88:91]
    ds_read_b128 v[48:51], v7 offset:12288
    v_mfma_f32_16x16x32_bf16 v[84:87], v[52:55], v[144:147], v[84:87]
    v_mfma_f32_16x16x32_bf16 v[84:87], v[56:59], v[152:155], v[84:87]
    v_mfma_f32_16x16x32_bf16 v[92:95], v[52:55], v[148:151], v[92:95]
    ds_read_b128 v[52:55], v6 offset:14336
    v_mfma_f32_16x16x32_bf16 v[92:95], v[56:59], v[156:159], v[92:95]
    ds_read_b128 v[56:59], v7 offset:14336
    s_barrier
    s_waitcnt lgkmcnt(4)
    v_mfma_f32_16x16x32_bf16 v[80:83], v[28:31], v[160:163], v[80:83]
    v_mfma_f32_16x16x32_bf16 v[80:83], v[32:35], v[168:171], v[80:83]
    v_mfma_f32_16x16x32_bf16 v[88:91], v[28:31], v[164:167], v[88:91]
    ds_read_b128 v[28:31], v6 offset:16384
    v_mfma_f32_16x16x32_bf16 v[88:91], v[32:35], v[172:175], v[88:91]
    ds_read_b128 v[32:35], v7 offset:16384
    v_mfma_f32_16x16x32_bf16 v[84:87], v[36:39], v[160:163], v[84:87]
    v_mfma_f32_16x16x32_bf16 v[84:87], v[40:43], v[168:171], v[84:87]
    v_mfma_f32_16x16x32_bf16 v[92:95], v[36:39], v[164:167], v[92:95]
    ds_read_b128 v[36:39], v6 offset:18432
    v_mfma_f32_16x16x32_bf16 v[92:95], v[40:43], v[172:175], v[92:95]
    ds_read_b128 v[40:43], v7 offset:18432
    s_waitcnt lgkmcnt(4)
    v_mfma_f32_16x16x32_bf16 v[80:83], v[44:47], v[176:179], v[80:83]
    v_mfma_f32_16x16x32_bf16 v[80:83], v[48:51], v[184:187], v[80:83]
    v_mfma_f32_16x16x32_bf16 v[88:91], v[44:47], v[180:183], v[88:91]
    ds_read_b128 v[44:47], v6 offset:20480
    v_mfma_f32_16x16x32_bf16 v[88:91], v[48:51], v[188:191], v[88:91]
    ds_read_b128 v[48:51], v7 offset:20480
    v_cvt_pk_bf16_f32 v20, v112, v113
    v_cvt_pk_bf16_f32 v21, v114, v115
    v_mfma_f32_16x16x32_bf16 v[84:87], v[52:55], v[176:179], v[84:87]
    v_mfma_f32_16x16x32_bf16 v[84:87], v[56:59], v[184:187], v[84:87]
    s_add_u32 m0, s66, 32768
    s_add_u32 s59, s65, 1048576
    buffer_load_dwordx4 v5, s[16:19], s59 offen lds
    v_cvt_pk_bf16_f32 v22, v116, v117
    v_cvt_pk_bf16_f32 v23, v118, v119
    v_mfma_f32_16x16x32_bf16 v[92:95], v[52:55], v[180:183], v[92:95]
    ds_read_b128 v[52:55], v6 offset:22528
    v_mfma_f32_16x16x32_bf16 v[92:95], v[56:59], v[188:191], v[92:95]
    ds_read_b128 v[56:59], v7 offset:22528
    s_add_u32 m0, s66, 33792
    s_add_u32 s59, s65, 1048640
    buffer_load_dwordx4 v5, s[16:19], s59 offen lds
    v_cvt_pk_bf16_f32 v24, v120, v121
    v_cvt_pk_bf16_f32 v25, v122, v123
    s_waitcnt lgkmcnt(4)
    v_mfma_f32_16x16x32_bf16 v[80:83], v[28:31], v[192:195], v[80:83]
    v_mfma_f32_16x16x32_bf16 v[80:83], v[32:35], v[200:203], v[80:83]
    s_add_u32 m0, s66, 34816
    s_add_u32 s59, s65, 1048704
    buffer_load_dwordx4 v5, s[16:19], s59 offen lds
    v_cvt_pk_bf16_f32 v26, v124, v125
    v_cvt_pk_bf16_f32 v27, v126, v127
    s_add_u32 s60, s54, 24576
    buffer_store_dwordx4 v[20:23], v2, s[12:15], s60 offen offset:0 sc1
    v_mfma_f32_16x16x32_bf16 v[88:91], v[28:31], v[196:199], v[88:91]
    ds_read_b128 v[28:31], v6 offset:24576
    v_mfma_f32_16x16x32_bf16 v[88:91], v[32:35], v[204:207], v[88:91]
    ds_read_b128 v[32:35], v7 offset:24576
    s_add_u32 m0, s66, 35840
    s_add_u32 s59, s65, 1048768
    buffer_load_dwordx4 v5, s[16:19], s59 offen lds
    v_mfma_f32_16x16x32_bf16 v[84:87], v[36:39], v[192:195], v[84:87]
    v_mfma_f32_16x16x32_bf16 v[84:87], v[40:43], v[200:203], v[84:87]
    v_mfma_f32_16x16x32_bf16 v[92:95], v[36:39], v[196:199], v[92:95]
    ds_read_b128 v[36:39], v6 offset:26624
    v_mfma_f32_16x16x32_bf16 v[92:95], v[40:43], v[204:207], v[92:95]
    ds_read_b128 v[40:43], v7 offset:26624
    s_add_u32 s60, s54, 24576
    buffer_store_dwordx4 v[24:27], v2, s[12:15], s60 offen offset:1024 sc1
    s_waitcnt lgkmcnt(4)
    v_mfma_f32_16x16x32_bf16 v[80:83], v[44:47], v[208:211], v[80:83]
    v_mfma_f32_16x16x32_bf16 v[80:83], v[48:51], v[216:219], v[80:83]
    v_mfma_f32_16x16x32_bf16 v[88:91], v[44:47], v[212:215], v[88:91]
    ds_read_b128 v[44:47], v6 offset:28672
    v_mfma_f32_16x16x32_bf16 v[88:91], v[48:51], v[220:223], v[88:91]
    ds_read_b128 v[48:51], v7 offset:28672
    v_mfma_f32_16x16x32_bf16 v[84:87], v[52:55], v[208:211], v[84:87]
    v_mfma_f32_16x16x32_bf16 v[84:87], v[56:59], v[216:219], v[84:87]
    v_mfma_f32_16x16x32_bf16 v[92:95], v[52:55], v[212:215], v[92:95]
    ds_read_b128 v[52:55], v6 offset:30720
    v_mfma_f32_16x16x32_bf16 v[92:95], v[56:59], v[220:223], v[92:95]
    ds_read_b128 v[56:59], v7 offset:30720
    s_waitcnt lgkmcnt(4)
    v_mfma_f32_16x16x32_bf16 v[80:83], v[28:31], v[224:227], v[80:83]
    v_mfma_f32_16x16x32_bf16 v[80:83], v[32:35], v[232:235], v[80:83]
    v_cvt_pk_bf16_f32 v12, v64, v65
    v_cvt_pk_bf16_f32 v13, v66, v67
    v_mfma_f32_16x16x32_bf16 v[88:91], v[28:31], v[228:231], v[88:91]
    ds_read_b128 v[28:31], v6 offset:32768
    v_mfma_f32_16x16x32_bf16 v[88:91], v[32:35], v[236:239], v[88:91]
    ds_read_b128 v[32:35], v7 offset:32768
    v_cvt_pk_bf16_f32 v14, v68, v69
    v_cvt_pk_bf16_f32 v15, v70, v71
    v_mfma_f32_16x16x32_bf16 v[84:87], v[36:39], v[224:227], v[84:87]
    v_mfma_f32_16x16x32_bf16 v[84:87], v[40:43], v[232:235], v[84:87]
    v_cvt_pk_bf16_f32 v16, v72, v73
    v_cvt_pk_bf16_f32 v17, v74, v75
    v_mfma_f32_16x16x32_bf16 v[92:95], v[36:39], v[228:231], v[92:95]
    ds_read_b128 v[36:39], v6 offset:34816
    v_mfma_f32_16x16x32_bf16 v[92:95], v[40:43], v[236:239], v[92:95]
    ds_read_b128 v[40:43], v7 offset:34816
    v_cvt_pk_bf16_f32 v18, v76, v77
    v_cvt_pk_bf16_f32 v19, v78, v79
    s_add_u32 s60, s54, 32768
    buffer_store_dwordx4 v[12:15], v2, s[12:15], s60 offen offset:0 sc1
    s_waitcnt lgkmcnt(4)
    v_mfma_f32_16x16x32_bf16 v[80:83], v[44:47], v[240:243], v[80:83]
    v_mfma_f32_16x16x32_bf16 v[80:83], v[48:51], v[248:251], v[80:83]
    v_mfma_f32_16x16x32_bf16 v[88:91], v[44:47], v[244:247], v[88:91]
    ds_read_b128 v[44:47], v6 offset:36864
    v_mfma_f32_16x16x32_bf16 v[88:91], v[48:51], v[252:255], v[88:91]
    ds_read_b128 v[48:51], v7 offset:36864
    v_mfma_f32_16x16x32_bf16 v[84:87], v[52:55], v[240:243], v[84:87]
    v_mfma_f32_16x16x32_bf16 v[84:87], v[56:59], v[248:251], v[84:87]
    s_add_u32 s60, s54, 32768
    buffer_store_dwordx4 v[16:19], v2, s[12:15], s60 offen offset:1024 sc1
    v_mfma_f32_16x16x32_bf16 v[92:95], v[52:55], v[244:247], v[92:95]
    ds_read_b128 v[52:55], v6 offset:38912
    v_mfma_f32_16x16x32_bf16 v[92:95], v[56:59], v[252:255], v[92:95]
    ds_read_b128 v[56:59], v7 offset:38912
    s_waitcnt lgkmcnt(4)
    v_mfma_f32_16x16x32_bf16 v[96:99], v[28:31], v[128:131], 0
    v_mfma_f32_16x16x32_bf16 v[96:99], v[32:35], v[136:139], v[96:99]
    v_mfma_f32_16x16x32_bf16 v[104:107], v[28:31], v[132:135], 0
    ds_read_b128 v[28:31], v6 offset:40960
    v_mfma_f32_16x16x32_bf16 v[104:107], v[32:35], v[140:143], v[104:107]
    ds_read_b128 v[32:35], v7 offset:40960
    v_mfma_f32_16x16x32_bf16 v[100:103], v[36:39], v[128:131], 0
    v_mfma_f32_16x16x32_bf16 v[100:103], v[40:43], v[136:139], v[100:103]
    v_mfma_f32_16x16x32_bf16 v[108:111], v[36:39], v[132:135], 0
    ds_read_b128 v[36:39], v6 offset:43008
    v_mfma_f32_16x16x32_bf16 v[108:111], v[40:43], v[140:143], v[108:111]
    ds_read_b128 v[40:43], v7 offset:43008
    s_waitcnt lgkmcnt(4)
    v_mfma_f32_16x16x32_bf16 v[96:99], v[44:47], v[144:147], v[96:99]
    v_mfma_f32_16x16x32_bf16 v[96:99], v[48:51], v[152:155], v[96:99]
    v_mfma_f32_16x16x32_bf16 v[104:107], v[44:47], v[148:151], v[104:107]
    ds_read_b128 v[44:47], v6 offset:45056
    v_mfma_f32_16x16x32_bf16 v[104:107], v[48:51], v[156:159], v[104:107]
    ds_read_b128 v[48:51], v7 offset:45056
    v_mfma_f32_16x16x32_bf16 v[100:103], v[52:55], v[144:147], v[100:103]
    v_mfma_f32_16x16x32_bf16 v[100:103], v[56:59], v[152:155], v[100:103]
    v_mfma_f32_16x16x32_bf16 v[108:111], v[52:55], v[148:151], v[108:111]
    ds_read_b128 v[52:55], v6 offset:47104
    v_mfma_f32_16x16x32_bf16 v[108:111], v[56:59], v[156:159], v[108:111]
    ds_read_b128 v[56:59], v7 offset:47104
    s_barrier
    s_waitcnt lgkmcnt(4)
    v_mfma_f32_16x16x32_bf16 v[96:99], v[28:31], v[160:163], v[96:99]
    v_mfma_f32_16x16x32_bf16 v[96:99], v[32:35], v[168:171], v[96:99]
    v_mfma_f32_16x16x32_bf16 v[104:107], v[28:31], v[164:167], v[104:107]
    ds_read_b128 v[28:31], v6 offset:49152
    v_mfma_f32_16x16x32_bf16 v[104:107], v[32:35], v[172:175], v[104:107]
    ds_read_b128 v[32:35], v7 offset:49152
    v_mfma_f32_16x16x32_bf16 v[100:103], v[36:39], v[160:163], v[100:103]
    v_mfma_f32_16x16x32_bf16 v[100:103], v[40:43], v[168:171], v[100:103]
    v_mfma_f32_16x16x32_bf16 v[108:111], v[36:39], v[164:167], v[108:111]
    ds_read_b128 v[36:39], v6 offset:51200
    v_mfma_f32_16x16x32_bf16 v[108:111], v[40:43], v[172:175], v[108:111]
    ds_read_b128 v[40:43], v7 offset:51200
    s_waitcnt lgkmcnt(4)
    v_mfma_f32_16x16x32_bf16 v[96:99], v[44:47], v[176:179], v[96:99]
    v_mfma_f32_16x16x32_bf16 v[96:99], v[48:51], v[184:187], v[96:99]
    v_mfma_f32_16x16x32_bf16 v[104:107], v[44:47], v[180:183], v[104:107]
    ds_read_b128 v[44:47], v6 offset:53248
    v_mfma_f32_16x16x32_bf16 v[104:107], v[48:51], v[188:191], v[104:107]
    ds_read_b128 v[48:51], v7 offset:53248
    v_cvt_pk_bf16_f32 v20, v80, v81
    v_cvt_pk_bf16_f32 v21, v82, v83
    v_mfma_f32_16x16x32_bf16 v[100:103], v[52:55], v[176:179], v[100:103]
    v_mfma_f32_16x16x32_bf16 v[100:103], v[56:59], v[184:187], v[100:103]
    s_add_u32 m0, s66, 65536
    s_add_u32 s59, s65, 2097152
    buffer_load_dwordx4 v5, s[16:19], s59 offen lds
    v_cvt_pk_bf16_f32 v22, v84, v85
    v_cvt_pk_bf16_f32 v23, v86, v87
    v_mfma_f32_16x16x32_bf16 v[108:111], v[52:55], v[180:183], v[108:111]
    ds_read_b128 v[52:55], v6 offset:55296
    v_mfma_f32_16x16x32_bf16 v[108:111], v[56:59], v[188:191], v[108:111]
    ds_read_b128 v[56:59], v7 offset:55296
    s_add_u32 m0, s66, 66560
    s_add_u32 s59, s65, 2097216
    buffer_load_dwordx4 v5, s[16:19], s59 offen lds
    v_cvt_pk_bf16_f32 v24, v88, v89
    v_cvt_pk_bf16_f32 v25, v90, v91
    s_waitcnt lgkmcnt(4)
    v_mfma_f32_16x16x32_bf16 v[96:99], v[28:31], v[192:195], v[96:99]
    v_mfma_f32_16x16x32_bf16 v[96:99], v[32:35], v[200:203], v[96:99]
    s_add_u32 m0, s66, 67584
    s_add_u32 s59, s65, 2097280
    buffer_load_dwordx4 v5, s[16:19], s59 offen lds
    v_cvt_pk_bf16_f32 v26, v92, v93
    v_cvt_pk_bf16_f32 v27, v94, v95
    s_add_u32 s60, s54, 40960
    buffer_store_dwordx4 v[20:23], v2, s[12:15], s60 offen offset:0 sc1
    v_mfma_f32_16x16x32_bf16 v[104:107], v[28:31], v[196:199], v[104:107]
    ds_read_b128 v[28:31], v6 offset:57344
    v_mfma_f32_16x16x32_bf16 v[104:107], v[32:35], v[204:207], v[104:107]
    ds_read_b128 v[32:35], v7 offset:57344
    s_add_u32 m0, s66, 68608
    s_add_u32 s59, s65, 2097344
    buffer_load_dwordx4 v5, s[16:19], s59 offen lds
    v_mfma_f32_16x16x32_bf16 v[100:103], v[36:39], v[192:195], v[100:103]
    v_mfma_f32_16x16x32_bf16 v[100:103], v[40:43], v[200:203], v[100:103]
    v_mfma_f32_16x16x32_bf16 v[108:111], v[36:39], v[196:199], v[108:111]
    ds_read_b128 v[36:39], v6 offset:59392
    v_mfma_f32_16x16x32_bf16 v[108:111], v[40:43], v[204:207], v[108:111]
    ds_read_b128 v[40:43], v7 offset:59392
    s_add_u32 s60, s54, 40960
    buffer_store_dwordx4 v[24:27], v2, s[12:15], s60 offen offset:1024 sc1
    s_waitcnt lgkmcnt(4)
    v_mfma_f32_16x16x32_bf16 v[96:99], v[44:47], v[208:211], v[96:99]
    v_mfma_f32_16x16x32_bf16 v[96:99], v[48:51], v[216:219], v[96:99]
    v_mfma_f32_16x16x32_bf16 v[104:107], v[44:47], v[212:215], v[104:107]
    ds_read_b128 v[44:47], v6 offset:61440
    v_mfma_f32_16x16x32_bf16 v[104:107], v[48:51], v[220:223], v[104:107]
    ds_read_b128 v[48:51], v7 offset:61440
    v_mfma_f32_16x16x32_bf16 v[100:103], v[52:55], v[208:211], v[100:103]
    v_mfma_f32_16x16x32_bf16 v[100:103], v[56:59], v[216:219], v[100:103]
    v_mfma_f32_16x16x32_bf16 v[108:111], v[52:55], v[212:215], v[108:111]
    ds_read_b128 v[52:55], v6 offset:63488
    v_mfma_f32_16x16x32_bf16 v[108:111], v[56:59], v[220:223], v[108:111]
    ds_read_b128 v[56:59], v7 offset:63488
    s_waitcnt lgkmcnt(4)
    v_mfma_f32_16x16x32_bf16 v[96:99], v[28:31], v[224:227], v[96:99]
    v_mfma_f32_16x16x32_bf16 v[96:99], v[32:35], v[232:235], v[96:99]
    v_mfma_f32_16x16x32_bf16 v[104:107], v[28:31], v[228:231], v[104:107]
    v_add_u32 v6, 0x10000, v6
    v_add_u32 v7, 0x10000, v7
    ds_read_b128 v[28:31], v6 offset:0
    v_mfma_f32_16x16x32_bf16 v[104:107], v[32:35], v[236:239], v[104:107]
    ds_read_b128 v[32:35], v7 offset:0
    v_mfma_f32_16x16x32_bf16 v[100:103], v[36:39], v[224:227], v[100:103]
    v_mfma_f32_16x16x32_bf16 v[100:103], v[40:43], v[232:235], v[100:103]
    v_mfma_f32_16x16x32_bf16 v[108:111], v[36:39], v[228:231], v[108:111]
    ds_read_b128 v[36:39], v6 offset:2048
    v_mfma_f32_16x16x32_bf16 v[108:111], v[40:43], v[236:239], v[108:111]
    ds_read_b128 v[40:43], v7 offset:2048
    s_waitcnt lgkmcnt(4)
    v_mfma_f32_16x16x32_bf16 v[96:99], v[44:47], v[240:243], v[96:99]
    v_mfma_f32_16x16x32_bf16 v[96:99], v[48:51], v[248:251], v[96:99]
    v_mfma_f32_16x16x32_bf16 v[104:107], v[44:47], v[244:247], v[104:107]
    ds_read_b128 v[44:47], v6 offset:4096
    v_mfma_f32_16x16x32_bf16 v[104:107], v[48:51], v[252:255], v[104:107]
    ds_read_b128 v[48:51], v7 offset:4096
    v_mfma_f32_16x16x32_bf16 v[100:103], v[52:55], v[240:243], v[100:103]
    v_mfma_f32_16x16x32_bf16 v[100:103], v[56:59], v[248:251], v[100:103]
    v_mfma_f32_16x16x32_bf16 v[108:111], v[52:55], v[244:247], v[108:111]
    ds_read_b128 v[52:55], v6 offset:6144
    v_mfma_f32_16x16x32_bf16 v[108:111], v[56:59], v[252:255], v[108:111]
    ds_read_b128 v[56:59], v7 offset:6144
    s_waitcnt lgkmcnt(4)
    v_mfma_f32_16x16x32_bf16 v[112:115], v[28:31], v[128:131], 0
    v_mfma_f32_16x16x32_bf16 v[112:115], v[32:35], v[136:139], v[112:115]
    v_mfma_f32_16x16x32_bf16 v[120:123], v[28:31], v[132:135], 0
    ds_read_b128 v[28:31], v6 offset:8192
    v_mfma_f32_16x16x32_bf16 v[120:123], v[32:35], v[140:143], v[120:123]
    ds_read_b128 v[32:35], v7 offset:8192
    v_mfma_f32_16x16x32_bf16 v[116:119], v[36:39], v[128:131], 0
    v_mfma_f32_16x16x32_bf16 v[116:119], v[40:43], v[136:139], v[116:119]
    s_add_u32 s59, s67, 0
    buffer_load_dwordx4 v[128:131], v2, s[24:27], s59 offen offset:0 sc1
    v_mfma_f32_16x16x32_bf16 v[124:127], v[36:39], v[132:135], 0
    ds_read_b128 v[36:39], v6 offset:10240
    v_mfma_f32_16x16x32_bf16 v[124:127], v[40:43], v[140:143], v[124:127]
    ds_read_b128 v[40:43], v7 offset:10240
    s_add_u32 s59, s67, 0
    buffer_load_dwordx4 v[136:139], v2, s[24:27], s59 offen offset:1024 sc1
    s_waitcnt lgkmcnt(4)
    v_mfma_f32_16x16x32_bf16 v[112:115], v[44:47], v[144:147], v[112:115]
    v_mfma_f32_16x16x32_bf16 v[112:115], v[48:51], v[152:155], v[112:115]
    s_add_u32 s59, s67, 16384
    buffer_load_dwordx4 v[132:135], v2, s[24:27], s59 offen offset:0 sc1
    v_mfma_f32_16x16x32_bf16 v[120:123], v[44:47], v[148:151], v[120:123]
    ds_read_b128 v[44:47], v6 offset:12288
    v_mfma_f32_16x16x32_bf16 v[120:123], v[48:51], v[156:159], v[120:123]
    ds_read_b128 v[48:51], v7 offset:12288
    s_add_u32 s59, s67, 16384
    buffer_load_dwordx4 v[140:143], v2, s[24:27], s59 offen offset:1024 sc1
    v_mfma_f32_16x16x32_bf16 v[116:119], v[52:55], v[144:147], v[116:119]
    v_mfma_f32_16x16x32_bf16 v[116:119], v[56:59], v[152:155], v[116:119]
    s_add_u32 s59, s67, 0
    buffer_load_dwordx4 v[144:147], v2, s[24:27], s59 offen offset:2048 sc1
    v_mfma_f32_16x16x32_bf16 v[124:127], v[52:55], v[148:151], v[124:127]
    ds_read_b128 v[52:55], v6 offset:14336
    v_mfma_f32_16x16x32_bf16 v[124:127], v[56:59], v[156:159], v[124:127]
    ds_read_b128 v[56:59], v7 offset:14336
    s_add_u32 s59, s67, 0
    buffer_load_dwordx4 v[152:155], v2, s[24:27], s59 offen offset:3072 sc1
    s_waitcnt vmcnt(14)
    s_barrier
    s_waitcnt lgkmcnt(4)
    v_mfma_f32_16x16x32_bf16 v[112:115], v[28:31], v[160:163], v[112:115]
    v_mfma_f32_16x16x32_bf16 v[112:115], v[32:35], v[168:171], v[112:115]
    s_add_u32 s59, s67, 16384
    buffer_load_dwordx4 v[148:151], v2, s[24:27], s59 offen offset:2048 sc1
    v_mfma_f32_16x16x32_bf16 v[120:123], v[28:31], v[164:167], v[120:123]
    ds_read_b128 v[28:31], v6 offset:16384
    v_mfma_f32_16x16x32_bf16 v[120:123], v[32:35], v[172:175], v[120:123]
    ds_read_b128 v[32:35], v7 offset:16384
    s_add_u32 s59, s67, 16384
    buffer_load_dwordx4 v[156:159], v2, s[24:27], s59 offen offset:3072 sc1
    v_mfma_f32_16x16x32_bf16 v[116:119], v[36:39], v[160:163], v[116:119]
    v_mfma_f32_16x16x32_bf16 v[116:119], v[40:43], v[168:171], v[116:119]
    v_mfma_f32_16x16x32_bf16 v[124:127], v[36:39], v[164:167], v[124:127]
    ds_read_b128 v[36:39], v6 offset:18432
    v_mfma_f32_16x16x32_bf16 v[124:127], v[40:43], v[172:175], v[124:127]
    ds_read_b128 v[40:43], v7 offset:18432
    s_waitcnt lgkmcnt(4)
    v_mfma_f32_16x16x32_bf16 v[112:115], v[44:47], v[176:179], v[112:115]
    v_mfma_f32_16x16x32_bf16 v[112:115], v[48:51], v[184:187], v[112:115]
    s_add_u32 s59, s67, 4096
    buffer_load_dwordx4 v[160:163], v2, s[24:27], s59 offen offset:0 sc1
    v_mfma_f32_16x16x32_bf16 v[120:123], v[44:47], v[180:183], v[120:123]
    ds_read_b128 v[44:47], v6 offset:20480
    v_mfma_f32_16x16x32_bf16 v[120:123], v[48:51], v[188:191], v[120:123]
    ds_read_b128 v[48:51], v7 offset:20480
    v_cvt_pk_bf16_f32 v12, v96, v97
    v_cvt_pk_bf16_f32 v13, v98, v99
    v_mfma_f32_16x16x32_bf16 v[116:119], v[52:55], v[176:179], v[116:119]
    v_mfma_f32_16x16x32_bf16 v[116:119], v[56:59], v[184:187], v[116:119]
    s_add_u32 m0, s66, 98304
    s_add_u32 s59, s65, 3145728
    buffer_load_dwordx4 v5, s[16:19], s59 offen lds
    v_cvt_pk_bf16_f32 v14, v100, v101
    v_cvt_pk_bf16_f32 v15, v102, v103
    v_mfma_f32_16x16x32_bf16 v[124:127], v[52:55], v[180:183], v[124:127]
    ds_read_b128 v[52:55], v6 offset:22528
    v_mfma_f32_16x16x32_bf16 v[124:127], v[56:59], v[188:191], v[124:127]
    ds_read_b128 v[56:59], v7 offset:22528
    s_add_u32 m0, s66, 99328
    s_add_u32 s59, s65, 3145792
    buffer_load_dwordx4 v5, s[16:19], s59 offen lds
    v_cvt_pk_bf16_f32 v16, v104, v105
    v_cvt_pk_bf16_f32 v17, v106, v107
    s_waitcnt lgkmcnt(4)
    v_mfma_f32_16x16x32_bf16 v[112:115], v[28:31], v[192:195], v[112:115]
    v_mfma_f32_16x16x32_bf16 v[112:115], v[32:35], v[200:203], v[112:115]
    s_add_u32 s59, s67, 4096
    buffer_load_dwordx4 v[168:171], v2, s[24:27], s59 offen offset:1024 sc1
    s_add_u32 m0, s66, 100352
    s_add_u32 s59, s65, 3145856
    buffer_load_dwordx4 v5, s[16:19], s59 offen lds
    v_cvt_pk_bf16_f32 v18, v108, v109
    v_cvt_pk_bf16_f32 v19, v110, v111
    s_add_u32 s60, s54, 49152
    buffer_store_dwordx4 v[12:15], v2, s[12:15], s60 offen offset:0 sc1
    v_mfma_f32_16x16x32_bf16 v[120:123], v[28:31], v[196:199], v[120:123]
    ds_read_b128 v[28:31], v6 offset:24576
    v_mfma_f32_16x16x32_bf16 v[120:123], v[32:35], v[204:207], v[120:123]
    ds_read_b128 v[32:35], v7 offset:24576
    s_add_u32 m0, s66, 101376
    s_add_u32 s59, s65, 3145920
    buffer_load_dwordx4 v5, s[16:19], s59 offen lds
    v_mfma_f32_16x16x32_bf16 v[116:119], v[36:39], v[192:195], v[116:119]
    v_mfma_f32_16x16x32_bf16 v[116:119], v[40:43], v[200:203], v[116:119]
    v_mfma_f32_16x16x32_bf16 v[124:127], v[36:39], v[196:199], v[124:127]
    ds_read_b128 v[36:39], v6 offset:26624
    v_mfma_f32_16x16x32_bf16 v[124:127], v[40:43], v[204:207], v[124:127]
    ds_read_b128 v[40:43], v7 offset:26624
    s_add_u32 s60, s54, 49152
    buffer_store_dwordx4 v[16:19], v2, s[12:15], s60 offen offset:1024 sc1
    s_waitcnt lgkmcnt(4)
    v_mfma_f32_16x16x32_bf16 v[112:115], v[44:47], v[208:211], v[112:115]
    v_mfma_f32_16x16x32_bf16 v[112:115], v[48:51], v[216:219], v[112:115]
    s_add_u32 s59, s67, 20480
    buffer_load_dwordx4 v[164:167], v2, s[24:27], s59 offen offset:0 sc1
    v_mfma_f32_16x16x32_bf16 v[120:123], v[44:47], v[212:215], v[120:123]
    ds_read_b128 v[44:47], v6 offset:28672
    v_mfma_f32_16x16x32_bf16 v[120:123], v[48:51], v[220:223], v[120:123]
    ds_read_b128 v[48:51], v7 offset:28672
    v_mfma_f32_16x16x32_bf16 v[116:119], v[52:55], v[208:211], v[116:119]
    v_mfma_f32_16x16x32_bf16 v[116:119], v[56:59], v[216:219], v[116:119]
    v_mfma_f32_16x16x32_bf16 v[124:127], v[52:55], v[212:215], v[124:127]
    ds_read_b128 v[52:55], v6 offset:30720
    v_mfma_f32_16x16x32_bf16 v[124:127], v[56:59], v[220:223], v[124:127]
    ds_read_b128 v[56:59], v7 offset:30720
    s_waitcnt lgkmcnt(4)
    v_mfma_f32_16x16x32_bf16 v[112:115], v[28:31], v[224:227], v[112:115]
    v_mfma_f32_16x16x32_bf16 v[112:115], v[32:35], v[232:235], v[112:115]
    s_add_u32 s59, s67, 20480
    buffer_load_dwordx4 v[172:175], v2, s[24:27], s59 offen offset:1024 sc1
    v_mfma_f32_16x16x32_bf16 v[120:123], v[28:31], v[228:231], v[120:123]
    v_mfma_f32_16x16x32_bf16 v[120:123], v[32:35], v[236:239], v[120:123]
    v_mfma_f32_16x16x32_bf16 v[116:119], v[36:39], v[224:227], v[116:119]
    v_mfma_f32_16x16x32_bf16 v[116:119], v[40:43], v[232:235], v[116:119]
    v_mfma_f32_16x16x32_bf16 v[124:127], v[36:39], v[228:231], v[124:127]
    v_mfma_f32_16x16x32_bf16 v[124:127], v[40:43], v[236:239], v[124:127]
    s_waitcnt lgkmcnt(0)
    v_mfma_f32_16x16x32_bf16 v[112:115], v[44:47], v[240:243], v[112:115]
    ds_read_b64_tr_b16 v[28:29], v8 offset:0
    v_mfma_f32_16x16x32_bf16 v[112:115], v[48:51], v[248:251], v[112:115]
    s_add_u32 s59, s67, 4096
    buffer_load_dwordx4 v[176:179], v2, s[24:27], s59 offen offset:2048 sc1
    ds_read_b64_tr_b16 v[30:31], v8 offset:256
    v_mfma_f32_16x16x32_bf16 v[120:123], v[44:47], v[244:247], v[120:123]
    ds_read_b64_tr_b16 v[32:33], v8 offset:8192
    v_mfma_f32_16x16x32_bf16 v[120:123], v[48:51], v[252:255], v[120:123]
    ds_read_b64_tr_b16 v[34:35], v8 offset:8448
    v_mfma_f32_16x16x32_bf16 v[116:119], v[52:55], v[240:243], v[116:119]
    ds_read_b64_tr_b16 v[36:37], v8 offset:16384
    v_mfma_f32_16x16x32_bf16 v[116:119], v[56:59], v[248:251], v[116:119]
    ds_read_b64_tr_b16 v[38:39], v8 offset:16640
    v_mfma_f32_16x16x32_bf16 v[124:127], v[52:55], v[244:247], v[124:127]
    ds_read_b64_tr_b16 v[40:41], v8 offset:24576
    v_mfma_f32_16x16x32_bf16 v[124:127], v[56:59], v[252:255], v[124:127]
    ds_read_b64_tr_b16 v[42:43], v8 offset:24832
    s_waitcnt lgkmcnt(0)
    s_waitcnt vmcnt(13)
    v_mfma_f32_16x16x32_bf16 v[64:67], v[28:31], v[128:131], 0
    ds_read_b64_tr_b16 v[44:45], v9 offset:0
    ds_read_b64_tr_b16 v[46:47], v9 offset:256
    v_mfma_f32_16x16x32_bf16 v[64:67], v[32:35], v[136:139], v[64:67]
    ds_read_b64_tr_b16 v[48:49], v9 offset:8192
    ds_read_b64_tr_b16 v[50:51], v9 offset:8448
    v_mfma_f32_16x16x32_bf16 v[64:67], v[36:39], v[144:147], v[64:67]
    ds_read_b64_tr_b16 v[52:53], v9 offset:16384
    ds_read_b64_tr_b16 v[54:55], v9 offset:16640
    v_mfma_f32_16x16x32_bf16 v[64:67], v[40:43], v[152:155], v[64:67]
    ds_read_b64_tr_b16 v[56:57], v9 offset:24576
    ds_read_b64_tr_b16 v[58:59], v9 offset:24832
    s_waitcnt vmcnt(11)
    v_mfma_f32_16x16x32_bf16 v[68:71], v[28:31], v[132:135], 0
    s_add_u32 s59, s67, 4096
    buffer_load_dwordx4 v[184:187], v2, s[24:27], s59 offen offset:3072 sc1
    v_mfma_f32_16x16x32_bf16 v[68:71], v[32:35], v[140:143], v[68:71]
    v_mfma_f32_16x16x32_bf16 v[68:71], v[36:39], v[148:151], v[68:71]
    v_mfma_f32_16x16x32_bf16 v[68:71], v[40:43], v[156:159], v[68:71]
    v_cvt_pk_bf16_f32 v20, v112, v113
    v_cvt_pk_bf16_f32 v21, v114, v115
    s_waitcnt lgkmcnt(0)
    v_mfma_f32_16x16x32_bf16 v[72:75], v[44:47], v[128:131], 0
    ds_read_b64_tr_b16 v[28:29], v8 offset:1024
    ds_read_b64_tr_b16 v[30:31], v8 offset:1280
    v_mfma_f32_16x16x32_bf16 v[72:75], v[48:51], v[136:139], v[72:75]
    ds_read_b64_tr_b16 v[32:33], v8 offset:9216
    ds_read_b64_tr_b16 v[34:35], v8 offset:9472
    v_cvt_pk_bf16_f32 v22, v116, v117
    v_cvt_pk_bf16_f32 v23, v118, v119
    v_mfma_f32_16x16x32_bf16 v[72:75], v[52:55], v[144:147], v[72:75]
    ds_read_b64_tr_b16 v[36:37], v8 offset:17408
    ds_read_b64_tr_b16 v[38:39], v8 offset:17664
    v_mfma_f32_16x16x32_bf16 v[72:75], v[56:59], v[152:155], v[72:75]
    ds_read_b64_tr_b16 v[40:41], v8 offset:25600
    ds_read_b64_tr_b16 v[42:43], v8 offset:25856
    v_cvt_pk_bf16_f32 v24, v120, v121
    v_cvt_pk_bf16_f32 v25, v122, v123
    v_mfma_f32_16x16x32_bf16 v[76:79], v[44:47], v[132:135], 0
    s_add_u32 s59, s67, 20480
    buffer_load_dwordx4 v[180:183], v2, s[24:27], s59 offen offset:2048 sc1
    v_mfma_f32_16x16x32_bf16 v[76:79], v[48:51], v[140:143], v[76:79]
    v_cvt_pk_bf16_f32 v26, v124, v125
    v_cvt_pk_bf16_f32 v27, v126, v127
    s_add_u32 s60, s54, 57344
    buffer_store_dwordx4 v[20:23], v2, s[12:15], s60 offen offset:0 sc1
    v_mfma_f32_16x16x32_bf16 v[76:79], v[52:55], v[148:151], v[76:79]
    v_mfma_f32_16x16x32_bf16 v[76:79], v[56:59], v[156:159], v[76:79]
    s_waitcnt lgkmcnt(0)
    v_mfma_f32_16x16x32_bf16 v[80:83], v[28:31], v[128:131], 0
    ds_read_b64_tr_b16 v[44:45], v9 offset:1024
    ds_read_b64_tr_b16 v[46:47], v9 offset:1280
    v_mfma_f32_16x16x32_bf16 v[80:83], v[32:35], v[136:139], v[80:83]
    ds_read_b64_tr_b16 v[48:49], v9 offset:9216
    ds_read_b64_tr_b16 v[50:51], v9 offset:9472
    v_mfma_f32_16x16x32_bf16 v[80:83], v[36:39], v[144:147], v[80:83]
    ds_read_b64_tr_b16 v[52:53], v9 offset:17408
    ds_read_b64_tr_b16 v[54:55], v9 offset:17664
    v_mfma_f32_16x16x32_bf16 v[80:83], v[40:43], v[152:155], v[80:83]
    ds_read_b64_tr_b16 v[56:57], v9 offset:25600
    ds_read_b64_tr_b16 v[58:59], v9 offset:25856
    s_add_u32 s60, s54, 57344
    buffer_store_dwordx4 v[24:27], v2, s[12:15], s60 offen offset:1024 sc1
    v_mfma_f32_16x16x32_bf16 v[84:87], v[28:31], v[132:135], 0
    s_add_u32 s59, s67, 20480
    buffer_load_dwordx4 v[188:191], v2, s[24:27], s59 offen offset:3072 sc1
    v_mfma_f32_16x16x32_bf16 v[84:87], v[32:35], v[140:143], v[84:87]
    v_mfma_f32_16x16x32_bf16 v[84:87], v[36:39], v[148:151], v[84:87]
    v_mfma_f32_16x16x32_bf16 v[84:87], v[40:43], v[156:159], v[84:87]
    s_waitcnt lgkmcnt(0)
    v_mfma_f32_16x16x32_bf16 v[88:91], v[44:47], v[128:131], 0
    ds_read_b64_tr_b16 v[28:29], v8 offset:2048
    ds_read_b64_tr_b16 v[30:31], v8 offset:2304
    v_mfma_f32_16x16x32_bf16 v[88:91], v[48:51], v[136:139], v[88:91]
    ds_read_b64_tr_b16 v[32:33], v8 offset:10240
    ds_read_b64_tr_b16 v[34:35], v8 offset:10496
    v_mfma_f32_16x16x32_bf16 v[88:91], v[52:55], v[144:147], v[88:91]
    ds_read_b64_tr_b16 v[36:37], v8 offset:18432
    ds_read_b64_tr_b16 v[38:39], v8 offset:18688
    v_mfma_f32_16x16x32_bf16 v[88:91], v[56:59], v[152:155], v[88:91]
    ds_read_b64_tr_b16 v[40:41], v8 offset:26624
    ds_read_b64_tr_b16 v[42:43], v8 offset:26880
    v_mfma_f32_16x16x32_bf16 v[92:95], v[44:47], v[132:135], 0
    s_add_u32 s59, s67, 8192
    buffer_load_dwordx4 v[192:195], v2, s[24:27], s59 offen offset:0 sc1
    v_mfma_f32_16x16x32_bf16 v[92:95], v[48:51], v[140:143], v[92:95]
    v_mfma_f32_16x16x32_bf16 v[92:95], v[52:55], v[148:151], v[92:95]
    v_mfma_f32_16x16x32_bf16 v[92:95], v[56:59], v[156:159], v[92:95]
    s_cmp_lg_u32 s40, 4
    s_cbranch_scc1 KFP_33
    v_and_b32 v63, 7, v1
    v_lshlrev_b32 v63, 2, v63
    buffer_load_dword v63, v63, s[24:27], s76 offen sc1
KFP_33:
    s_waitcnt lgkmcnt(0)
    v_mfma_f32_16x16x32_bf16 v[96:99], v[28:31], v[128:131], 0
    ds_read_b64_tr_b16 v[44:45], v9 offset:2048
    ds_read_b64_tr_b16 v[46:47], v9 offset:2304
    v_mfma_f32_16x16x32_bf16 v[96:99], v[32:35], v[136:139], v[96:99]
    ds_read_b64_tr_b16 v[48:49], v9 offset:10240
    ds_read_b64_tr_b16 v[50:51], v9 offset:10496
    v_mfma_f32_16x16x32_bf16 v[96:99], v[36:39], v[144:147], v[96:99]
    ds_read_b64_tr_b16 v[52:53], v9 offset:18432
    ds_read_b64_tr_b16 v[54:55], v9 offset:18688
    v_mfma_f32_16x16x32_bf16 v[96:99], v[40:43], v[152:155], v[96:99]
    ds_read_b64_tr_b16 v[56:57], v9 offset:26624
    ds_read_b64_tr_b16 v[58:59], v9 offset:26880
    v_mfma_f32_16x16x32_bf16 v[100:103], v[28:31], v[132:135], 0
    s_add_u32 s59, s67, 8192
    buffer_load_dwordx4 v[200:203], v2, s[24:27], s59 offen offset:1024 sc1
    v_mfma_f32_16x16x32_bf16 v[100:103], v[32:35], v[140:143], v[100:103]
    v_mfma_f32_16x16x32_bf16 v[100:103], v[36:39], v[148:151], v[100:103]
    v_mfma_f32_16x16x32_bf16 v[100:103], v[40:43], v[156:159], v[100:103]
    s_waitcnt lgkmcnt(0)
    v_mfma_f32_16x16x32_bf16 v[104:107], v[44:47], v[128:131], 0
    ds_read_b64_tr_b16 v[28:29], v8 offset:3072
    ds_read_b64_tr_b16 v[30:31], v8 offset:3328
    v_mfma_f32_16x16x32_bf16 v[104:107], v[48:51], v[136:139], v[104:107]
    ds_read_b64_tr_b16 v[32:33], v8 offset:11264
    ds_read_b64_tr_b16 v[34:35], v8 offset:11520
    v_mfma_f32_16x16x32_bf16 v[104:107], v[52:55], v[144:147], v[104:107]
    ds_read_b64_tr_b16 v[36:37], v8 offset:19456
    ds_read_b64_tr_b16 v[38:39], v8 offset:19712
    v_mfma_f32_16x16x32_bf16 v[104:107], v[56:59], v[152:155], v[104:107]
    ds_read_b64_tr_b16 v[40:41], v8 offset:27648
    ds_read_b64_tr_b16 v[42:43], v8 offset:27904
    v_mfma_f32_16x16x32_bf16 v[108:111], v[44:47], v[132:135], 0
    s_add_u32 s59, s67, 24576
    buffer_load_dwordx4 v[196:199], v2, s[24:27], s59 offen offset:0 sc1
    v_mfma_f32_16x16x32_bf16 v[108:111], v[48:51], v[140:143], v[108:111]
    v_mfma_f32_16x16x32_bf16 v[108:111], v[52:55], v[148:151], v[108:111]
    v_mfma_f32_16x16x32_bf16 v[108:111], v[56:59], v[156:159], v[108:111]
    s_waitcnt lgkmcnt(0)
    v_mfma_f32_16x16x32_bf16 v[112:115], v[28:31], v[128:131], 0
    ds_read_b64_tr_b16 v[44:45], v9 offset:3072
    ds_read_b64_tr_b16 v[46:47], v9 offset:3328
    v_mfma_f32_16x16x32_bf16 v[112:115], v[32:35], v[136:139], v[112:115]
    ds_read_b64_tr_b16 v[48:49], v9 offset:11264
    ds_read_b64_tr_b16 v[50:51], v9 offset:11520
    v_mfma_f32_16x16x32_bf16 v[112:115], v[36:39], v[144:147], v[112:115]
    ds_read_b64_tr_b16 v[52:53], v9 offset:19456
    ds_read_b64_tr_b16 v[54:55], v9 offset:19712
    v_mfma_f32_16x16x32_bf16 v[112:115], v[40:43], v[152:155], v[112:115]
    ds_read_b64_tr_b16 v[56:57], v9 offset:27648
    ds_read_b64_tr_b16 v[58:59], v9 offset:27904
    v_mfma_f32_16x16x32_bf16 v[116:119], v[28:31], v[132:135], 0
    s_add_u32 s59, s67, 24576
    buffer_load_dwordx4 v[204:207], v2, s[24:27], s59 offen offset:1024 sc1
    v_mfma_f32_16x16x32_bf16 v[116:119], v[32:35], v[140:143], v[116:119]
    v_mfma_f32_16x16x32_bf16 v[116:119], v[36:39], v[148:151], v[116:119]
    v_mfma_f32_16x16x32_bf16 v[116:119], v[40:43], v[156:159], v[116:119]
    s_cmp_lg_u32 s40, 4
    s_cbranch_scc1 KFR_35
    s_waitcnt vmcnt(3)
    v_cmp_gt_u32 vcc, 1, v63
    s_nop 0
    s_bitcmp0_b32 vcc_lo, 0
    s_cbranch_scc0 KFS_34
KFR_35:
    s_waitcnt vmcnt(5)
    s_barrier
    s_waitcnt lgkmcnt(0)
    v_mfma_f32_16x16x32_bf16 v[120:123], v[44:47], v[128:131], 0
    ds_read_b64_tr_b16 v[28:29], v8 offset:32768
    ds_read_b64_tr_b16 v[30:31], v8 offset:33024
    v_mfma_f32_16x16x32_bf16 v[120:123], v[48:51], v[136:139], v[120:123]
    ds_read_b64_tr_b16 v[32:33], v8 offset:40960
    ds_read_b64_tr_b16 v[34:35], v8 offset:41216
    v_mfma_f32_16x16x32_bf16 v[120:123], v[52:55], v[144:147], v[120:123]
    ds_read_b64_tr_b16 v[36:37], v8 offset:49152
    ds_read_b64_tr_b16 v[38:39], v8 offset:49408
    v_mfma_f32_16x16x32_bf16 v[120:123], v[56:59], v[152:155], v[120:123]
    ds_read_b64_tr_b16 v[40:41], v8 offset:57344
    ds_read_b64_tr_b16 v[42:43], v8 offset:57600
    v_mfma_f32_16x16x32_bf16 v[124:127], v[44:47], v[132:135], 0
    s_add_u32 s59, s67, 8192
    buffer_load_dwordx4 v[208:211], v2, s[24:27], s59 offen offset:2048 sc1
    v_mfma_f32_16x16x32_bf16 v[124:127], v[48:51], v[140:143], v[124:127]
    v_mfma_f32_16x16x32_bf16 v[124:127], v[52:55], v[148:151], v[124:127]
    s_add_u32 m0, s69, 131072
    s_nop 0
    buffer_load_dwordx4 v2, s[28:31], s68 offen offset:0 sc1 lds
    v_mfma_f32_16x16x32_bf16 v[124:127], v[56:59], v[156:159], v[124:127]
    s_waitcnt lgkmcnt(0)
    v_mfma_f32_16x16x32_bf16 v[64:67], v[28:31], v[160:163], v[64:67]
    ds_read_b64_tr_b16 v[44:45], v9 offset:32768
    ds_read_b64_tr_b16 v[46:47], v9 offset:33024
    v_mfma_f32_16x16x32_bf16 v[64:67], v[32:35], v[168:171], v[64:67]
    ds_read_b64_tr_b16 v[48:49], v9 offset:40960
    ds_read_b64_tr_b16 v[50:51], v9 offset:41216
    v_mfma_f32_16x16x32_bf16 v[64:67], v[36:39], v[176:179], v[64:67]
    ds_read_b64_tr_b16 v[52:53], v9 offset:49152
    ds_read_b64_tr_b16 v[54:55], v9 offset:49408
    v_mfma_f32_16x16x32_bf16 v[64:67], v[40:43], v[184:187], v[64:67]
    ds_read_b64_tr_b16 v[56:57], v9 offset:57344
    ds_read_b64_tr_b16 v[58:59], v9 offset:57600
    s_waitcnt vmcnt(6)
    v_mfma_f32_16x16x32_bf16 v[68:71], v[28:31], v[164:167], v[68:71]
    s_add_u32 s59, s67, 8192
    buffer_load_dwordx4 v[216:219], v2, s[24:27], s59 offen offset:3072 sc1
    v_mfma_f32_16x16x32_bf16 v[68:71], v[32:35], v[172:175], v[68:71]
    v_mfma_f32_16x16x32_bf16 v[68:71], v[36:39], v[180:183], v[68:71]
    buffer_load_dwordx4 v2, s[28:31], s68 offen offset:1024 sc1 lds
    v_mfma_f32_16x16x32_bf16 v[68:71], v[40:43], v[188:191], v[68:71]
    v_lshlrev_b32 v60, 2, v1
    s_lshl_b32 s59, s40, 8
    s_add_u32 s59, s59, 147456
    v_add_u32 v14, s59, v60
    s_lshl_b32 s59, s43, 8
    s_add_u32 s59, s59, 149504
    v_add_u32 v19, s59, v60
    v_add_u32 v21, 1024, v19
    v_and_b32 v60, 3, v1
    v_mul_u32_u24 v60, 260, v60
    v_add_u32 v12, 149504, v60
    v_add_u32 v22, 150528, v60
    v_and_b32 v60, 7, v1
    v_mul_u32_u24 v60, 260, v60
    v_add_u32 v17, 147456, v60
    v_mov_b32 v16, 0
    v_mov_b32 v20, 0
    ds_write_b32 v14, v16
    ds_write_b32 v19, v20
    ds_write_b32 v21, v16
    s_mov_b32 s55, s59
    s_lshl_b32 s56, s2, 8
    s_add_u32 s56, s56, 2162688
    s_waitcnt lgkmcnt(3)
    v_mfma_f32_16x16x32_bf16 v[72:75], v[44:47], v[160:163], v[72:75]
    ds_read_b64_tr_b16 v[28:29], v8 offset:33792
    ds_read_b64_tr_b16 v[30:31], v8 offset:34048
    v_mfma_f32_16x16x32_bf16 v[72:75], v[48:51], v[168:171], v[72:75]
    ds_read_b64_tr_b16 v[32:33], v8 offset:41984
    ds_read_b64_tr_b16 v[34:35], v8 offset:42240
    v_mfma_f32_16x16x32_bf16 v[72:75], v[52:55], v[176:179], v[72:75]
    ds_read_b64_tr_b16 v[36:37], v8 offset:50176
    ds_read_b64_tr_b16 v[38:39], v8 offset:50432
    v_mfma_f32_16x16x32_bf16 v[72:75], v[56:59], v[184:187], v[72:75]
    ds_read_b64_tr_b16 v[40:41], v8 offset:58368
    ds_read_b64_tr_b16 v[42:43], v8 offset:58624
    v_mfma_f32_16x16x32_bf16 v[76:79], v[44:47], v[164:167], v[76:79]
    s_add_u32 s59, s67, 24576
    buffer_load_dwordx4 v[212:215], v2, s[24:27], s59 offen offset:2048 sc1
    v_mfma_f32_16x16x32_bf16 v[76:79], v[48:51], v[172:175], v[76:79]
    v_mfma_f32_16x16x32_bf16 v[76:79], v[52:55], v[180:183], v[76:79]
    buffer_load_dwordx4 v2, s[28:31], s68 offen offset:2048 sc1 lds
    v_mfma_f32_16x16x32_bf16 v[76:79], v[56:59], v[188:191], v[76:79]
    s_waitcnt lgkmcnt(0)
    v_mfma_f32_16x16x32_bf16 v[80:83], v[28:31], v[160:163], v[80:83]
    ds_read_b64_tr_b16 v[44:45], v9 offset:33792
    ds_read_b64_tr_b16 v[46:47], v9 offset:34048
    v_mfma_f32_16x16x32_bf16 v[80:83], v[32:35], v[168:171], v[80:83]
    ds_read_b64_tr_b16 v[48:49], v9 offset:41984
    ds_read_b64_tr_b16 v[50:51], v9 offset:42240
    v_mfma_f32_16x16x32_bf16 v[80:83], v[36:39], v[176:179], v[80:83]
    ds_read_b64_tr_b16 v[52:53], v9 offset:50176
    ds_read_b64_tr_b16 v[54:55], v9 offset:50432
    v_mfma_f32_16x16x32_bf16 v[80:83], v[40:43], v[184:187], v[80:83]
    ds_read_b64_tr_b16 v[56:57], v9 offset:58368
    ds_read_b64_tr_b16 v[58:59], v9 offset:58624
    v_mfma_f32_16x16x32_bf16 v[84:87], v[28:31], v[164:167], v[84:87]
    s_add_u32 s59, s67, 24576
    buffer_load_dwordx4 v[220:223], v2, s[24:27], s59 offen offset:3072 sc1
    v_mfma_f32_16x16x32_bf16 v[84:87], v[32:35], v[172:175], v[84:87]
    v_mfma_f32_16x16x32_bf16 v[84:87], v[36:39], v[180:183], v[84:87]
    buffer_load_dwordx4 v2, s[28:31], s68 offen offset:3072 sc1 lds
    v_mfma_f32_16x16x32_bf16 v[84:87], v[40:43], v[188:191], v[84:87]
    s_waitcnt lgkmcnt(0)
    v_mfma_f32_16x16x32_bf16 v[88:91], v[44:47], v[160:163], v[88:91]
    ds_read_b64_tr_b16 v[28:29], v8 offset:34816
    ds_read_b64_tr_b16 v[30:31], v8 offset:35072
    v_mfma_f32_16x16x32_bf16 v[88:91], v[48:51], v[168:171], v[88:91]
    ds_read_b64_tr_b16 v[32:33], v8 offset:43008
    ds_read_b64_tr_b16 v[34:35], v8 offset:43264
    v_mfma_f32_16x16x32_bf16 v[88:91], v[52:55], v[176:179], v[88:91]
    ds_read_b64_tr_b16 v[36:37], v8 offset:51200
    ds_read_b64_tr_b16 v[38:39], v8 offset:51456
    v_mfma_f32_16x16x32_bf16 v[88:91], v[56:59], v[184:187], v[88:91]
    ds_read_b64_tr_b16 v[40:41], v8 offset:59392
    ds_read_b64_tr_b16 v[42:43], v8 offset:59648
    v_mfma_f32_16x16x32_bf16 v[92:95], v[44:47], v[164:167], v[92:95]
    s_add_u32 s59, s67, 12288
    buffer_load_dwordx4 v[224:227], v2, s[24:27], s59 offen offset:0 sc1
    v_mfma_f32_16x16x32_bf16 v[92:95], v[48:51], v[172:175], v[92:95]
    v_mfma_f32_16x16x32_bf16 v[92:95], v[52:55], v[180:183], v[92:95]
    v_mfma_f32_16x16x32_bf16 v[92:95], v[56:59], v[188:191], v[92:95]
    s_waitcnt lgkmcnt(0)
    v_mfma_f32_16x16x32_bf16 v[96:99], v[28:31], v[160:163], v[96:99]
    ds_read_b64_tr_b16 v[44:45], v9 offset:34816
    ds_read_b64_tr_b16 v[46:47], v9 offset:35072
    v_mfma_f32_16x16x32_bf16 v[96:99], v[32:35], v[168:171], v[96:99]
    ds_read_b64_tr_b16 v[48:49], v9 offset:43008
    ds_read_b64_tr_b16 v[50:51], v9 offset:43264
    v_mfma_f32_16x16x32_bf16 v[96:99], v[36:39], v[176:179], v[96:99]
    ds_read_b64_tr_b16 v[52:53], v9 offset:51200
    ds_read_b64_tr_b16 v[54:55], v9 offset:51456
    v_mfma_f32_16x16x32_bf16 v[96:99], v[40:43], v[184:187], v[96:99]
    ds_read_b64_tr_b16 v[56:57], v9 offset:59392
    ds_read_b64_tr_b16 v[58:59], v9 offset:59648
    v_mfma_f32_16x16x32_bf16 v[100:103], v[28:31], v[164:167], v[100:103]
    s_add_u32 s59, s67, 12288
    buffer_load_dwordx4 v[232:235], v2, s[24:27], s59 offen offset:1024 sc1
    v_mfma_f32_16x16x32_bf16 v[100:103], v[32:35], v[172:175], v[100:103]
    v_mfma_f32_16x16x32_bf16 v[100:103], v[36:39], v[180:183], v[100:103]
    v_mfma_f32_16x16x32_bf16 v[100:103], v[40:43], v[188:191], v[100:103]
    s_waitcnt lgkmcnt(0)
    v_mfma_f32_16x16x32_bf16 v[104:107], v[44:47], v[160:163], v[104:107]
    ds_read_b64_tr_b16 v[28:29], v8 offset:35840
    ds_read_b64_tr_b16 v[30:31], v8 offset:36096
    v_mfma_f32_16x16x32_bf16 v[104:107], v[48:51], v[168:171], v[104:107]
    ds_read_b64_tr_b16 v[32:33], v8 offset:44032
    ds_read_b64_tr_b16 v[34:35], v8 offset:44288
    v_mfma_f32_16x16x32_bf16 v[104:107], v[52:55], v[176:179], v[104:107]
    ds_read_b64_tr_b16 v[36:37], v8 offset:52224
    ds_read_b64_tr_b16 v[38:39], v8 offset:52480
    v_mfma_f32_16x16x32_bf16 v[104:107], v[56:59], v[184:187], v[104:107]
    ds_read_b64_tr_b16 v[40:41], v8 offset:60416
    ds_read_b64_tr_b16 v[42:43], v8 offset:60672
    v_mfma_f32_16x16x32_bf16 v[108:111], v[44:47], v[164:167], v[108:111]
    s_add_u32 s59, s67, 28672
    buffer_load_dwordx4 v[228:231], v2, s[24:27], s59 offen offset:0 sc1
    v_mfma_f32_16x16x32_bf16 v[108:111], v[48:51], v[172:175], v[108:111]
    v_mfma_f32_16x16x32_bf16 v[108:111], v[52:55], v[180:183], v[108:111]
    v_mfma_f32_16x16x32_bf16 v[108:111], v[56:59], v[188:191], v[108:111]
    s_waitcnt lgkmcnt(0)
    v_mfma_f32_16x16x32_bf16 v[112:115], v[28:31], v[160:163], v[112:115]
    ds_read_b64_tr_b16 v[44:45], v9 offset:35840
    ds_read_b64_tr_b16 v[46:47], v9 offset:36096
    v_mfma_f32_16x16x32_bf16 v[112:115], v[32:35], v[168:171], v[112:115]
    ds_read_b64_tr_b16 v[48:49], v9 offset:44032
    ds_read_b64_tr_b16 v[50:51], v9 offset:44288
    v_mfma_f32_16x16x32_bf16 v[112:115], v[36:39], v[176:179], v[112:115]
    ds_read_b64_tr_b16 v[52:53], v9 offset:52224
    ds_read_b64_tr_b16 v[54:55], v9 offset:52480
    v_mfma_f32_16x16x32_bf16 v[112:115], v[40:43], v[184:187], v[112:115]
    ds_read_b64_tr_b16 v[56:57], v9 offset:60416
    ds_read_b64_tr_b16 v[58:59], v9 offset:60672
    v_mfma_f32_16x16x32_bf16 v[116:119], v[28:31], v[164:167], v[116:119]
    s_add_u32 s59, s67, 28672
    buffer_load_dwordx4 v[236:239], v2, s[24:27], s59 offen offset:1024 sc1
    v_mfma_f32_16x16x32_bf16 v[116:119], v[32:35], v[172:175], v[116:119]
    v_mfma_f32_16x16x32_bf16 v[116:119], v[36:39], v[180:183], v[116:119]
    v_mfma_f32_16x16x32_bf16 v[116:119], v[40:43], v[188:191], v[116:119]
    s_barrier
    s_waitcnt lgkmcnt(0)
    v_mfma_f32_16x16x32_bf16 v[120:123], v[44:47], v[160:163], v[120:123]
    ds_read_b64_tr_b16 v[28:29], v10 offset:0
    ds_read_b64_tr_b16 v[30:31], v10 offset:256
    v_mfma_f32_16x16x32_bf16 v[120:123], v[48:51], v[168:171], v[120:123]
    ds_read_b64_tr_b16 v[32:33], v10 offset:8192
    ds_read_b64_tr_b16 v[34:35], v10 offset:8448
    v_mfma_f32_16x16x32_bf16 v[120:123], v[52:55], v[176:179], v[120:123]
    ds_read_b64_tr_b16 v[36:37], v10 offset:16384
    ds_read_b64_tr_b16 v[38:39], v10 offset:16640
    v_mfma_f32_16x16x32_bf16 v[120:123], v[56:59], v[184:187], v[120:123]
    ds_read_b64_tr_b16 v[40:41], v10 offset:24576
    ds_read_b64_tr_b16 v[42:43], v10 offset:24832
    v_mfma_f32_16x16x32_bf16 v[124:127], v[44:47], v[164:167], v[124:127]
    s_add_u32 s59, s67, 12288
    buffer_load_dwordx4 v[240:243], v2, s[24:27], s59 offen offset:2048 sc1
    v_mfma_f32_16x16x32_bf16 v[124:127], v[48:51], v[172:175], v[124:127]
    s_add_u32 m0, s69, 0
    s_nop 0
    buffer_load_dwordx4 v2, s[32:35], s68 offen offset:0 sc1 lds
    v_mfma_f32_16x16x32_bf16 v[124:127], v[52:55], v[180:183], v[124:127]
    buffer_load_dwordx4 v2, s[32:35], s68 offen offset:1024 sc1 lds
    v_mfma_f32_16x16x32_bf16 v[124:127], v[56:59], v[188:191], v[124:127]
    s_waitcnt lgkmcnt(0)
    s_waitcnt vmcnt(12)
    v_mfma_f32_16x16x32_bf16 v[64:67], v[28:31], v[192:195], v[64:67]
    ds_read_b64_tr_b16 v[44:45], v11 offset:0
    ds_read_b64_tr_b16 v[46:47], v11 offset:256
    v_mfma_f32_16x16x32_bf16 v[64:67], v[32:35], v[200:203], v[64:67]
    ds_read_b64_tr_b16 v[48:49], v11 offset:8192
    ds_read_b64_tr_b16 v[50:51], v11 offset:8448
    v_mfma_f32_16x16x32_bf16 v[64:67], v[36:39], v[208:211], v[64:67]
    ds_read_b64_tr_b16 v[52:53], v11 offset:16384
    ds_read_b64_tr_b16 v[54:55], v11 offset:16640
    v_mfma_f32_16x16x32_bf16 v[64:67], v[40:43], v[216:219], v[64:67]
    ds_read_b64_tr_b16 v[56:57], v11 offset:24576
    ds_read_b64_tr_b16 v[58:59], v11 offset:24832
    s_waitcnt vmcnt(8)
    v_mfma_f32_16x16x32_bf16 v[68:71], v[28:31], v[196:199], v[68:71]
    s_add_u32 s59, s67, 12288
    buffer_load_dwordx4 v[248:251], v2, s[24:27], s59 offen offset:3072 sc1
    v_mfma_f32_16x16x32_bf16 v[68:71], v[32:35], v[204:207], v[68:71]
    buffer_load_dwordx4 v2, s[32:35], s68 offen offset:2048 sc1 lds
    v_mfma_f32_16x16x32_bf16 v[68:71], v[36:39], v[212:215], v[68:71]
    buffer_load_dwordx4 v2, s[32:35], s68 offen offset:3072 sc1 lds
    v_mfma_f32_16x16x32_bf16 v[68:71], v[40:43], v[220:223], v[68:71]
    s_waitcnt lgkmcnt(0)
    v_mfma_f32_16x16x32_bf16 v[72:75], v[44:47], v[192:195], v[72:75]
    ds_read_b64_tr_b16 v[28:29], v10 offset:1024
    ds_read_b64_tr_b16 v[30:31], v10 offset:1280
    v_mfma_f32_16x16x32_bf16 v[72:75], v[48:51], v[200:203], v[72:75]
    ds_read_b64_tr_b16 v[32:33], v10 offset:9216
    ds_read_b64_tr_b16 v[34:35], v10 offset:9472
    v_mfma_f32_16x16x32_bf16 v[72:75], v[52:55], v[208:211], v[72:75]
    ds_read_b64_tr_b16 v[36:37], v10 offset:17408
    ds_read_b64_tr_b16 v[38:39], v10 offset:17664
    v_mfma_f32_16x16x32_bf16 v[72:75], v[56:59], v[216:219], v[72:75]
    ds_read_b64_tr_b16 v[40:41], v10 offset:25600
    ds_read_b64_tr_b16 v[42:43], v10 offset:25856
    v_mfma_f32_16x16x32_bf16 v[76:79], v[44:47], v[196:199], v[76:79]
    s_add_u32 s59, s67, 28672
    buffer_load_dwordx4 v[244:247], v2, s[24:27], s59 offen offset:2048 sc1
    v_mfma_f32_16x16x32_bf16 v[76:79], v[48:51], v[204:207], v[76:79]
    v_mfma_f32_16x16x32_bf16 v[76:79], v[52:55], v[212:215], v[76:79]
    s_add_u32 m0, m0, 16384
    s_add_u32 s68, s68, 16384
    buffer_load_dwordx4 v2, s[28:31], s68 offen offset:0 sc1 lds
    v_mfma_f32_16x16x32_bf16 v[76:79], v[56:59], v[220:223], v[76:79]
    s_waitcnt lgkmcnt(0)
    v_mfma_f32_16x16x32_bf16 v[80:83], v[28:31], v[192:195], v[80:83]
    ds_read_b64_tr_b16 v[44:45], v11 offset:1024
    ds_read_b64_tr_b16 v[46:47], v11 offset:1280
    v_mfma_f32_16x16x32_bf16 v[80:83], v[32:35], v[200:203], v[80:83]
    ds_read_b64_tr_b16 v[48:49], v11 offset:9216
    ds_read_b64_tr_b16 v[50:51], v11 offset:9472
    v_mfma_f32_16x16x32_bf16 v[80:83], v[36:39], v[208:211], v[80:83]
    ds_read_b64_tr_b16 v[52:53], v11 offset:17408
    ds_read_b64_tr_b16 v[54:55], v11 offset:17664
    v_mfma_f32_16x16x32_bf16 v[80:83], v[40:43], v[216:219], v[80:83]
    ds_read_b64_tr_b16 v[56:57], v11 offset:25600
    ds_read_b64_tr_b16 v[58:59], v11 offset:25856
    v_mfma_f32_16x16x32_bf16 v[84:87], v[28:31], v[196:199], v[84:87]
    s_add_u32 s59, s67, 28672
    buffer_load_dwordx4 v[252:255], v2, s[24:27], s59 offen offset:3072 sc1
    v_mfma_f32_16x16x32_bf16 v[84:87], v[32:35], v[204:207], v[84:87]
    v_mfma_f32_16x16x32_bf16 v[84:87], v[36:39], v[212:215], v[84:87]
    buffer_load_dwordx4 v2, s[28:31], s68 offen offset:1024 sc1 lds
    v_mfma_f32_16x16x32_bf16 v[84:87], v[40:43], v[220:223], v[84:87]
    s_waitcnt lgkmcnt(0)
    v_mfma_f32_16x16x32_bf16 v[88:91], v[44:47], v[192:195], v[88:91]
    ds_read_b64_tr_b16 v[28:29], v10 offset:2048
    ds_read_b64_tr_b16 v[30:31], v10 offset:2304
    v_mfma_f32_16x16x32_bf16 v[88:91], v[48:51], v[200:203], v[88:91]
    ds_read_b64_tr_b16 v[32:33], v10 offset:10240
    ds_read_b64_tr_b16 v[34:35], v10 offset:10496
    v_mfma_f32_16x16x32_bf16 v[88:91], v[52:55], v[208:211], v[88:91]
    ds_read_b64_tr_b16 v[36:37], v10 offset:18432
    ds_read_b64_tr_b16 v[38:39], v10 offset:18688
    v_mfma_f32_16x16x32_bf16 v[88:91], v[56:59], v[216:219], v[88:91]
    ds_read_b64_tr_b16 v[40:41], v10 offset:26624
    ds_read_b64_tr_b16 v[42:43], v10 offset:26880
    v_mfma_f32_16x16x32_bf16 v[92:95], v[44:47], v[196:199], v[92:95]
    buffer_load_dwordx4 v2, s[28:31], s68 offen offset:2048 sc1 lds
    v_mfma_f32_16x16x32_bf16 v[92:95], v[48:51], v[204:207], v[92:95]
    v_mfma_f32_16x16x32_bf16 v[92:95], v[52:55], v[212:215], v[92:95]
    buffer_load_dwordx4 v2, s[28:31], s68 offen offset:3072 sc1 lds
    s_mov_b32 m0, s55
    s_add_u32 s56, s56, 4
    buffer_load_dword v20, s[24:27], s56 offen lds
    v_mfma_f32_16x16x32_bf16 v[92:95], v[56:59], v[220:223], v[92:95]
    s_cmp_lg_u32 s40, 4
    s_cbranch_scc1 KFP_36
    v_and_b32 v63, 7, v1
    v_lshlrev_b32 v63, 2, v63
    buffer_load_dword v63, v63, s[24:27], s76 offen sc1
KFP_36:
    s_waitcnt lgkmcnt(0)
    v_mfma_f32_16x16x32_bf16 v[96:99], v[28:31], v[192:195], v[96:99]
    ds_read_b64_tr_b16 v[44:45], v11 offset:2048
    ds_read_b64_tr_b16 v[46:47], v11 offset:2304
    v_mfma_f32_16x16x32_bf16 v[96:99], v[32:35], v[200:203], v[96:99]
    ds_read_b64_tr_b16 v[48:49], v11 offset:10240
    ds_read_b64_tr_b16 v[50:51], v11 offset:10496
    v_mfma_f32_16x16x32_bf16 v[96:99], v[36:39], v[208:211], v[96:99]
    ds_read_b64_tr_b16 v[52:53], v11 offset:18432
    ds_read_b64_tr_b16 v[54:55], v11 offset:18688
    v_mfma_f32_16x16x32_bf16 v[96:99], v[40:43], v[216:219], v[96:99]
    ds_read_b64_tr_b16 v[56:57], v11 offset:26624
    ds_read_b64_tr_b16 v[58:59], v11 offset:26880
    v_mfma_f32_16x16x32_bf16 v[100:103], v[28:31], v[196:199], v[100:103]
    v_mfma_f32_16x16x32_bf16 v[100:103], v[32:35], v[204:207], v[100:103]
    v_mfma_f32_16x16x32_bf16 v[100:103], v[36:39], v[212:215], v[100:103]
    v_mfma_f32_16x16x32_bf16 v[100:103], v[40:43], v[220:223], v[100:103]
    s_waitcnt lgkmcnt(0)
    v_mfma_f32_16x16x32_bf16 v[104:107], v[44:47], v[192:195], v[104:107]
    ds_read_b64_tr_b16 v[28:29], v10 offset:3072
    ds_read_b64_tr_b16 v[30:31], v10 offset:3328
    v_mfma_f32_16x16x32_bf16 v[104:107], v[48:51], v[200:203], v[104:107]
    ds_read_b64_tr_b16 v[32:33], v10 offset:11264
    ds_read_b64_tr_b16 v[34:35], v10 offset:11520
    v_mfma_f32_16x16x32_bf16 v[104:107], v[52:55], v[208:211], v[104:107]
    ds_read_b64_tr_b16 v[36:37], v10 offset:19456
    ds_read_b64_tr_b16 v[38:39], v10 offset:19712
    v_mfma_f32_16x16x32_bf16 v[104:107], v[56:59], v[216:219], v[104:107]
    ds_read_b64_tr_b16 v[40:41], v10 offset:27648
    ds_read_b64_tr_b16 v[42:43], v10 offset:27904
    v_mfma_f32_16x16x32_bf16 v[108:111], v[44:47], v[196:199], v[108:111]
    v_mfma_f32_16x16x32_bf16 v[108:111], v[48:51], v[204:207], v[108:111]
    v_mfma_f32_16x16x32_bf16 v[108:111], v[52:55], v[212:215], v[108:111]
    v_mfma_f32_16x16x32_bf16 v[108:111], v[56:59], v[220:223], v[108:111]
    s_waitcnt lgkmcnt(0)
    v_mfma_f32_16x16x32_bf16 v[112:115], v[28:31], v[192:195], v[112:115]
    ds_read_b64_tr_b16 v[44:45], v11 offset:3072
    ds_read_b64_tr_b16 v[46:47], v11 offset:3328
    v_mfma_f32_16x16x32_bf16 v[112:115], v[32:35], v[200:203], v[112:115]
    ds_read_b64_tr_b16 v[48:49], v11 offset:11264
    ds_read_b64_tr_b16 v[50:51], v11 offset:11520
    v_mfma_f32_16x16x32_bf16 v[112:115], v[36:39], v[208:211], v[112:115]
    ds_read_b64_tr_b16 v[52:53], v11 offset:19456
    ds_read_b64_tr_b16 v[54:55], v11 offset:19712
    v_mfma_f32_16x16x32_bf16 v[112:115], v[40:43], v[216:219], v[112:115]
    ds_read_b64_tr_b16 v[56:57], v11 offset:27648
    ds_read_b64_tr_b16 v[58:59], v11 offset:27904
    v_mfma_f32_16x16x32_bf16 v[116:119], v[28:31], v[196:199], v[116:119]
    v_mfma_f32_16x16x32_bf16 v[116:119], v[32:35], v[204:207], v[116:119]
    v_mfma_f32_16x16x32_bf16 v[116:119], v[36:39], v[212:215], v[116:119]
    v_mfma_f32_16x16x32_bf16 v[116:119], v[40:43], v[220:223], v[116:119]
    s_cmp_lg_u32 s40, 4
    s_cbranch_scc1 KFR_38
    s_waitcnt vmcnt(0)
    v_cmp_gt_u32 vcc, 2, v63
    s_nop 0
    s_and_b32 s62, vcc_lo, s77
    s_cmp_eq_u32 s62, 0
    s_cbranch_scc0 KFS_37
KFR_38:
    s_waitcnt lgkmcnt(0)
    s_waitcnt vmcnt(17)
    s_barrier
    s_setprio 2
    v_mfma_f32_16x16x32_bf16 v[120:123], v[44:47], v[192:195], v[120:123]
    ds_read_b64_tr_b16 v[28:29], v10 offset:32768
    ds_read_b64_tr_b16 v[30:31], v10 offset:33024
    v_mfma_f32_16x16x32_bf16 v[120:123], v[48:51], v[200:203], v[120:123]
    ds_read_b64_tr_b16 v[32:33], v10 offset:40960
    ds_read_b64_tr_b16 v[34:35], v10 offset:41216
    v_mfma_f32_16x16x32_bf16 v[120:123], v[52:55], v[208:211], v[120:123]
    ds_read_b64_tr_b16 v[36:37], v10 offset:49152
    ds_read_b64_tr_b16 v[38:39], v10 offset:49408
    v_mfma_f32_16x16x32_bf16 v[120:123], v[56:59], v[216:219], v[120:123]
    ds_read_b64_tr_b16 v[40:41], v10 offset:57344
    ds_read_b64_tr_b16 v[42:43], v10 offset:57600
    v_mfma_f32_16x16x32_bf16 v[124:127], v[44:47], v[196:199], v[124:127]
    s_add_u32 m0, s69, 32768
    s_nop 0
    buffer_load_dwordx4 v2, s[32:35], s68 offen offset:0 sc1 lds
    v_mfma_f32_16x16x32_bf16 v[124:127], v[48:51], v[204:207], v[124:127]
    buffer_load_dwordx4 v2, s[32:35], s68 offen offset:1024 sc1 lds
    v_mfma_f32_16x16x32_bf16 v[124:127], v[52:55], v[212:215], v[124:127]
    buffer_load_dwordx4 v2, s[32:35], s68 offen offset:2048 sc1 lds
    v_mfma_f32_16x16x32_bf16 v[124:127], v[56:59], v[220:223], v[124:127]
    s_waitcnt lgkmcnt(0)
    s_waitcnt vmcnt(12)
    v_mfma_f32_16x16x32_bf16 v[64:67], v[28:31], v[224:227], v[64:67]
    ds_read_b64_tr_b16 v[208:209], v11 offset:32768
    ds_read_b64_tr_b16 v[210:211], v11 offset:33024
    v_mfma_f32_16x16x32_bf16 v[64:67], v[32:35], v[232:235], v[64:67]
    ds_read_b64_tr_b16 v[212:213], v11 offset:40960
    ds_read_b64_tr_b16 v[214:215], v11 offset:41216
    v_mfma_f32_16x16x32_bf16 v[64:67], v[36:39], v[240:243], v[64:67]
    ds_read_b64_tr_b16 v[216:217], v11 offset:49152
    ds_read_b64_tr_b16 v[218:219], v11 offset:49408
    v_mfma_f32_16x16x32_bf16 v[64:67], v[40:43], v[248:251], v[64:67]
    ds_read_b64_tr_b16 v[220:221], v11 offset:57344
    ds_read_b64_tr_b16 v[222:223], v11 offset:57600
    s_waitcnt vmcnt(7)
    v_mfma_f32_16x16x32_bf16 v[68:71], v[28:31], v[228:231], v[68:71]
    buffer_load_dwordx4 v2, s[32:35], s68 offen offset:3072 sc1 lds
    v_mfma_f32_16x16x32_bf16 v[68:71], v[32:35], v[236:239], v[68:71]
    s_add_u32 m0, m0, 16384
    s_add_u32 s68, s68, 16384
    buffer_load_dwordx4 v2, s[28:31], s68 offen offset:0 sc1 lds
    v_mfma_f32_16x16x32_bf16 v[68:71], v[36:39], v[244:247], v[68:71]
    buffer_load_dwordx4 v2, s[28:31], s68 offen offset:1024 sc1 lds
    v_mfma_f32_16x16x32_bf16 v[68:71], v[40:43], v[252:255], v[68:71]
    s_waitcnt lgkmcnt(0)
    v_mfma_f32_16x16x32_bf16 v[72:75], v[208:211], v[224:227], v[72:75]
    ds_read_b64_tr_b16 v[192:193], v10 offset:33792
    ds_read_b64_tr_b16 v[194:195], v10 offset:34048
    v_mfma_f32_16x16x32_bf16 v[72:75], v[212:215], v[232:235], v[72:75]
    ds_read_b64_tr_b16 v[196:197], v10 offset:41984
    ds_read_b64_tr_b16 v[198:199], v10 offset:42240
    v_mfma_f32_16x16x32_bf16 v[72:75], v[216:219], v[240:243], v[72:75]
    ds_read_b64_tr_b16 v[200:201], v10 offset:50176
    ds_read_b64_tr_b16 v[202:203], v10 offset:50432
    v_mfma_f32_16x16x32_bf16 v[72:75], v[220:223], v[248:251], v[72:75]
    ds_read_b64_tr_b16 v[204:205], v10 offset:58368
    ds_read_b64_tr_b16 v[206:207], v10 offset:58624
    v_mfma_f32_16x16x32_bf16 v[76:79], v[208:211], v[228:231], v[76:79]
    buffer_load_dwordx4 v2, s[28:31], s68 offen offset:2048 sc1 lds
    v_mfma_f32_16x16x32_bf16 v[76:79], v[212:215], v[236:239], v[76:79]
    buffer_load_dwordx4 v2, s[28:31], s68 offen offset:3072 sc1 lds
    s_mov_b32 m0, s55
    s_add_u32 s56, s56, 4
    buffer_load_dword v20, s[24:27], s56 offen lds
    v_mfma_f32_16x16x32_bf16 v[76:79], v[216:219], v[244:247], v[76:79]
    s_add_u32 m0, s69, 65536
    s_nop 0
    buffer_load_dwordx4 v2, s[32:35], s68 offen offset:0 sc1 lds
    v_mfma_f32_16x16x32_bf16 v[76:79], v[220:223], v[252:255], v[76:79]
    s_waitcnt lgkmcnt(0)
    v_mfma_f32_16x16x32_bf16 v[80:83], v[192:195], v[224:227], v[80:83]
    ds_read_b64_tr_b16 v[208:209], v11 offset:33792
    ds_read_b64_tr_b16 v[210:211], v11 offset:34048
    v_mfma_f32_16x16x32_bf16 v[80:83], v[196:199], v[232:235], v[80:83]
    ds_read_b64_tr_b16 v[212:213], v11 offset:41984
    ds_read_b64_tr_b16 v[214:215], v11 offset:42240
    v_mfma_f32_16x16x32_bf16 v[80:83], v[200:203], v[240:243], v[80:83]
    ds_read_b64_tr_b16 v[216:217], v11 offset:50176
    ds_read_b64_tr_b16 v[218:219], v11 offset:50432
    v_mfma_f32_16x16x32_bf16 v[80:83], v[204:207], v[248:251], v[80:83]
    ds_read_b64_tr_b16 v[220:221], v11 offset:58368
    ds_read_b64_tr_b16 v[222:223], v11 offset:58624
    v_mfma_f32_16x16x32_bf16 v[84:87], v[192:195], v[228:231], v[84:87]
    buffer_load_dwordx4 v2, s[32:35], s68 offen offset:1024 sc1 lds
    v_cvt_pk_bf16_f32 v28, v64, v65
    v_mfma_f32_16x16x32_bf16 v[84:87], v[196:199], v[236:239], v[84:87]
    buffer_load_dwordx4 v2, s[32:35], s68 offen offset:2048 sc1 lds
    v_cvt_pk_bf16_f32 v29, v66, v67
    v_mfma_f32_16x16x32_bf16 v[84:87], v[200:203], v[244:247], v[84:87]
    buffer_load_dwordx4 v2, s[32:35], s68 offen offset:3072 sc1 lds
    v_cvt_pk_bf16_f32 v44, v68, v69
    v_mfma_f32_16x16x32_bf16 v[84:87], v[204:207], v[252:255], v[84:87]
    v_cvt_pk_bf16_f32 v45, v70, v71
    s_waitcnt lgkmcnt(0)
    v_mfma_f32_16x16x32_bf16 v[88:91], v[208:211], v[224:227], v[88:91]
    ds_read_b64_tr_b16 v[192:193], v10 offset:34816
    ds_read_b64_tr_b16 v[194:195], v10 offset:35072
    v_mfma_f32_16x16x32_bf16 v[88:91], v[212:215], v[232:235], v[88:91]
    ds_read_b64_tr_b16 v[196:197], v10 offset:43008
    ds_read_b64_tr_b16 v[198:199], v10 offset:43264
    v_mfma_f32_16x16x32_bf16 v[88:91], v[216:219], v[240:243], v[88:91]
    ds_read_b64_tr_b16 v[200:201], v10 offset:51200
    ds_read_b64_tr_b16 v[202:203], v10 offset:51456
    v_mfma_f32_16x16x32_bf16 v[88:91], v[220:223], v[248:251], v[88:91]
    ds_read_b64_tr_b16 v[204:205], v10 offset:59392
    ds_read_b64_tr_b16 v[206:207], v10 offset:59648
    v_mfma_f32_16x16x32_bf16 v[92:95], v[208:211], v[228:231], v[92:95]
    s_add_u32 m0, m0, 16384
    s_add_u32 s68, s68, 16384
    buffer_load_dwordx4 v2, s[28:31], s68 offen offset:0 sc1 lds
    v_cvt_pk_bf16_f32 v30, v72, v73
    v_mfma_f32_16x16x32_bf16 v[92:95], v[212:215], v[236:239], v[92:95]
    v_cvt_pk_bf16_f32 v31, v74, v75
    v_mfma_f32_16x16x32_bf16 v[92:95], v[216:219], v[244:247], v[92:95]
    buffer_load_dwordx4 v2, s[28:31], s68 offen offset:1024 sc1 lds
    v_cvt_pk_bf16_f32 v46, v76, v77
    v_mfma_f32_16x16x32_bf16 v[92:95], v[220:223], v[252:255], v[92:95]
    v_cvt_pk_bf16_f32 v47, v78, v79
    s_waitcnt lgkmcnt(0)
    v_mfma_f32_16x16x32_bf16 v[96:99], v[192:195], v[224:227], v[96:99]
    ds_read_b64_tr_b16 v[208:209], v11 offset:34816
    ds_read_b64_tr_b16 v[210:211], v11 offset:35072
    v_mfma_f32_16x16x32_bf16 v[96:99], v[196:199], v[232:235], v[96:99]
    ds_read_b64_tr_b16 v[212:213], v11 offset:43008
    ds_read_b64_tr_b16 v[214:215], v11 offset:43264
    v_mfma_f32_16x16x32_bf16 v[96:99], v[200:203], v[240:243], v[96:99]
    ds_read_b64_tr_b16 v[216:217], v11 offset:51200
    ds_read_b64_tr_b16 v[218:219], v11 offset:51456
    v_mfma_f32_16x16x32_bf16 v[96:99], v[204:207], v[248:251], v[96:99]
    ds_read_b64_tr_b16 v[220:221], v11 offset:59392
    ds_read_b64_tr_b16 v[222:223], v11 offset:59648
    v_mfma_f32_16x16x32_bf16 v[100:103], v[192:195], v[228:231], v[100:103]
    buffer_load_dwordx4 v2, s[28:31], s68 offen offset:2048 sc1 lds
    v_cvt_pk_bf16_f32 v32, v80, v81
    ds_read_b128 v[160:163], v3 offset:0
    v_mfma_f32_16x16x32_bf16 v[100:103], v[196:199], v[236:239], v[100:103]
    v_cvt_pk_bf16_f32 v33, v82, v83
    ds_read_b128 v[164:167], v3 offset:2048
    v_mfma_f32_16x16x32_bf16 v[100:103], v[200:203], v[244:247], v[100:103]
    buffer_load_dwordx4 v2, s[28:31], s68 offen offset:3072 sc1 lds
    s_mov_b32 m0, s55
    s_add_u32 s56, s56, 4
    buffer_load_dword v20, s[24:27], s56 offen lds
    v_cvt_pk_bf16_f32 v48, v84, v85
    ds_read_b128 v[168:171], v3 offset:4096
    v_mfma_f32_16x16x32_bf16 v[100:103], v[204:207], v[252:255], v[100:103]
    v_cvt_pk_bf16_f32 v49, v86, v87
    ds_read_b128 v[172:175], v3 offset:6144
    s_waitcnt lgkmcnt(4)
    v_mfma_f32_16x16x32_bf16 v[104:107], v[208:211], v[224:227], v[104:107]
    ds_read_b64_tr_b16 v[192:193], v10 offset:35840
    ds_read_b64_tr_b16 v[194:195], v10 offset:36096
    v_mfma_f32_16x16x32_bf16 v[104:107], v[212:215], v[232:235], v[104:107]
    ds_read_b64_tr_b16 v[196:197], v10 offset:44032
    ds_read_b64_tr_b16 v[198:199], v10 offset:44288
    v_mfma_f32_16x16x32_bf16 v[104:107], v[216:219], v[240:243], v[104:107]
    ds_read_b64_tr_b16 v[200:201], v10 offset:52224
    ds_read_b64_tr_b16 v[202:203], v10 offset:52480
    v_mfma_f32_16x16x32_bf16 v[104:107], v[220:223], v[248:251], v[104:107]
    ds_read_b64_tr_b16 v[204:205], v10 offset:60416
    ds_read_b64_tr_b16 v[206:207], v10 offset:60672
    v_mfma_f32_16x16x32_bf16 v[108:111], v[208:211], v[228:231], v[108:111]
    v_cvt_pk_bf16_f32 v34, v88, v89
    ds_read_b128 v[176:179], v3 offset:1024
    v_mfma_f32_16x16x32_bf16 v[108:111], v[212:215], v[236:239], v[108:111]
    v_cvt_pk_bf16_f32 v35, v90, v91
    ds_read_b128 v[180:183], v3 offset:3072
    v_mfma_f32_16x16x32_bf16 v[108:111], v[216:219], v[244:247], v[108:111]
    v_cvt_pk_bf16_f32 v50, v92, v93
    ds_read_b128 v[184:187], v3 offset:5120
    v_mfma_f32_16x16x32_bf16 v[108:111], v[220:223], v[252:255], v[108:111]
    v_cvt_pk_bf16_f32 v51, v94, v95
    ds_read_b128 v[188:191], v3 offset:7168
    s_waitcnt lgkmcnt(4)
    v_mfma_f32_16x16x32_bf16 v[112:115], v[192:195], v[224:227], v[112:115]
    ds_read_b64_tr_b16 v[208:209], v11 offset:35840
    ds_read_b64_tr_b16 v[210:211], v11 offset:36096
    v_mfma_f32_16x16x32_bf16 v[112:115], v[196:199], v[232:235], v[112:115]
    ds_read_b64_tr_b16 v[212:213], v11 offset:44032
    ds_read_b64_tr_b16 v[214:215], v11 offset:44288
    v_mfma_f32_16x16x32_bf16 v[112:115], v[200:203], v[240:243], v[112:115]
    ds_read_b64_tr_b16 v[216:217], v11 offset:52224
    ds_read_b64_tr_b16 v[218:219], v11 offset:52480
    v_mfma_f32_16x16x32_bf16 v[112:115], v[204:207], v[248:251], v[112:115]
    ds_read_b64_tr_b16 v[220:221], v11 offset:60416
    ds_read_b64_tr_b16 v[222:223], v11 offset:60672
    v_mfma_f32_16x16x32_bf16 v[116:119], v[192:195], v[228:231], v[116:119]
    v_cvt_pk_bf16_f32 v36, v96, v97
    ds_read_b128 v[128:131], v3 offset:8192
    v_mfma_f32_16x16x32_bf16 v[116:119], v[196:199], v[236:239], v[116:119]
    v_cvt_pk_bf16_f32 v37, v98, v99
    ds_read_b128 v[132:135], v3 offset:10240
    v_mfma_f32_16x16x32_bf16 v[116:119], v[200:203], v[244:247], v[116:119]
    v_cvt_pk_bf16_f32 v52, v100, v101
    ds_read_b128 v[136:139], v3 offset:12288
    v_mfma_f32_16x16x32_bf16 v[116:119], v[204:207], v[252:255], v[116:119]
    v_cvt_pk_bf16_f32 v53, v102, v103
    ds_read_b128 v[140:143], v3 offset:14336
    s_waitcnt lgkmcnt(4)
    v_mfma_f32_16x16x32_bf16 v[120:123], v[208:211], v[224:227], v[120:123]
    v_mfma_f32_16x16x32_bf16 v[120:123], v[212:215], v[232:235], v[120:123]
    v_mfma_f32_16x16x32_bf16 v[120:123], v[216:219], v[240:243], v[120:123]
    v_mfma_f32_16x16x32_bf16 v[120:123], v[220:223], v[248:251], v[120:123]
    v_mfma_f32_16x16x32_bf16 v[124:127], v[208:211], v[228:231], v[124:127]
    v_cvt_pk_bf16_f32 v38, v104, v105
    ds_read_b128 v[144:147], v3 offset:9216
    v_mfma_f32_16x16x32_bf16 v[124:127], v[212:215], v[236:239], v[124:127]
    v_cvt_pk_bf16_f32 v39, v106, v107
    ds_read_b128 v[148:151], v3 offset:11264
    v_mfma_f32_16x16x32_bf16 v[124:127], v[216:219], v[244:247], v[124:127]
    v_cvt_pk_bf16_f32 v54, v108, v109
    ds_read_b128 v[152:155], v3 offset:13312
    v_mfma_f32_16x16x32_bf16 v[124:127], v[220:223], v[252:255], v[124:127]
    v_cvt_pk_bf16_f32 v55, v110, v111
    ds_read_b128 v[156:159], v3 offset:15360
    v_mov_b32 v96, 0
    v_mov_b32 v97, 0
    v_mov_b32 v98, 0
    v_mov_b32 v99, 0
    v_mov_b32 v100, 0
    v_mov_b32 v101, 0
    v_mov_b32 v102, 0
    v_mov_b32 v103, 0
    v_mov_b32 v104, 0
    v_mov_b32 v105, 0
    v_mov_b32 v106, 0
    v_mov_b32 v107, 0
    v_mov_b32 v108, 0
    v_mov_b32 v109, 0
    v_mov_b32 v110, 0
    v_mov_b32 v111, 0
    v_mov_b32 v60, 0
    v_mov_b32 v61, 0
    v_mov_b32 v62, 0xf149f2ca
    v_cvt_pk_bf16_f32 v40, v112, v113
    v_cvt_pk_bf16_f32 v41, v114, v115
    v_cvt_pk_bf16_f32 v56, v116, v117
    v_cvt_pk_bf16_f32 v57, v118, v119
    v_cvt_pk_bf16_f32 v42, v120, v121
    v_cvt_pk_bf16_f32 v43, v122, v123
    v_cvt_pk_bf16_f32 v58, v124, v125
    v_cvt_pk_bf16_f32 v59, v126, v127
    s_cmp_lg_u32 s44, 0
    s_cbranch_scc1 KFL_39
    v_cndmask_b32 v96, v62, v60, s[78:79]
    v_cndmask_b32 v108, v62, v61, s[78:79]
    v_mov_b32 v100, v62
    v_cndmask_b32 v97, v62, v60, s[80:81]
    v_cndmask_b32 v109, v62, v61, s[80:81]
    v_mov_b32 v101, v62
    v_cndmask_b32 v98, v62, v60, s[82:83]
    v_cndmask_b32 v110, v62, v61, s[82:83]
    v_mov_b32 v102, v62
    v_cndmask_b32 v99, v62, v60, s[84:85]
    v_cndmask_b32 v111, v62, v61, s[84:85]
    v_mov_b32 v103, v62
KFL_39:
    s_waitcnt lgkmcnt(0)
    v_mov_b32 v16, 1
    ds_write_b32 v14, v16
    v_mfma_f32_16x16x32_bf16 v[64:67], v[160:163], v[28:31], v[96:99]
    v_mov_b32 v192, 0
    v_mov_b32 v193, 0
    v_mov_b32 v194, 0
    v_mfma_f32_16x16x32_bf16 v[64:67], v[164:167], v[32:35], v[64:67]
    v_mov_b32 v195, 0
    v_mov_b32 v196, 0
    v_mov_b32 v197, 0
    v_mfma_f32_16x16x32_bf16 v[64:67], v[168:171], v[36:39], v[64:67]
    v_mov_b32 v198, 0
    v_mov_b32 v199, 0
    v_mov_b32 v200, 0
    v_mfma_f32_16x16x32_bf16 v[64:67], v[172:175], v[40:43], v[64:67]
    v_mov_b32 v201, 0
    v_mov_b32 v202, 0
    v_mov_b32 v203, 0
    v_mfma_f32_16x16x32_bf16 v[72:75], v[160:163], v[44:47], v[104:107]
    v_mov_b32 v204, 0
    v_mov_b32 v205, 0
    v_mov_b32 v206, 0
    v_mfma_f32_16x16x32_bf16 v[72:75], v[164:167], v[48:51], v[72:75]
    v_mov_b32 v207, 0
    v_mov_b32 v208, 0
    v_mov_b32 v209, 0
    v_mfma_f32_16x16x32_bf16 v[72:75], v[168:171], v[52:55], v[72:75]
    v_mov_b32 v210, 0
    v_mov_b32 v211, 0
    v_mov_b32 v212, 0
    v_mfma_f32_16x16x32_bf16 v[72:75], v[172:175], v[56:59], v[72:75]
    v_mov_b32 v213, 0
    v_mov_b32 v214, 0
    v_mov_b32 v215, 0
    v_mfma_f32_16x16x32_bf16 v[68:71], v[176:179], v[28:31], v[100:103]
    v_mov_b32 v216, 0
    v_mov_b32 v217, 0
    v_mov_b32 v218, 0
    v_mfma_f32_16x16x32_bf16 v[68:71], v[180:183], v[32:35], v[68:71]
    v_mov_b32 v219, 0
    v_mov_b32 v220, 0
    v_mov_b32 v221, 0
    v_mfma_f32_16x16x32_bf16 v[68:71], v[184:187], v[36:39], v[68:71]
    v_mov_b32 v222, 0
    v_mov_b32 v223, 0
    v_mov_b32 v224, 0
    v_mfma_f32_16x16x32_bf16 v[68:71], v[188:191], v[40:43], v[68:71]
    v_mov_b32 v225, 0
    v_mov_b32 v226, 0
    v_mov_b32 v227, 0
    v_mfma_f32_16x16x32_bf16 v[76:79], v[176:179], v[44:47], v[108:111]
    v_mov_b32 v228, 0
    v_mov_b32 v229, 0
    v_mov_b32 v230, 0
    v_mfma_f32_16x16x32_bf16 v[76:79], v[180:183], v[48:51], v[76:79]
    v_mov_b32 v231, 0
    v_mov_b32 v232, 0
    v_mov_b32 v233, 0
    v_mfma_f32_16x16x32_bf16 v[76:79], v[184:187], v[52:55], v[76:79]
    v_mov_b32 v234, 0
    v_mov_b32 v235, 0
    v_mov_b32 v236, 0
    v_mfma_f32_16x16x32_bf16 v[76:79], v[188:191], v[56:59], v[76:79]
    v_mov_b32 v237, 0
    v_mov_b32 v238, 0
    v_mov_b32 v239, 0
    s_mov_b32 s47, 0
    s_mov_b32 s71, 0
    s_mov_b32 s70, 0x18000
    v_mov_b32 v240, 0
    v_mov_b32 v241, 0
    v_mov_b32 v242, 0
    v_mov_b32 v243, 0
    v_mov_b32 v244, 0
    v_mov_b32 v245, 0
    v_mov_b32 v246, 0
    v_mov_b32 v247, 0
    v_max3_f32 v60, v64, v65, v66
    v_max3_f32 v60, v60, v67, v68
    v_max3_f32 v60, v60, v69, v70
    v_max_f32 v60, v60, v71
    v_max3_f32 v61, v72, v73, v74
    v_max3_f32 v61, v61, v75, v76
    v_max3_f32 v61, v61, v77, v78
    v_max_f32 v61, v61, v79
    v_mov_b32 v10, v60
    v_mov_b32 v11, v61
    s_nop 1
    v_permlane16_swap_b32 v60, v10
    v_permlane16_swap_b32 v61, v11
    s_nop 0
    v_max_f32 v60, v60, v10
    v_max_f32 v61, v61, v11
    v_mov_b32 v10, v60
    v_mov_b32 v11, v61
    s_nop 1
    v_permlane32_swap_b32 v60, v10
    v_permlane32_swap_b32 v61, v11
    s_nop 0
    v_max_f32 v60, v60, v10
    v_max_f32 v61, v61, v11
    v_sub_f32 v60, 0, v60
    v_sub_f32 v61, 0, v61
    v_mov_b32 v96, v60
    v_add_f32 v64, v64, v60
    v_mov_b32 v97, v60
    v_add_f32 v65, v65, v60
    v_mov_b32 v98, v60
    v_add_f32 v66, v66, v60
    v_mov_b32 v99, v60
    v_add_f32 v67, v67, v60
    v_mov_b32 v100, v60
    v_add_f32 v68, v68, v60
    v_mov_b32 v101, v60
    v_add_f32 v69, v69, v60
    v_mov_b32 v102, v60
    v_add_f32 v70, v70, v60
    v_mov_b32 v103, v60
    v_add_f32 v71, v71, v60
    v_mov_b32 v104, v61
    v_add_f32 v72, v72, v61
    v_mov_b32 v105, v61
    v_add_f32 v73, v73, v61
    v_mov_b32 v106, v61
    v_add_f32 v74, v74, v61
    v_mov_b32 v107, v61
    v_add_f32 v75, v75, v61
    v_mov_b32 v108, v61
    v_add_f32 v76, v76, v61
    v_mov_b32 v109, v61
    v_add_f32 v77, v77, v61
    v_mov_b32 v110, v61
    v_add_f32 v78, v78, v61
    v_mov_b32 v111, v61
    v_add_f32 v79, v79, v61
    v_exp_f32 v64, v64
    v_exp_f32 v65, v65
    v_exp_f32 v66, v66
    v_exp_f32 v67, v67
    v_exp_f32 v68, v68
    v_exp_f32 v69, v69
    v_mov_b32 v248, 0
    v_mov_b32 v249, 0
    v_mov_b32 v250, 0
    v_mov_b32 v251, 0
    v_mov_b32 v252, 0
    v_mov_b32 v253, 0
    v_mov_b32 v254, 0
    v_mov_b32 v255, 0
    v_mov_b32 v112, 0
    v_mov_b32 v113, 0
    v_mov_b32 v114, 0
    v_mov_b32 v115, 0
    v_mov_b32 v116, 0
    v_mov_b32 v117, 0
    v_mov_b32 v118, 0
    v_mov_b32 v119, 0
    v_mov_b32 v120, 0x3f803f80
    v_mov_b32 v121, 0x3f803f80
    v_mov_b32 v122, 0x3f803f80
    v_mov_b32 v123, 0x3f803f80
    v_cvt_pk_bf16_f32 v64, v64, v65
    v_cvt_pk_bf16_f32 v65, v66, v67
    v_cvt_pk_bf16_f32 v66, v68, v69
    s_setprio 2
    s_mov_b32 s66, 0
KFN_40:
    ds_read_b32 v13, v12
    s_add_u32 s66, s66, 1
    s_cmp_gt_u32 s66, 200000
    s_waitcnt lgkmcnt(0)
    v_cmp_gt_u32 vcc, 1, v13
    s_cbranch_scc1 KFN_41
    s_cbranch_vccz KFN_41
    s_sleep 1
    s_branch KFN_40
KFN_41:
    s_cmp_eq_u32 s47, s45
    v_add_u32 v3, s71, v2
    s_cbranch_scc1 KF_A_TAIL
KF_A_BODY:
    v_mfma_f32_16x16x32_bf16 v[80:83], v[128:131], v[28:31], v[96:99]
    v_exp_f32 v70, v70
    v_mfma_f32_16x16x32_bf16 v[80:83], v[132:135], v[32:35], v[80:83]
    ds_read_b128 v[164:167], v3 offset:1024
    ds_read_b128 v[160:163], v3 offset:0
    v_mfma_f32_16x16x32_bf16 v[80:83], v[136:139], v[36:39], v[80:83]
    v_exp_f32 v71, v71
    v_mfma_f32_16x16x32_bf16 v[80:83], v[140:143], v[40:43], v[80:83]
    ds_read_b128 v[168:171], v3 offset:2048
    v_cvt_pk_bf16_f32 v67, v70, v71
    v_mfma_f32_16x16x32_bf16 v[88:91], v[128:131], v[44:47], v[104:107]
    v_exp_f32 v72, v72
    v_mfma_f32_16x16x32_bf16 v[88:91], v[132:135], v[48:51], v[88:91]
    ds_read_b128 v[176:179], v3 offset:4096
    ds_read_b128 v[172:175], v3 offset:3072
    v_mfma_f32_16x16x32_bf16 v[88:91], v[136:139], v[52:55], v[88:91]
    v_exp_f32 v73, v73
    v_mfma_f32_16x16x32_bf16 v[88:91], v[140:143], v[56:59], v[88:91]
    ds_read_b128 v[180:183], v3 offset:5120
    v_cvt_pk_bf16_f32 v72, v72, v73
    v_mfma_f32_16x16x32_bf16 v[84:87], v[144:147], v[28:31], v[100:103]
    v_exp_f32 v74, v74
    v_mfma_f32_16x16x32_bf16 v[84:87], v[148:151], v[32:35], v[84:87]
    ds_read_b128 v[188:191], v3 offset:7168
    ds_read_b128 v[184:187], v3 offset:6144
    v_mfma_f32_16x16x32_bf16 v[84:87], v[152:155], v[36:39], v[84:87]
    v_exp_f32 v75, v75
    v_mfma_f32_16x16x32_bf16 v[84:87], v[156:159], v[40:43], v[84:87]
    v_cvt_pk_bf16_f32 v73, v74, v75
    v_mfma_f32_16x16x32_bf16 v[92:95], v[144:147], v[44:47], v[108:111]
    v_exp_f32 v76, v76
    v_mfma_f32_16x16x32_bf16 v[92:95], v[148:151], v[48:51], v[92:95]
    v_mfma_f32_16x16x32_bf16 v[92:95], v[152:155], v[52:55], v[92:95]
    v_exp_f32 v77, v77
    v_mfma_f32_16x16x32_bf16 v[92:95], v[156:159], v[56:59], v[92:95]
    v_cvt_pk_bf16_f32 v74, v76, v77
    s_waitcnt lgkmcnt(0)
    v_mfma_f32_16x16x32_bf16 v[192:195], v[160:163], v[64:67], v[192:195]
    v_exp_f32 v78, v78
    v_mfma_f32_16x16x32_bf16 v[196:199], v[164:167], v[64:67], v[196:199]
    ds_read_b128 v[132:135], v3 offset:18432
    ds_read_b128 v[128:131], v3 offset:16384
    v_mfma_f32_16x16x32_bf16 v[200:203], v[168:171], v[64:67], v[200:203]
    v_exp_f32 v79, v79
    v_mfma_f32_16x16x32_bf16 v[204:207], v[172:175], v[64:67], v[204:207]
    ds_read_b128 v[136:139], v3 offset:20480
    v_cvt_pk_bf16_f32 v75, v78, v79
    v_mfma_f32_16x16x32_bf16 v[208:211], v[176:179], v[64:67], v[208:211]
    v_exp_f32 v80, v80
    v_mfma_f32_16x16x32_bf16 v[212:215], v[180:183], v[64:67], v[212:215]
    ds_read_b128 v[144:147], v3 offset:17408
    ds_read_b128 v[140:143], v3 offset:22528
    v_mfma_f32_16x16x32_bf16 v[216:219], v[184:187], v[64:67], v[216:219]
    v_exp_f32 v81, v81
    v_mfma_f32_16x16x32_bf16 v[220:223], v[188:191], v[64:67], v[220:223]
    ds_read_b128 v[148:151], v3 offset:19456
    v_cvt_pk_bf16_f32 v80, v80, v81
    v_mfma_f32_16x16x32_bf16 v[112:115], v[120:123], v[64:67], v[112:115]
    v_exp_f32 v82, v82
    v_mfma_f32_16x16x32_bf16 v[224:227], v[160:163], v[72:75], v[224:227]
    ds_read_b128 v[156:159], v3 offset:23552
    ds_read_b128 v[152:155], v3 offset:21504
    v_mfma_f32_16x16x32_bf16 v[228:231], v[164:167], v[72:75], v[228:231]
    v_exp_f32 v83, v83
    v_mfma_f32_16x16x32_bf16 v[232:235], v[168:171], v[72:75], v[232:235]
    v_cvt_pk_bf16_f32 v81, v82, v83
    ds_read_b32 v18, v17
    ds_read_b32 v13, v12
    v_mfma_f32_16x16x32_bf16 v[236:239], v[172:175], v[72:75], v[236:239]
    v_exp_f32 v84, v84
    v_mfma_f32_16x16x32_bf16 v[240:243], v[176:179], v[72:75], v[240:243]
    s_add_u32 s47, s47, 1
    v_mfma_f32_16x16x32_bf16 v[244:247], v[180:183], v[72:75], v[244:247]
    v_exp_f32 v85, v85
    v_mfma_f32_16x16x32_bf16 v[248:251], v[184:187], v[72:75], v[248:251]
    v_cvt_pk_bf16_f32 v82, v84, v85
    v_mfma_f32_16x16x32_bf16 v[252:255], v[188:191], v[72:75], v[252:255]
    s_lshl_b32 s59, s47, 1
    s_cmp_eq_u32 s59, s44
    v_mfma_f32_16x16x32_bf16 v[116:119], v[120:123], v[72:75], v[116:119]
    s_waitcnt lgkmcnt(0)
    s_cbranch_scc1 KF_A_MSK
KF_A_MSKR:
    v_mfma_f32_16x16x32_bf16 v[64:67], v[128:131], v[28:31], v[96:99]
    v_exp_f32 v86, v86
    v_mfma_f32_16x16x32_bf16 v[64:67], v[132:135], v[32:35], v[64:67]
    ds_read_b128 v[164:167], v3 offset:9216
    ds_read_b128 v[160:163], v3 offset:8192
    v_mfma_f32_16x16x32_bf16 v[64:67], v[136:139], v[36:39], v[64:67]
    v_exp_f32 v87, v87
    v_cmp_gt_u32 vcc, s47, v18
    v_mfma_f32_16x16x32_bf16 v[64:67], v[140:143], v[40:43], v[64:67]
    ds_read_b128 v[168:171], v3 offset:10240
    v_cvt_pk_bf16_f32 v83, v86, v87
    v_mfma_f32_16x16x32_bf16 v[72:75], v[128:131], v[44:47], v[104:107]
    v_exp_f32 v88, v88
    s_cbranch_vccnz KF_A_DSL
KF_A_DSR:
    v_mfma_f32_16x16x32_bf16 v[72:75], v[132:135], v[48:51], v[72:75]
    ds_read_b128 v[176:179], v3 offset:12288
    ds_read_b128 v[172:175], v3 offset:11264
    v_mfma_f32_16x16x32_bf16 v[72:75], v[136:139], v[52:55], v[72:75]
    v_exp_f32 v89, v89
    s_add_u32 m0, s69, s70
    s_nop 0
    buffer_load_dwordx4 v2, s[32:35], s68 offen offset:0 sc1 lds
    v_mfma_f32_16x16x32_bf16 v[72:75], v[140:143], v[56:59], v[72:75]
    ds_read_b128 v[180:183], v3 offset:13312
    v_cvt_pk_bf16_f32 v88, v88, v89
    v_mfma_f32_16x16x32_bf16 v[68:71], v[144:147], v[28:31], v[100:103]
    v_exp_f32 v90, v90
    buffer_load_dwordx4 v2, s[32:35], s68 offen offset:1024 sc1 lds
    v_mfma_f32_16x16x32_bf16 v[68:71], v[148:151], v[32:35], v[68:71]
    ds_read_b128 v[188:191], v3 offset:15360
    ds_read_b128 v[184:187], v3 offset:14336
    v_mfma_f32_16x16x32_bf16 v[68:71], v[152:155], v[36:39], v[68:71]
    v_exp_f32 v91, v91
    buffer_load_dwordx4 v2, s[32:35], s68 offen offset:2048 sc1 lds
    v_mfma_f32_16x16x32_bf16 v[68:71], v[156:159], v[40:43], v[68:71]
    v_cvt_pk_bf16_f32 v89, v90, v91
    v_add_u32 v16, 1, v16
    v_mfma_f32_16x16x32_bf16 v[76:79], v[144:147], v[44:47], v[108:111]
    v_exp_f32 v92, v92
    buffer_load_dwordx4 v2, s[32:35], s68 offen offset:3072 sc1 lds
    v_mfma_f32_16x16x32_bf16 v[76:79], v[148:151], v[48:51], v[76:79]
    s_add_u32 s71, s71, 0x8000
    s_and_b32 s71, s71, 0x1ffff
    v_mfma_f32_16x16x32_bf16 v[76:79], v[152:155], v[52:55], v[76:79]
    v_exp_f32 v93, v93
    s_add_u32 m0, m0, 16384
    s_add_u32 s68, s68, 16384
    buffer_load_dwordx4 v2, s[28:31], s68 offen offset:0 sc1 lds
    v_mfma_f32_16x16x32_bf16 v[76:79], v[156:159], v[56:59], v[76:79]
    v_cvt_pk_bf16_f32 v90, v92, v93
    s_waitcnt lgkmcnt(0)
    v_mfma_f32_16x16x32_bf16 v[192:195], v[160:163], v[80:83], v[192:195]
    v_exp_f32 v94, v94
    buffer_load_dwordx4 v2, s[28:31], s68 offen offset:1024 sc1 lds
    v_mfma_f32_16x16x32_bf16 v[196:199], v[164:167], v[80:83], v[196:199]
    ds_read_b128 v[132:135], v3 offset:26624
    ds_read_b128 v[128:131], v3 offset:24576
    v_mfma_f32_16x16x32_bf16 v[200:203], v[168:171], v[80:83], v[200:203]
    v_exp_f32 v95, v95
    buffer_load_dwordx4 v2, s[28:31], s68 offen offset:2048 sc1 lds
    v_mfma_f32_16x16x32_bf16 v[204:207], v[172:175], v[80:83], v[204:207]
    ds_read_b128 v[136:139], v3 offset:28672
    v_cvt_pk_bf16_f32 v91, v94, v95
    v_mfma_f32_16x16x32_bf16 v[208:211], v[176:179], v[80:83], v[208:211]
    v_exp_f32 v64, v64
    buffer_load_dwordx4 v2, s[28:31], s68 offen offset:3072 sc1 lds
    s_mov_b32 m0, s55
    s_add_u32 s56, s56, 4
    buffer_load_dword v20, s[24:27], s56 offen lds
    v_mfma_f32_16x16x32_bf16 v[212:215], v[180:183], v[80:83], v[212:215]
    ds_read_b128 v[144:147], v3 offset:25600
    ds_read_b128 v[140:143], v3 offset:30720
    v_mfma_f32_16x16x32_bf16 v[216:219], v[184:187], v[80:83], v[216:219]
    v_exp_f32 v65, v65
    s_add_u32 s70, s70, 0x8000
    s_and_b32 s70, s70, 0x1ffff
    v_mfma_f32_16x16x32_bf16 v[220:223], v[188:191], v[80:83], v[220:223]
    ds_read_b128 v[148:151], v3 offset:27648
    v_cvt_pk_bf16_f32 v64, v64, v65
    v_mfma_f32_16x16x32_bf16 v[112:115], v[120:123], v[80:83], v[112:115]
    v_exp_f32 v66, v66
    v_mfma_f32_16x16x32_bf16 v[224:227], v[160:163], v[88:91], v[224:227]
    ds_read_b128 v[156:159], v3 offset:31744
    ds_read_b128 v[152:155], v3 offset:29696
    v_mfma_f32_16x16x32_bf16 v[228:231], v[164:167], v[88:91], v[228:231]
    v_exp_f32 v67, v67
    v_mfma_f32_16x16x32_bf16 v[232:235], v[168:171], v[88:91], v[232:235]
    v_cvt_pk_bf16_f32 v65, v66, v67
    v_cmp_ge_u32 vcc, s47, v13
    v_mfma_f32_16x16x32_bf16 v[236:239], v[172:175], v[88:91], v[236:239]
    v_exp_f32 v68, v68
    v_mfma_f32_16x16x32_bf16 v[240:243], v[176:179], v[88:91], v[240:243]
    s_cmp_eq_u32 s47, s45
    s_cselect_b32 s59, 1, 0
    v_mfma_f32_16x16x32_bf16 v[244:247], v[180:183], v[88:91], v[244:247]
    v_exp_f32 v69, v69
    v_mfma_f32_16x16x32_bf16 v[248:251], v[184:187], v[88:91], v[248:251]
    v_cvt_pk_bf16_f32 v66, v68, v69
    v_add_u32 v3, s71, v2
    v_mfma_f32_16x16x32_bf16 v[252:255], v[188:191], v[88:91], v[252:255]
    s_or_b32 s59, s59, vcc_lo
    v_mfma_f32_16x16x32_bf16 v[116:119], v[120:123], v[88:91], v[116:119]
    s_waitcnt lgkmcnt(0)
    ds_write_b32 v14, v16
    s_cbranch_scc0 KF_A_BODY
    s_mov_b32 s66, 0
KFN_42:
    ds_read_b32 v13, v12
    s_add_u32 s66, s66, 1
    s_cmp_gt_u32 s66, 200000
    s_waitcnt lgkmcnt(0)
    v_cmp_ge_u32 vcc, s47, v13
    s_cbranch_scc1 KFN_43
    s_cbranch_vccz KFN_43
    s_sleep 1
    s_branch KFN_42
KFN_43:
    s_cmp_lg_u32 s47, s45
    s_cbranch_scc1 KF_A_BODY
KF_A_TAIL:
    s_bitcmp0_b32 s44, 0
    s_cbranch_scc1 KF_A_TEVEN
    v_cndmask_b32 v96, v62, v60, s[78:79]
    v_cndmask_b32 v108, v62, v61, s[78:79]
    v_mov_b32 v100, v62
    v_cndmask_b32 v97, v62, v60, s[80:81]
    v_cndmask_b32 v109, v62, v61, s[80:81]
    v_mov_b32 v101, v62
    v_cndmask_b32 v98, v62, v60, s[82:83]
    v_cndmask_b32 v110, v62, v61, s[82:83]
    v_mov_b32 v102, v62
    v_cndmask_b32 v99, v62, v60, s[84:85]
    v_cndmask_b32 v111, v62, v61, s[84:85]
    v_mov_b32 v103, v62
    s_nop 1
    v_mfma_f32_16x16x32_bf16 v[80:83], v[128:131], v[28:31], v[96:99]
    v_exp_f32 v70, v70
    v_mfma_f32_16x16x32_bf16 v[80:83], v[132:135], v[32:35], v[80:83]
    ds_read_b128 v[164:167], v3 offset:1024
    ds_read_b128 v[160:163], v3 offset:0
    v_mfma_f32_16x16x32_bf16 v[80:83], v[136:139], v[36:39], v[80:83]
    v_exp_f32 v71, v71
    v_mfma_f32_16x16x32_bf16 v[80:83], v[140:143], v[40:43], v[80:83]
    ds_read_b128 v[168:171], v3 offset:2048
    v_cvt_pk_bf16_f32 v67, v70, v71
    v_mfma_f32_16x16x32_bf16 v[88:91], v[128:131], v[44:47], v[104:107]
    v_exp_f32 v72, v72
    v_mfma_f32_16x16x32_bf16 v[88:91], v[132:135], v[48:51], v[88:91]
    ds_read_b128 v[176:179], v3 offset:4096
    ds_read_b128 v[172:175], v3 offset:3072
    v_mfma_f32_16x16x32_bf16 v[88:91], v[136:139], v[52:55], v[88:91]
    v_exp_f32 v73, v73
    v_mfma_f32_16x16x32_bf16 v[88:91], v[140:143], v[56:59], v[88:91]
    ds_read_b128 v[180:183], v3 offset:5120
    v_cvt_pk_bf16_f32 v72, v72, v73
    v_mfma_f32_16x16x32_bf16 v[84:87], v[144:147], v[28:31], v[100:103]
    v_exp_f32 v74, v74
    v_mfma_f32_16x16x32_bf16 v[84:87], v[148:151], v[32:35], v[84:87]
    ds_read_b128 v[188:191], v3 offset:7168
    ds_read_b128 v[184:187], v3 offset:6144
    v_mfma_f32_16x16x32_bf16 v[84:87], v[152:155], v[36:39], v[84:87]
    v_exp_f32 v75, v75
    v_mfma_f32_16x16x32_bf16 v[84:87], v[156:159], v[40:43], v[84:87]
    v_cvt_pk_bf16_f32 v73, v74, v75
    v_mfma_f32_16x16x32_bf16 v[92:95], v[144:147], v[44:47], v[108:111]
    v_exp_f32 v76, v76
    v_mfma_f32_16x16x32_bf16 v[92:95], v[148:151], v[48:51], v[92:95]
    v_mfma_f32_16x16x32_bf16 v[92:95], v[152:155], v[52:55], v[92:95]
    v_exp_f32 v77, v77
    v_mfma_f32_16x16x32_bf16 v[92:95], v[156:159], v[56:59], v[92:95]
    v_cvt_pk_bf16_f32 v74, v76, v77
    s_waitcnt lgkmcnt(0)
    v_mfma_f32_16x16x32_bf16 v[192:195], v[160:163], v[64:67], v[192:195]
    v_exp_f32 v78, v78
    v_mfma_f32_16x16x32_bf16 v[196:199], v[164:167], v[64:67], v[196:199]
    ds_read_b128 v[132:135], v3 offset:9216
    ds_read_b128 v[128:131], v3 offset:8192
    v_mfma_f32_16x16x32_bf16 v[200:203], v[168:171], v[64:67], v[200:203]
    v_exp_f32 v79, v79
    v_mfma_f32_16x16x32_bf16 v[204:207], v[172:175], v[64:67], v[204:207]
    ds_read_b128 v[136:139], v3 offset:10240
    v_cvt_pk_bf16_f32 v75, v78, v79
    v_mfma_f32_16x16x32_bf16 v[208:211], v[176:179], v[64:67], v[208:211]
    v_exp_f32 v80, v80
    v_mfma_f32_16x16x32_bf16 v[212:215], v[180:183], v[64:67], v[212:215]
    ds_read_b128 v[144:147], v3 offset:12288
    ds_read_b128 v[140:143], v3 offset:11264
    v_mfma_f32_16x16x32_bf16 v[216:219], v[184:187], v[64:67], v[216:219]
    v_exp_f32 v81, v81
    v_mfma_f32_16x16x32_bf16 v[220:223], v[188:191], v[64:67], v[220:223]
    ds_read_b128 v[148:151], v3 offset:13312
    v_cvt_pk_bf16_f32 v80, v80, v81
    v_mfma_f32_16x16x32_bf16 v[112:115], v[120:123], v[64:67], v[112:115]
    v_exp_f32 v82, v82
    v_mfma_f32_16x16x32_bf16 v[224:227], v[160:163], v[72:75], v[224:227]
    ds_read_b128 v[156:159], v3 offset:15360
    ds_read_b128 v[152:155], v3 offset:14336
    v_mfma_f32_16x16x32_bf16 v[228:231], v[164:167], v[72:75], v[228:231]
    v_exp_f32 v83, v83
    v_mfma_f32_16x16x32_bf16 v[232:235], v[168:171], v[72:75], v[232:235]
    v_cvt_pk_bf16_f32 v81, v82, v83
    v_mfma_f32_16x16x32_bf16 v[236:239], v[172:175], v[72:75], v[236:239]
    v_exp_f32 v84, v84
    v_mfma_f32_16x16x32_bf16 v[240:243], v[176:179], v[72:75], v[240:243]
    v_mfma_f32_16x16x32_bf16 v[244:247], v[180:183], v[72:75], v[244:247]
    v_exp_f32 v85, v85
    v_mfma_f32_16x16x32_bf16 v[248:251], v[184:187], v[72:75], v[248:251]
    v_cvt_pk_bf16_f32 v82, v84, v85
    v_mfma_f32_16x16x32_bf16 v[252:255], v[188:191], v[72:75], v[252:255]
    v_mfma_f32_16x16x32_bf16 v[116:119], v[120:123], v[72:75], v[116:119]
    s_waitcnt lgkmcnt(0)
    v_exp_f32 v86, v86
    v_exp_f32 v87, v87
    s_nop 0
    v_cvt_pk_bf16_f32 v83, v86, v87
    s_waitcnt lgkmcnt(0)
    v_mov_b32 v16, 0x7ffffff0
    ds_write_b32 v14, v16
    v_mfma_f32_16x16x32_bf16 v[192:195], v[128:131], v[80:83], v[192:195]
    v_exp_f32 v88, v88
    v_mfma_f32_16x16x32_bf16 v[196:199], v[132:135], v[80:83], v[196:199]
    v_exp_f32 v89, v89
    v_mfma_f32_16x16x32_bf16 v[200:203], v[136:139], v[80:83], v[200:203]
    v_exp_f32 v90, v90
    v_cvt_pk_bf16_f32 v88, v88, v89
    v_mfma_f32_16x16x32_bf16 v[204:207], v[140:143], v[80:83], v[204:207]
    v_exp_f32 v91, v91
    v_mfma_f32_16x16x32_bf16 v[208:211], v[144:147], v[80:83], v[208:211]
    v_exp_f32 v92, v92
    v_cvt_pk_bf16_f32 v89, v90, v91
    v_mfma_f32_16x16x32_bf16 v[212:215], v[148:151], v[80:83], v[212:215]
    v_exp_f32 v93, v93
    v_mfma_f32_16x16x32_bf16 v[216:219], v[152:155], v[80:83], v[216:219]
    v_exp_f32 v94, v94
    v_cvt_pk_bf16_f32 v90, v92, v93
    v_mfma_f32_16x16x32_bf16 v[220:223], v[156:159], v[80:83], v[220:223]
    v_exp_f32 v95, v95
    v_mfma_f32_16x16x32_bf16 v[112:115], v[120:123], v[80:83], v[112:115]
    v_cvt_pk_bf16_f32 v91, v94, v95
    s_nop 1
    v_mfma_f32_16x16x32_bf16 v[224:227], v[128:131], v[88:91], v[224:227]
    v_mfma_f32_16x16x32_bf16 v[228:231], v[132:135], v[88:91], v[228:231]
    v_mfma_f32_16x16x32_bf16 v[232:235], v[136:139], v[88:91], v[232:235]
    v_mfma_f32_16x16x32_bf16 v[236:239], v[140:143], v[88:91], v[236:239]
    v_mfma_f32_16x16x32_bf16 v[240:243], v[144:147], v[88:91], v[240:243]
    v_mfma_f32_16x16x32_bf16 v[244:247], v[148:151], v[88:91], v[244:247]
    v_mfma_f32_16x16x32_bf16 v[248:251], v[152:155], v[88:91], v[248:251]
    v_mfma_f32_16x16x32_bf16 v[252:255], v[156:159], v[88:91], v[252:255]
    v_mfma_f32_16x16x32_bf16 v[116:119], v[120:123], v[88:91], v[116:119]
    s_branch KF_A_EPI
KF_A_MSK:
    v_cndmask_b32 v96, v62, v60, s[78:79]
    v_cndmask_b32 v108, v62, v61, s[78:79]
    v_mov_b32 v100, v62
    v_cndmask_b32 v97, v62, v60, s[80:81]
    v_cndmask_b32 v109, v62, v61, s[80:81]
    v_mov_b32 v101, v62
    v_cndmask_b32 v98, v62, v60, s[82:83]
    v_cndmask_b32 v110, v62, v61, s[82:83]
    v_mov_b32 v102, v62
    v_cndmask_b32 v99, v62, v60, s[84:85]
    v_cndmask_b32 v111, v62, v61, s[84:85]
    v_mov_b32 v103, v62
    s_nop 0
    s_branch KF_A_MSKR
KF_A_DSL:
    s_mov_b32 s66, 0
KFN_44:
    ds_read_b32 v18, v17
    s_add_u32 s66, s66, 1
    s_cmp_gt_u32 s66, 200000
    s_waitcnt lgkmcnt(0)
    v_cmp_gt_u32 vcc, s47, v18
    s_cbranch_scc1 KFN_45
    s_cbranch_vccz KFN_45
    s_sleep 1
    s_branch KFN_44
KFN_45:
    s_branch KF_A_DSR
KF_A_TEVEN:
    ds_read_b128 v[160:163], v3 offset:0
    ds_read_b128 v[164:167], v3 offset:1024
    ds_read_b128 v[168:171], v3 offset:2048
    ds_read_b128 v[172:175], v3 offset:3072
    ds_read_b128 v[176:179], v3 offset:4096
    ds_read_b128 v[180:183], v3 offset:5120
    ds_read_b128 v[184:187], v3 offset:6144
    ds_read_b128 v[188:191], v3 offset:7168
    v_exp_f32 v70, v70
    v_exp_f32 v71, v71
    s_nop 0
    v_cvt_pk_bf16_f32 v67, v70, v71
    s_waitcnt lgkmcnt(0)
    v_mov_b32 v16, 0x7ffffff0
    ds_write_b32 v14, v16
    v_mfma_f32_16x16x32_bf16 v[192:195], v[160:163], v[64:67], v[192:195]
    v_exp_f32 v72, v72
    v_mfma_f32_16x16x32_bf16 v[196:199], v[164:167], v[64:67], v[196:199]
    v_exp_f32 v73, v73
    v_mfma_f32_16x16x32_bf16 v[200:203], v[168:171], v[64:67], v[200:203]
    v_exp_f32 v74, v74
    v_cvt_pk_bf16_f32 v72, v72, v73
    v_mfma_f32_16x16x32_bf16 v[204:207], v[172:175], v[64:67], v[204:207]
    v_exp_f32 v75, v75
    v_mfma_f32_16x16x32_bf16 v[208:211], v[176:179], v[64:67], v[208:211]
    v_exp_f32 v76, v76
    v_cvt_pk_bf16_f32 v73, v74, v75
    v_mfma_f32_16x16x32_bf16 v[212:215], v[180:183], v[64:67], v[212:215]
    v_exp_f32 v77, v77
    v_mfma_f32_16x16x32_bf16 v[216:219], v[184:187], v[64:67], v[216:219]
    v_exp_f32 v78, v78
    v_cvt_pk_bf16_f32 v74, v76, v77
    v_mfma_f32_16x16x32_bf16 v[220:223], v[188:191], v[64:67], v[220:223]
    v_exp_f32 v79, v79
    v_mfma_f32_16x16x32_bf16 v[112:115], v[120:123], v[64:67], v[112:115]
    v_cvt_pk_bf16_f32 v75, v78, v79
    s_nop 1
    v_mfma_f32_16x16x32_bf16 v[224:227], v[160:163], v[72:75], v[224:227]
    v_mfma_f32_16x16x32_bf16 v[228:231], v[164:167], v[72:75], v[228:231]
    v_mfma_f32_16x16x32_bf16 v[232:235], v[168:171], v[72:75], v[232:235]
    v_mfma_f32_16x16x32_bf16 v[236:239], v[172:175], v[72:75], v[236:239]
    v_mfma_f32_16x16x32_bf16 v[240:243], v[176:179], v[72:75], v[240:243]
    v_mfma_f32_16x16x32_bf16 v[244:247], v[180:183], v[72:75], v[244:247]
    v_mfma_f32_16x16x32_bf16 v[248:251], v[184:187], v[72:75], v[248:251]
    v_mfma_f32_16x16x32_bf16 v[252:255], v[188:191], v[72:75], v[252:255]
    v_mfma_f32_16x16x32_bf16 v[116:119], v[120:123], v[72:75], v[116:119]
KF_A_EPI:
    s_add_u32 s59, s47, 3
    s_cmp_lt_u32 s59, s46
    s_cbranch_scc1 KFL_46
    s_waitcnt vmcnt(0)
    s_branch KFL_47
KFL_46:
    s_mov_b32 s66, 0
KFN_48:
    ds_read_b32 v18, v17
    s_add_u32 s66, s66, 1
    s_cmp_gt_u32 s66, 200000
    s_waitcnt lgkmcnt(0)
    v_cmp_ge_u32 vcc, s47, v18
    s_cbranch_scc1 KFN_49
    s_cbranch_vccz KFN_49
    s_sleep 2
    s_branch KFN_48
KFN_49:
    s_add_u32 m0, s69, s70
    s_nop 0
    buffer_load_dwordx4 v2, s[32:35], s68 offen offset:0 sc1 lds
    buffer_load_dwordx4 v2, s[32:35], s68 offen offset:1024 sc1 lds
    buffer_load_dwordx4 v2, s[32:35], s68 offen offset:2048 sc1 lds
    buffer_load_dwordx4 v2, s[32:35], s68 offen offset:3072 sc1 lds
    s_add_u32 m0, m0, 16384
    s_add_u32 s68, s68, 16384
    buffer_load_dwordx4 v2, s[28:31], s68 offen offset:0 sc1 lds
    buffer_load_dwordx4 v2, s[28:31], s68 offen offset:1024 sc1 lds
    buffer_load_dwordx4 v2, s[28:31], s68 offen offset:2048 sc1 lds
    buffer_load_dwordx4 v2, s[28:31], s68 offen offset:3072 sc1 lds
    s_mov_b32 m0, s55
    s_add_u32 s56, s56, 4
    buffer_load_dword v20, s[24:27], s56 offen lds
    s_add_u32 s70, s70, 0x8000
    s_and_b32 s70, s70, 0x1ffff
    s_add_u32 s47, s47, 1
KFL_47:
    v_maximum3_f32 v10, |v192|, |v193|, |v194|
    v_maximum3_f32 v11, |v195|, |v196|, |v197|
    v_maximum3_f32 v10, v10, |v198|, |v199|
    v_maximum3_f32 v11, v11, |v200|, |v201|
    v_maximum3_f32 v10, v10, |v202|, |v203|
    v_maximum3_f32 v11, v11, |v204|, |v205|
    v_maximum3_f32 v10, v10, |v206|, |v207|
    v_maximum3_f32 v11, v11, |v208|, |v209|
    v_maximum3_f32 v10, v10, |v210|, |v211|
    v_maximum3_f32 v11, v11, |v212|, |v213|
    v_maximum3_f32 v10, v10, |v214|, |v215|
    v_maximum3_f32 v11, v11, |v216|, |v217|
    v_maximum3_f32 v10, v10, |v218|, |v219|
    v_maximum3_f32 v11, v11, |v220|, |v221|
    v_maximum3_f32 v10, v10, |v222|, |v223|
    v_maximum3_f32 v11, v11, |v224|, |v225|
    v_maximum3_f32 v10, v10, |v226|, |v227|
    v_maximum3_f32 v11, v11, |v228|, |v229|
    v_maximum3_f32 v10, v10, |v230|, |v231|
    v_maximum3_f32 v11, v11, |v232|, |v233|
    v_maximum3_f32 v10, v10, |v234|, |v235|
    v_maximum3_f32 v11, v11, |v236|, |v237|
    v_maximum3_f32 v10, v10, |v238|, |v239|
    v_maximum3_f32 v11, v11, |v240|, |v241|
    v_maximum3_f32 v10, v10, |v242|, |v243|
    v_maximum3_f32 v11, v11, |v244|, |v245|
    v_maximum3_f32 v10, v10, |v246|, |v247|
    v_maximum3_f32 v11, v11, |v248|, |v249|
    v_maximum3_f32 v10, v10, |v250|, |v251|
    v_maximum3_f32 v11, v11, |v252|, |v253|
    v_maximum3_f32 v10, v10, |v254|, |v255|
    v_maximum3_f32 v10, v10, v11, v11
    v_maximum3_f32 v11, v112, v116, v116
    v_mov_b32 v4, 0x7f7fffff
    v_mov_b32 v5, 0x5f800000
    v_cmp_nle_f32 vcc, v10, v4
    v_cmp_nle_f32 s[62:63], v11, v5
    s_nop 0
    s_or_b64 vcc, vcc, s[62:63]
    s_cselect_b32 s72, 1, 0
    s_cbranch_scc1 KFL_50
    v_rcp_f32 v10, v112
    v_rcp_f32 v11, v116
    s_lshr_b32 s59, s44, 2
    s_lshl_b32 s59, s59, 20
    s_lshl_b32 s60, s41, 15
    s_add_u32 s59, s59, s60
    s_and_b32 s60, s44, 3
    s_lshl_b32 s60, s60, 11
    s_add_u32 s59, s59, s60
    v_mul_f32 v192, v192, v10
    v_mul_f32 v193, v193, v10
    v_mul_f32 v194, v194, v10
    v_mul_f32 v195, v195, v10
    v_mul_f32 v196, v196, v10
    v_mul_f32 v197, v197, v10
    v_mul_f32 v198, v198, v10
    v_mul_f32 v199, v199, v10
    v_cvt_pk_bf16_f32 v192, v192, v193
    v_cvt_pk_bf16_f32 v193, v194, v195
    v_cvt_pk_bf16_f32 v194, v196, v197
    v_cvt_pk_bf16_f32 v195, v198, v199
    buffer_store_dwordx4 v[192:195], v2, s[20:23], s59 offen offset:0 sc1
    v_mul_f32 v224, v224, v11
    v_mul_f32 v225, v225, v11
    v_mul_f32 v226, v226, v11
    v_mul_f32 v227, v227, v11
    v_mul_f32 v228, v228, v11
    v_mul_f32 v229, v229, v11
    v_mul_f32 v230, v230, v11
    v_mul_f32 v231, v231, v11
    v_cvt_pk_bf16_f32 v224, v224, v225
    v_cvt_pk_bf16_f32 v225, v226, v227
    v_cvt_pk_bf16_f32 v226, v228, v229
    v_cvt_pk_bf16_f32 v227, v230, v231
    buffer_store_dwordx4 v[224:227], v2, s[20:23], s59 offen offset:1024 sc1
    s_add_u32 s59, s59, 8192
    v_mul_f32 v200, v200, v10
    v_mul_f32 v201, v201, v10
    v_mul_f32 v202, v202, v10
    v_mul_f32 v203, v203, v10
    v_mul_f32 v204, v204, v10
    v_mul_f32 v205, v205, v10
    v_mul_f32 v206, v206, v10
    v_mul_f32 v207, v207, v10
    v_cvt_pk_bf16_f32 v200, v200, v201
    v_cvt_pk_bf16_f32 v201, v202, v203
    v_cvt_pk_bf16_f32 v202, v204, v205
    v_cvt_pk_bf16_f32 v203, v206, v207
    buffer_store_dwordx4 v[200:203], v2, s[20:23], s59 offen offset:0 sc1
    v_mul_f32 v232, v232, v11
    v_mul_f32 v233, v233, v11
    v_mul_f32 v234, v234, v11
    v_mul_f32 v235, v235, v11
    v_mul_f32 v236, v236, v11
    v_mul_f32 v237, v237, v11
    v_mul_f32 v238, v238, v11
    v_mul_f32 v239, v239, v11
    v_cvt_pk_bf16_f32 v232, v232, v233
    v_cvt_pk_bf16_f32 v233, v234, v235
    v_cvt_pk_bf16_f32 v234, v236, v237
    v_cvt_pk_bf16_f32 v235, v238, v239
    buffer_store_dwordx4 v[232:235], v2, s[20:23], s59 offen offset:1024 sc1
    s_add_u32 s59, s59, 8192
    v_mul_f32 v208, v208, v10
    v_mul_f32 v209, v209, v10
    v_mul_f32 v210, v210, v10
    v_mul_f32 v211, v211, v10
    v_mul_f32 v212, v212, v10
    v_mul_f32 v213, v213, v10
    v_mul_f32 v214, v214, v10
    v_mul_f32 v215, v215, v10
    v_cvt_pk_bf16_f32 v208, v208, v209
    v_cvt_pk_bf16_f32 v209, v210, v211
    v_cvt_pk_bf16_f32 v210, v212, v213
    v_cvt_pk_bf16_f32 v211, v214, v215
    buffer_store_dwordx4 v[208:211], v2, s[20:23], s59 offen offset:0 sc1
    v_mul_f32 v240, v240, v11
    v_mul_f32 v241, v241, v11
    v_mul_f32 v242, v242, v11
    v_mul_f32 v243, v243, v11
    v_mul_f32 v244, v244, v11
    v_mul_f32 v245, v245, v11
    v_mul_f32 v246, v246, v11
    v_mul_f32 v247, v247, v11
    v_cvt_pk_bf16_f32 v240, v240, v241
    v_cvt_pk_bf16_f32 v241, v242, v243
    v_cvt_pk_bf16_f32 v242, v244, v245
    v_cvt_pk_bf16_f32 v243, v246, v247
    buffer_store_dwordx4 v[240:243], v2, s[20:23], s59 offen offset:1024 sc1
    s_add_u32 s59, s59, 8192
    v_mul_f32 v216, v216, v10
    v_mul_f32 v217, v217, v10
    v_mul_f32 v218, v218, v10
    v_mul_f32 v219, v219, v10
    v_mul_f32 v220, v220, v10
    v_mul_f32 v221, v221, v10
    v_mul_f32 v222, v222, v10
    v_mul_f32 v223, v223, v10
    v_cvt_pk_bf16_f32 v216, v216, v217
    v_cvt_pk_bf16_f32 v217, v218, v219
    v_cvt_pk_bf16_f32 v218, v220, v221
    v_cvt_pk_bf16_f32 v219, v222, v223
    buffer_store_dwordx4 v[216:219], v2, s[20:23], s59 offen offset:0 sc1
    v_mul_f32 v248, v248, v11
    v_mul_f32 v249, v249, v11
    v_mul_f32 v250, v250, v11
    v_mul_f32 v251, v251, v11
    v_mul_f32 v252, v252, v11
    v_mul_f32 v253, v253, v11
    v_mul_f32 v254, v254, v11
    v_mul_f32 v255, v255, v11
    v_cvt_pk_bf16_f32 v248, v248, v249
    v_cvt_pk_bf16_f32 v249, v250, v251
    v_cvt_pk_bf16_f32 v250, v252, v253
    v_cvt_pk_bf16_f32 v251, v254, v255
    buffer_store_dwordx4 v[248:251], v2, s[20:23], s59 offen offset:1024 sc1
KFL_50:
    s_setprio 2
    s_add_u32 s59, s47, 3
    s_cmp_lt_u32 s59, s46
    s_cbranch_scc1 KFL_51
    s_waitcnt vmcnt(0)
    s_branch KFL_52
KFL_51:
    s_mov_b32 s66, 0
KFN_53:
    ds_read_b32 v18, v17
    s_add_u32 s66, s66, 1
    s_cmp_gt_u32 s66, 200000
    s_waitcnt lgkmcnt(0)
    v_cmp_ge_u32 vcc, s47, v18
    s_cbranch_scc1 KFN_54
    s_cbranch_vccz KFN_54
    s_sleep 2
    s_branch KFN_53
KFN_54:
    s_add_u32 m0, s69, s70
    s_nop 0
    buffer_load_dwordx4 v2, s[32:35], s68 offen offset:0 sc1 lds
    s_sleep 2
    buffer_load_dwordx4 v2, s[32:35], s68 offen offset:1024 sc1 lds
    s_sleep 1
    buffer_load_dwordx4 v2, s[32:35], s68 offen offset:2048 sc1 lds
    s_sleep 2
    buffer_load_dwordx4 v2, s[32:35], s68 offen offset:3072 sc1 lds
    s_sleep 1
    s_add_u32 m0, m0, 16384
    s_add_u32 s68, s68, 16384
    buffer_load_dwordx4 v2, s[28:31], s68 offen offset:0 sc1 lds
    s_sleep 2
    buffer_load_dwordx4 v2, s[28:31], s68 offen offset:1024 sc1 lds
    s_sleep 1
    buffer_load_dwordx4 v2, s[28:31], s68 offen offset:2048 sc1 lds
    s_sleep 2
    buffer_load_dwordx4 v2, s[28:31], s68 offen offset:3072 sc1 lds
    s_mov_b32 m0, s55
    s_add_u32 s56, s56, 4
    buffer_load_dword v20, s[24:27], s56 offen lds
    s_add_u32 s70, s70, 0x8000
    s_and_b32 s70, s70, 0x1ffff
    s_add_u32 s47, s47, 1
KFL_52:
    s_cmp_lg_u32 s72, 0
    s_cbranch_scc1 KFL_55
    s_waitcnt vmcnt(9)
    s_lshr_b32 s59, s44, 2
    s_lshl_b32 s59, s59, 9
    s_lshl_b32 s60, s41, 4
    s_add_u32 s59, s59, s60
    s_and_b32 s60, s44, 3
    s_lshl_b32 s60, s60, 2
    s_add_u32 s59, s59, s60
    s_add_u32 s59, s59, 2301952
    v_mov_b32 v4, 0
    v_mov_b32 v5, 1
    s_mov_b64 exec, 1
    buffer_store_dword v5, v4, s[24:27], s59 offen sc1
    s_mov_b64 exec, -1
KFL_55:
    s_cmp_gt_u32 s42, 3
    s_cbranch_scc1 KF_A_LD
    s_sub_u32 s51, s42, 1
    s_and_b32 s51, s51, 3
    s_lshl_b32 s51, s51, 4
    s_bitcmp0_b32 s41, 0
    s_cbranch_scc1 KF_A_LD
    s_and_b32 s59, s41, 2
    s_lshl_b32 s59, s59, 2
    s_add_u32 s51, s51, s59
    s_and_b32 s59, s2, 7
    s_add_u32 s51, s51, s59
    s_cmp_ge_u32 s51, 56
    s_cbranch_scc1 KF_A_LD
    s_cmp_lt_u32 s43, 2
    s_cselect_b32 s4, s92, s94
    s_cselect_b32 s5, s93, s95
    s_and_b32 s5, s5, 0xffff
    s_mov_b32 s6, 0x1c0000
    s_mov_b32 s7, 0x00020000
    s_mov_b32 s8, s96
    s_and_b32 s9, s97, 0xffff
    s_mov_b32 s10, 0x1c0000
    s_mov_b32 s11, 0x00020000
    s_add_u32 s49, s55, 1024
    s_lshl_b32 s50, s2, 8
    s_add_u32 s50, s50, 2162688
    s_lshl_b32 s75, s42, 1
    s_add_u32 s75, s75, 3
    s_max_u32 s75, s75, 7
KFL_56:
    s_cmp_ge_u32 s47, s75
    s_cbranch_scc1 KFL_57
    s_mov_b32 s66, 0
KFN_58:
    ds_read_b32 v18, v17
    s_add_u32 s66, s66, 1
    s_cmp_gt_u32 s66, 200000
    s_waitcnt lgkmcnt(0)
    v_cmp_ge_u32 vcc, s47, v18
    s_cbranch_scc1 KFN_59
    s_cbranch_vccz KFN_59
    s_sleep 2
    s_branch KFN_58
KFN_59:
    s_add_u32 m0, s69, s70
    s_nop 0
    buffer_load_dwordx4 v2, s[32:35], s68 offen offset:0 sc1 lds
    s_sleep 2
    buffer_load_dwordx4 v2, s[32:35], s68 offen offset:1024 sc1 lds
    s_sleep 1
    buffer_load_dwordx4 v2, s[32:35], s68 offen offset:2048 sc1 lds
    s_sleep 2
    buffer_load_dwordx4 v2, s[32:35], s68 offen offset:3072 sc1 lds
    s_sleep 1
    s_add_u32 m0, m0, 16384
    s_add_u32 s68, s68, 16384
    buffer_load_dwordx4 v2, s[28:31], s68 offen offset:0 sc1 lds
    s_sleep 2
    buffer_load_dwordx4 v2, s[28:31], s68 offen offset:1024 sc1 lds
    s_sleep 1
    buffer_load_dwordx4 v2, s[28:31], s68 offen offset:2048 sc1 lds
    s_sleep 2
    buffer_load_dwordx4 v2, s[28:31], s68 offen offset:3072 sc1 lds
    s_mov_b32 m0, s55
    s_add_u32 s56, s56, 4
    buffer_load_dword v20, s[24:27], s56 offen lds
    s_add_u32 s70, s70, 0x8000
    s_and_b32 s70, s70, 0x1ffff
    s_add_u32 s47, s47, 1
    s_branch KFL_56
KFL_57:
    s_mov_b32 s86, 2097152
    buffer_load_dwordx4 v[160:163], v2, s[24:27], s86 offen offset:0 sc1
    buffer_load_dwordx4 v[164:167], v2, s[24:27], s86 offen offset:1024 sc1
    buffer_load_dwordx4 v[168:171], v2, s[24:27], s86 offen offset:2048 sc1
    buffer_load_dwordx4 v[172:175], v2, s[24:27], s86 offen offset:3072 sc1
    s_mov_b32 s86, 2101248
    buffer_load_dwordx4 v[176:179], v2, s[24:27], s86 offen offset:0 sc1
    buffer_load_dwordx4 v[180:183], v2, s[24:27], s86 offen offset:1024 sc1
    buffer_load_dwordx4 v[184:187], v2, s[24:27], s86 offen offset:2048 sc1
    buffer_load_dwordx4 v[188:191], v2, s[24:27], s86 offen offset:3072 sc1
    s_add_u32 s59, s47, 3
    s_cmp_lt_u32 s59, s46
    s_cbranch_scc1 KFL_60
    s_waitcnt vmcnt(0)
    s_branch KFL_61
KFL_60:
    s_mov_b32 s66, 0
KFN_62:
    ds_read_b32 v18, v17
    s_add_u32 s66, s66, 1
    s_cmp_gt_u32 s66, 200000
    s_waitcnt lgkmcnt(0)
    v_cmp_ge_u32 vcc, s47, v18
    s_cbranch_scc1 KFN_63
    s_cbranch_vccz KFN_63
    s_sleep 2
    s_branch KFN_62
KFN_63:
    s_add_u32 m0, s69, s70
    s_nop 0
    buffer_load_dwordx4 v2, s[32:35], s68 offen offset:0 sc1 lds
    s_sleep 2
    buffer_load_dwordx4 v2, s[32:35], s68 offen offset:1024 sc1 lds
    s_sleep 1
    buffer_load_dwordx4 v2, s[32:35], s68 offen offset:2048 sc1 lds
    s_sleep 2
    buffer_load_dwordx4 v2, s[32:35], s68 offen offset:3072 sc1 lds
    s_sleep 1
    s_add_u32 m0, m0, 16384
    s_add_u32 s68, s68, 16384
    buffer_load_dwordx4 v2, s[28:31], s68 offen offset:0 sc1 lds
    s_sleep 2
    buffer_load_dwordx4 v2, s[28:31], s68 offen offset:1024 sc1 lds
    s_sleep 1
    buffer_load_dwordx4 v2, s[28:31], s68 offen offset:2048 sc1 lds
    s_sleep 2
    buffer_load_dwordx4 v2, s[28:31], s68 offen offset:3072 sc1 lds
    s_mov_b32 m0, s55
    s_add_u32 s56, s56, 4
    buffer_load_dword v20, s[24:27], s56 offen lds
    s_add_u32 s70, s70, 0x8000
    s_and_b32 s70, s70, 0x1ffff
    s_add_u32 s47, s47, 1
KFL_61:
    s_lshl_b32 s94, s43, 12
    s_add_u32 s94, s94, 131072
    s_lshl_b32 s93, s43, 11
    s_add_u32 s93, s93, 155648
    v_lshrrev_b32 v6, 2, v1
    v_and_b32 v5, 3, v1
    v_lshlrev_b32 v4, 10, v6
    v_lshl_add_u32 v4, v5, 4, v4
    v_lshlrev_b32 v7, 6, v6
    v_lshl_add_u32 v7, v5, 3, v7
    v_add_u32 v7, s93, v7
    v_mul_u32_u24 v6, 3584, v6
    v_lshl_add_u32 v6, v5, 4, v6
    s_lshl_b32 s91, s51, 15
    s_lshl_b32 s87, s43, 8
    s_add_u32 s91, s91, s87
    s_lshl_b32 s95, s51, 6
    s_and_b32 s87, s43, 1
    s_mul_i32 s88, s87, 229376
    s_add_u32 s95, s95, s88
    v_lshrrev_b32 v8, 4, v1
    v_lshlrev_b32 v8, 9, v8
    v_lshl_add_u32 v8, v5, 3, v8
    v_bfe_u32 v5, v1, 2, 2
    v_lshl_add_u32 v8, v5, 6, v8
    s_lshr_b32 s88, s43, 1
    s_lshl_b32 s88, s88, 13
    s_lshl_b32 s87, s87, 5
    s_add_u32 s88, s88, s87
    s_add_u32 s88, s88, 131072
    v_add_u32 v8, s88, v8
    s_add_u32 m0, s94, 0
    s_add_u32 s87, s95, 0
    buffer_load_dwordx4 v6, s[4:7], s87 offen lds
    s_sleep 1
    s_add_u32 m0, s94, 1024
    s_add_u32 s87, s95, 57344
    buffer_load_dwordx4 v6, s[4:7], s87 offen lds
    s_sleep 1
    s_add_u32 m0, s94, 2048
    s_add_u32 s87, s95, 114688
    buffer_load_dwordx4 v6, s[4:7], s87 offen lds
    s_sleep 1
    s_add_u32 m0, s94, 3072
    s_add_u32 s87, s95, 172032
    buffer_load_dwordx4 v6, s[4:7], s87 offen lds
    s_sleep 1
    s_add_u32 m0, s93, 0
    s_add_u32 s87, s91, 0
    buffer_load_dwordx4 v4, s[8:11], s87 offen lds
    s_sleep 1
    s_add_u32 m0, s93, 1024
    s_add_u32 s87, s91, 16384
    buffer_load_dwordx4 v4, s[8:11], s87 offen lds
    s_sleep 1
    s_sub_u32 m0, s49, 4
    s_nop 0
    buffer_load_dword v20, s[24:27], s50 offen offset:4 lds
    s_add_u32 s59, s47, 3
    s_cmp_lt_u32 s59, s46
    s_cbranch_scc1 KFL_64
    s_waitcnt vmcnt(0)
    s_branch KFL_65
KFL_64:
    s_mov_b32 s66, 0
KFN_66:
    ds_read_b32 v18, v17
    s_add_u32 s66, s66, 1
    s_cmp_gt_u32 s66, 200000
    s_waitcnt lgkmcnt(0)
    v_cmp_ge_u32 vcc, s47, v18
    s_cbranch_scc1 KFN_67
    s_cbranch_vccz KFN_67
    s_sleep 2
    s_branch KFN_66
KFN_67:
    s_add_u32 m0, s69, s70
    s_nop 0
    buffer_load_dwordx4 v2, s[32:35], s68 offen offset:0 sc1 lds
    s_sleep 2
    buffer_load_dwordx4 v2, s[32:35], s68 offen offset:1024 sc1 lds
    s_sleep 1
    buffer_load_dwordx4 v2, s[32:35], s68 offen offset:2048 sc1 lds
    s_sleep 2
    buffer_load_dwordx4 v2, s[32:35], s68 offen offset:3072 sc1 lds
    s_sleep 1
    s_add_u32 m0, m0, 16384
    s_add_u32 s68, s68, 16384
    buffer_load_dwordx4 v2, s[28:31], s68 offen offset:0 sc1 lds
    s_sleep 2
    buffer_load_dwordx4 v2, s[28:31], s68 offen offset:1024 sc1 lds
    s_sleep 1
    buffer_load_dwordx4 v2, s[28:31], s68 offen offset:2048 sc1 lds
    s_sleep 2
    buffer_load_dwordx4 v2, s[28:31], s68 offen offset:3072 sc1 lds
    s_mov_b32 m0, s55
    s_add_u32 s56, s56, 4
    buffer_load_dword v20, s[24:27], s56 offen lds
    s_add_u32 s70, s70, 0x8000
    s_and_b32 s70, s70, 0x1ffff
    s_add_u32 s47, s47, 1
KFL_65:
    s_waitcnt vmcnt(25)
    v_max3_u32 v9, v160, v161, v162
    v_max3_u32 v9, v9, v163, v164
    v_max3_u32 v9, v9, v165, v166
    v_max3_u32 v9, v9, v167, v168
    v_max3_u32 v9, v9, v169, v170
    v_max3_u32 v9, v9, v171, v172
    v_max3_u32 v9, v9, v173, v174
    v_max3_u32 v9, v9, v175, v176
    v_max3_u32 v9, v9, v177, v178
    v_max3_u32 v9, v9, v179, v180
    v_max3_u32 v9, v9, v181, v182
    v_max3_u32 v9, v9, v183, v184
    v_max3_u32 v9, v9, v185, v186
    v_max3_u32 v9, v9, v187, v188
    v_max3_u32 v9, v9, v189, v190
    v_max_u32 v9, v9, v191
    s_nop 1
    v_max_u32_dpp v9, v9, v9 quad_perm:[1,0,3,2] row_mask:0xf bank_mask:0xf
    s_nop 1
    v_max_u32_dpp v9, v9, v9 quad_perm:[2,3,0,1] row_mask:0xf bank_mask:0xf
    s_nop 1
    v_max_u32_dpp v9, v9, v9 row_half_mirror row_mask:0xf bank_mask:0xf
    s_nop 1
    v_max_u32_dpp v9, v9, v9 row_mirror row_mask:0xf bank_mask:0xf
    s_nop 0
    v_readlane_b32 s86, v9, 0
    v_readlane_b32 s87, v9, 16
    v_readlane_b32 s88, v9, 32
    v_readlane_b32 s89, v9, 48
    s_nop 0
    s_max_u32 s86, s86, s87
    s_max_u32 s88, s88, s89
    s_max_u32 s90, s86, s88
    s_and_b32 s86, s90, 0x7ff
    s_sub_u32 s86, 2047, s86
    s_lshr_b32 s92, s86, 4
    s_lshl_b32 s92, s92, 14
    s_and_b32 s88, s86, 15
    s_lshl_b32 s88, s88, 4
    s_add_u32 s92, s92, s88
    v_lshrrev_b32 v11, 4, v1
    v_lshlrev_b32 v11, 8, v11
    s_add_u32 s88, s92, 0
    buffer_load_dwordx4 v[160:163], v11, s[24:27], s88 offen offset:0 sc1
    buffer_load_dwordx4 v[164:167], v11, s[24:27], s88 offen offset:1024 sc1
    buffer_load_dwordx4 v[168:171], v11, s[24:27], s88 offen offset:2048 sc1
    buffer_load_dwordx4 v[172:175], v11, s[24:27], s88 offen offset:3072 sc1
    s_add_u32 s88, s92, 4096
    buffer_load_dwordx4 v[176:179], v11, s[24:27], s88 offen offset:0 sc1
    buffer_load_dwordx4 v[180:183], v11, s[24:27], s88 offen offset:1024 sc1
    buffer_load_dwordx4 v[184:187], v11, s[24:27], s88 offen offset:2048 sc1
    buffer_load_dwordx4 v[188:191], v11, s[24:27], s88 offen offset:3072 sc1
    s_add_u32 s59, s47, 3
    s_cmp_lt_u32 s59, s46
    s_cbranch_scc1 KFL_68
    s_waitcnt vmcnt(0)
    s_branch KFL_69
KFL_68:
    s_mov_b32 s66, 0
KFN_70:
    ds_read_b32 v18, v17
    s_add_u32 s66, s66, 1
    s_cmp_gt_u32 s66, 200000
    s_waitcnt lgkmcnt(0)
    v_cmp_ge_u32 vcc, s47, v18
    s_cbranch_scc1 KFN_71
    s_cbranch_vccz KFN_71
    s_sleep 2
    s_branch KFN_70
KFN_71:
    s_add_u32 m0, s69, s70
    s_nop 0
    buffer_load_dwordx4 v2, s[32:35], s68 offen offset:0 sc1 lds
    s_sleep 2
    buffer_load_dwordx4 v2, s[32:35], s68 offen offset:1024 sc1 lds
    s_sleep 1
    buffer_load_dwordx4 v2, s[32:35], s68 offen offset:2048 sc1 lds
    s_sleep 2
    buffer_load_dwordx4 v2, s[32:35], s68 offen offset:3072 sc1 lds
    s_sleep 1
    s_add_u32 m0, m0, 16384
    s_add_u32 s68, s68, 16384
    buffer_load_dwordx4 v2, s[28:31], s68 offen offset:0 sc1 lds
    s_sleep 2
    buffer_load_dwordx4 v2, s[28:31], s68 offen offset:1024 sc1 lds
    s_sleep 1
    buffer_load_dwordx4 v2, s[28:31], s68 offen offset:2048 sc1 lds
    s_sleep 2
    buffer_load_dwordx4 v2, s[28:31], s68 offen offset:3072 sc1 lds
    s_mov_b32 m0, s55
    s_add_u32 s56, s56, 4
    buffer_load_dword v20, s[24:27], s56 offen lds
    s_add_u32 s70, s70, 0x8000
    s_and_b32 s70, s70, 0x1ffff
    s_add_u32 s47, s47, 1
KFL_69:
    s_add_u32 s88, s92, 8192
    buffer_load_dwordx4 v[192:195], v11, s[24:27], s88 offen offset:0 sc1
    buffer_load_dwordx4 v[196:199], v11, s[24:27], s88 offen offset:1024 sc1
    buffer_load_dwordx4 v[200:203], v11, s[24:27], s88 offen offset:2048 sc1
    buffer_load_dwordx4 v[204:207], v11, s[24:27], s88 offen offset:3072 sc1
    s_add_u32 s88, s92, 12288
    buffer_load_dwordx4 v[208:211], v11, s[24:27], s88 offen offset:0 sc1
    buffer_load_dwordx4 v[212:215], v11, s[24:27], s88 offen offset:1024 sc1
    buffer_load_dwordx4 v[216:219], v11, s[24:27], s88 offen offset:2048 sc1
    buffer_load_dwordx4 v[220:223], v11, s[24:27], s88 offen offset:3072 sc1
    s_add_u32 s59, s47, 3
    s_cmp_lt_u32 s59, s46
    s_cbranch_scc1 KFL_72
    s_waitcnt vmcnt(0)
    s_branch KFL_73
KFL_72:
    s_mov_b32 s66, 0
KFN_74:
    ds_read_b32 v18, v17
    s_add_u32 s66, s66, 1
    s_cmp_gt_u32 s66, 200000
    s_waitcnt lgkmcnt(0)
    v_cmp_ge_u32 vcc, s47, v18
    s_cbranch_scc1 KFN_75
    s_cbranch_vccz KFN_75
    s_sleep 2
    s_branch KFN_74
KFN_75:
    s_add_u32 m0, s69, s70
    s_nop 0
    buffer_load_dwordx4 v2, s[32:35], s68 offen offset:0 sc1 lds
    s_sleep 2
    buffer_load_dwordx4 v2, s[32:35], s68 offen offset:1024 sc1 lds
    s_sleep 1
    buffer_load_dwordx4 v2, s[32:35], s68 offen offset:2048 sc1 lds
    s_sleep 2
    buffer_load_dwordx4 v2, s[32:35], s68 offen offset:3072 sc1 lds
    s_sleep 1
    s_add_u32 m0, m0, 16384
    s_add_u32 s68, s68, 16384
    buffer_load_dwordx4 v2, s[28:31], s68 offen offset:0 sc1 lds
    s_sleep 2
    buffer_load_dwordx4 v2, s[28:31], s68 offen offset:1024 sc1 lds
    s_sleep 1
    buffer_load_dwordx4 v2, s[28:31], s68 offen offset:2048 sc1 lds
    s_sleep 2
    buffer_load_dwordx4 v2, s[28:31], s68 offen offset:3072 sc1 lds
    s_mov_b32 m0, s55
    s_add_u32 s56, s56, 4
    buffer_load_dword v20, s[24:27], s56 offen lds
    s_add_u32 s70, s70, 0x8000
    s_and_b32 s70, s70, 0x1ffff
    s_add_u32 s47, s47, 1
KFL_73:
    s_mov_b32 s66, 0
KFN_76:
    ds_read_b32 v13, v22
    s_add_u32 s66, s66, 1
    s_cmp_gt_u32 s66, 200000
    s_waitcnt lgkmcnt(0)
    v_cmp_gt_u32 vcc, 1, v13
    s_cbranch_scc1 KFN_77
    s_cbranch_vccz KFN_77
    s_sleep 1
    s_branch KFN_76
KFN_77:
    s_waitcnt vmcnt(26)
    ds_read_b64_tr_b16 v[96:97], v8 offset:0
    ds_read_b64_tr_b16 v[98:99], v8 offset:256
    ds_read_b64_tr_b16 v[100:101], v8 offset:2048
    ds_read_b64_tr_b16 v[102:103], v8 offset:2304
    ds_read_b64_tr_b16 v[104:105], v8 offset:4096
    ds_read_b64_tr_b16 v[106:107], v8 offset:4352
    ds_read_b64_tr_b16 v[108:109], v8 offset:6144
    ds_read_b64_tr_b16 v[110:111], v8 offset:6400
    ds_read_b64_tr_b16 v[64:65], v7 offset:0
    ds_read_b64_tr_b16 v[66:67], v7 offset:1024
    ds_read_b64_tr_b16 v[68:69], v7 offset:32
    ds_read_b64_tr_b16 v[70:71], v7 offset:1056
    s_waitcnt lgkmcnt(0)
    s_sub_u32 m0, s49, 8
    s_nop 0
    buffer_load_dword v20, s[24:27], s50 offen offset:8 lds
    v_mfma_f32_16x16x32_bf16 v[224:227], v[96:99], v[160:163], 0
    v_mfma_f32_16x16x32_bf16 v[224:227], v[100:103], v[164:167], v[224:227]
    v_mfma_f32_16x16x32_bf16 v[224:227], v[104:107], v[168:171], v[224:227]
    v_mfma_f32_16x16x32_bf16 v[224:227], v[108:111], v[172:175], v[224:227]
    s_add_u32 s59, s47, 3
    s_cmp_lt_u32 s59, s46
    s_cbranch_scc1 KFL_78
    s_waitcnt vmcnt(0)
    s_branch KFL_79
KFL_78:
    s_mov_b32 s66, 0
KFN_80:
    ds_read_b32 v18, v17
    s_add_u32 s66, s66, 1
    s_cmp_gt_u32 s66, 200000
    s_waitcnt lgkmcnt(0)
    v_cmp_ge_u32 vcc, s47, v18
    s_cbranch_scc1 KFN_81
    s_cbranch_vccz KFN_81
    s_sleep 2
    s_branch KFN_80
KFN_81:
    s_add_u32 m0, s69, s70
    s_nop 0
    buffer_load_dwordx4 v2, s[32:35], s68 offen offset:0 sc1 lds
    s_sleep 2
    buffer_load_dwordx4 v2, s[32:35], s68 offen offset:1024 sc1 lds
    s_sleep 1
    buffer_load_dwordx4 v2, s[32:35], s68 offen offset:2048 sc1 lds
    s_sleep 2
    buffer_load_dwordx4 v2, s[32:35], s68 offen offset:3072 sc1 lds
    s_sleep 1
    s_add_u32 m0, m0, 16384
    s_add_u32 s68, s68, 16384
    buffer_load_dwordx4 v2, s[28:31], s68 offen offset:0 sc1 lds
    s_sleep 2
    buffer_load_dwordx4 v2, s[28:31], s68 offen offset:1024 sc1 lds
    s_sleep 1
    buffer_load_dwordx4 v2, s[28:31], s68 offen offset:2048 sc1 lds
    s_sleep 2
    buffer_load_dwordx4 v2, s[28:31], s68 offen offset:3072 sc1 lds
    s_mov_b32 m0, s55
    s_add_u32 s56, s56, 4
    buffer_load_dword v20, s[24:27], s56 offen lds
    s_add_u32 s70, s70, 0x8000
    s_and_b32 s70, s70, 0x1ffff
    s_add_u32 s47, s47, 1
KFL_79:
    s_mov_b32 s66, 0
KFN_82:
    ds_read_b32 v13, v22
    s_add_u32 s66, s66, 1
    s_cmp_gt_u32 s66, 200000
    s_waitcnt lgkmcnt(0)
    v_cmp_gt_u32 vcc, 2, v13
    s_cbranch_scc1 KFN_83
    s_cbranch_vccz KFN_83
    s_sleep 1
    s_branch KFN_82
KFN_83:
    s_add_u32 m0, s94, 0
    s_add_u32 s87, s95, 458752
    buffer_load_dwordx4 v6, s[4:7], s87 offen lds
    s_sleep 1
    s_add_u32 m0, s94, 1024
    s_add_u32 s87, s95, 516096
    buffer_load_dwordx4 v6, s[4:7], s87 offen lds
    s_sleep 1
    s_add_u32 m0, s94, 2048
    s_add_u32 s87, s95, 573440
    buffer_load_dwordx4 v6, s[4:7], s87 offen lds
    s_sleep 1
    s_add_u32 m0, s94, 3072
    s_add_u32 s87, s95, 630784
    buffer_load_dwordx4 v6, s[4:7], s87 offen lds
    s_sleep 1
    s_add_u32 m0, s93, 0
    s_add_u32 s87, s91, 64
    buffer_load_dwordx4 v4, s[8:11], s87 offen lds
    s_sleep 1
    s_add_u32 m0, s93, 1024
    s_add_u32 s87, s91, 16448
    buffer_load_dwordx4 v4, s[8:11], s87 offen lds
    s_sleep 1
    s_sub_u32 m0, s49, 12
    s_nop 0
    buffer_load_dword v20, s[24:27], s50 offen offset:12 lds
    s_add_u32 s59, s47, 3
    s_cmp_lt_u32 s59, s46
    s_cbranch_scc1 KFL_84
    s_waitcnt vmcnt(0)
    s_branch KFL_85
KFL_84:
    s_mov_b32 s66, 0
KFN_86:
    ds_read_b32 v18, v17
    s_add_u32 s66, s66, 1
    s_cmp_gt_u32 s66, 200000
    s_waitcnt lgkmcnt(0)
    v_cmp_ge_u32 vcc, s47, v18
    s_cbranch_scc1 KFN_87
    s_cbranch_vccz KFN_87
    s_sleep 2
    s_branch KFN_86
KFN_87:
    s_add_u32 m0, s69, s70
    s_nop 0
    buffer_load_dwordx4 v2, s[32:35], s68 offen offset:0 sc1 lds
    s_sleep 2
    buffer_load_dwordx4 v2, s[32:35], s68 offen offset:1024 sc1 lds
    s_sleep 1
    buffer_load_dwordx4 v2, s[32:35], s68 offen offset:2048 sc1 lds
    s_sleep 2
    buffer_load_dwordx4 v2, s[32:35], s68 offen offset:3072 sc1 lds
    s_sleep 1
    s_add_u32 m0, m0, 16384
    s_add_u32 s68, s68, 16384
    buffer_load_dwordx4 v2, s[28:31], s68 offen offset:0 sc1 lds
    s_sleep 2
    buffer_load_dwordx4 v2, s[28:31], s68 offen offset:1024 sc1 lds
    s_sleep 1
    buffer_load_dwordx4 v2, s[28:31], s68 offen offset:2048 sc1 lds
    s_sleep 2
    buffer_load_dwordx4 v2, s[28:31], s68 offen offset:3072 sc1 lds
    s_mov_b32 m0, s55
    s_add_u32 s56, s56, 4
    buffer_load_dword v20, s[24:27], s56 offen lds
    s_add_u32 s70, s70, 0x8000
    s_and_b32 s70, s70, 0x1ffff
    s_add_u32 s47, s47, 1
KFL_85:
    s_add_u32 s59, s47, 3
    s_cmp_lt_u32 s59, s46
    s_cbranch_scc1 KFL_88
    s_waitcnt vmcnt(0)
    s_branch KFL_89
KFL_88:
    s_mov_b32 s66, 0
KFN_90:
    ds_read_b32 v18, v17
    s_add_u32 s66, s66, 1
    s_cmp_gt_u32 s66, 200000
    s_waitcnt lgkmcnt(0)
    v_cmp_ge_u32 vcc, s47, v18
    s_cbranch_scc1 KFN_91
    s_cbranch_vccz KFN_91
    s_sleep 2
    s_branch KFN_90
KFN_91:
    s_add_u32 m0, s69, s70
    s_nop 0
    buffer_load_dwordx4 v2, s[32:35], s68 offen offset:0 sc1 lds
    s_sleep 2
    buffer_load_dwordx4 v2, s[32:35], s68 offen offset:1024 sc1 lds
    s_sleep 1
    buffer_load_dwordx4 v2, s[32:35], s68 offen offset:2048 sc1 lds
    s_sleep 2
    buffer_load_dwordx4 v2, s[32:35], s68 offen offset:3072 sc1 lds
    s_sleep 1
    s_add_u32 m0, m0, 16384
    s_add_u32 s68, s68, 16384
    buffer_load_dwordx4 v2, s[28:31], s68 offen offset:0 sc1 lds
    s_sleep 2
    buffer_load_dwordx4 v2, s[28:31], s68 offen offset:1024 sc1 lds
    s_sleep 1
    buffer_load_dwordx4 v2, s[28:31], s68 offen offset:2048 sc1 lds
    s_sleep 2
    buffer_load_dwordx4 v2, s[28:31], s68 offen offset:3072 sc1 lds
    s_mov_b32 m0, s55
    s_add_u32 s56, s56, 4
    buffer_load_dword v20, s[24:27], s56 offen lds
    s_add_u32 s70, s70, 0x8000
    s_and_b32 s70, s70, 0x1ffff
    s_add_u32 s47, s47, 1
KFL_89:
    s_mov_b32 s66, 0
KFN_92:
    ds_read_b32 v13, v22
    s_add_u32 s66, s66, 1
    s_cmp_gt_u32 s66, 200000
    s_waitcnt lgkmcnt(0)
    v_cmp_gt_u32 vcc, 3, v13
    s_cbranch_scc1 KFN_93
    s_cbranch_vccz KFN_93
    s_sleep 1
    s_branch KFN_92
KFN_93:
    ds_read_b64_tr_b16 v[96:97], v8 offset:0
    ds_read_b64_tr_b16 v[98:99], v8 offset:256
    ds_read_b64_tr_b16 v[100:101], v8 offset:2048
    ds_read_b64_tr_b16 v[102:103], v8 offset:2304
    ds_read_b64_tr_b16 v[104:105], v8 offset:4096
    ds_read_b64_tr_b16 v[106:107], v8 offset:4352
    ds_read_b64_tr_b16 v[108:109], v8 offset:6144
    ds_read_b64_tr_b16 v[110:111], v8 offset:6400
    ds_read_b64_tr_b16 v[72:73], v7 offset:0
    ds_read_b64_tr_b16 v[74:75], v7 offset:1024
    ds_read_b64_tr_b16 v[76:77], v7 offset:32
    ds_read_b64_tr_b16 v[78:79], v7 offset:1056
    s_waitcnt lgkmcnt(0)
    s_sub_u32 m0, s49, 16
    s_nop 0
    buffer_load_dword v20, s[24:27], s50 offen offset:16 lds
    v_mfma_f32_16x16x32_bf16 v[224:227], v[96:99], v[176:179], v[224:227]
    v_mfma_f32_16x16x32_bf16 v[224:227], v[100:103], v[180:183], v[224:227]
    v_mfma_f32_16x16x32_bf16 v[224:227], v[104:107], v[184:187], v[224:227]
    v_mfma_f32_16x16x32_bf16 v[224:227], v[108:111], v[188:191], v[224:227]
    s_add_u32 s59, s47, 3
    s_cmp_lt_u32 s59, s46
    s_cbranch_scc1 KFL_94
    s_waitcnt vmcnt(0)
    s_branch KFL_95
KFL_94:
    s_mov_b32 s66, 0
KFN_96:
    ds_read_b32 v18, v17
    s_add_u32 s66, s66, 1
    s_cmp_gt_u32 s66, 200000
    s_waitcnt lgkmcnt(0)
    v_cmp_ge_u32 vcc, s47, v18
    s_cbranch_scc1 KFN_97
    s_cbranch_vccz KFN_97
    s_sleep 2
    s_branch KFN_96
KFN_97:
    s_add_u32 m0, s69, s70
    s_nop 0
    buffer_load_dwordx4 v2, s[32:35], s68 offen offset:0 sc1 lds
    s_sleep 2
    buffer_load_dwordx4 v2, s[32:35], s68 offen offset:1024 sc1 lds
    s_sleep 1
    buffer_load_dwordx4 v2, s[32:35], s68 offen offset:2048 sc1 lds
    s_sleep 2
    buffer_load_dwordx4 v2, s[32:35], s68 offen offset:3072 sc1 lds
    s_sleep 1
    s_add_u32 m0, m0, 16384
    s_add_u32 s68, s68, 16384
    buffer_load_dwordx4 v2, s[28:31], s68 offen offset:0 sc1 lds
    s_sleep 2
    buffer_load_dwordx4 v2, s[28:31], s68 offen offset:1024 sc1 lds
    s_sleep 1
    buffer_load_dwordx4 v2, s[28:31], s68 offen offset:2048 sc1 lds
    s_sleep 2
    buffer_load_dwordx4 v2, s[28:31], s68 offen offset:3072 sc1 lds
    s_mov_b32 m0, s55
    s_add_u32 s56, s56, 4
    buffer_load_dword v20, s[24:27], s56 offen lds
    s_add_u32 s70, s70, 0x8000
    s_and_b32 s70, s70, 0x1ffff
    s_add_u32 s47, s47, 1
KFL_95:
    s_mov_b32 s66, 0
KFN_98:
    ds_read_b32 v13, v22
    s_add_u32 s66, s66, 1
    s_cmp_gt_u32 s66, 200000
    s_waitcnt lgkmcnt(0)
    v_cmp_gt_u32 vcc, 4, v13
    s_cbranch_scc1 KFN_99
    s_cbranch_vccz KFN_99
    s_sleep 1
    s_branch KFN_98
KFN_99:
    s_add_u32 m0, s94, 0
    s_add_u32 s87, s95, 917504
    buffer_load_dwordx4 v6, s[4:7], s87 offen lds
    s_sleep 1
    s_add_u32 m0, s94, 1024
    s_add_u32 s87, s95, 974848
    buffer_load_dwordx4 v6, s[4:7], s87 offen lds
    s_sleep 1
    s_add_u32 m0, s94, 2048
    s_add_u32 s87, s95, 1032192
    buffer_load_dwordx4 v6, s[4:7], s87 offen lds
    s_sleep 1
    s_add_u32 m0, s94, 3072
    s_add_u32 s87, s95, 1089536
    buffer_load_dwordx4 v6, s[4:7], s87 offen lds
    s_sleep 1
    s_add_u32 m0, s93, 0
    s_add_u32 s87, s91, 128
    buffer_load_dwordx4 v4, s[8:11], s87 offen lds
    s_sleep 1
    s_add_u32 m0, s93, 1024
    s_add_u32 s87, s91, 16512
    buffer_load_dwordx4 v4, s[8:11], s87 offen lds
    s_sleep 1
    s_sub_u32 m0, s49, 20
    s_nop 0
    buffer_load_dword v20, s[24:27], s50 offen offset:20 lds
    s_add_u32 s59, s47, 3
    s_cmp_lt_u32 s59, s46
    s_cbranch_scc1 KFL_100
    s_waitcnt vmcnt(0)
    s_branch KFL_101
KFL_100:
    s_mov_b32 s66, 0
KFN_102:
    ds_read_b32 v18, v17
    s_add_u32 s66, s66, 1
    s_cmp_gt_u32 s66, 200000
    s_waitcnt lgkmcnt(0)
    v_cmp_ge_u32 vcc, s47, v18
    s_cbranch_scc1 KFN_103
    s_cbranch_vccz KFN_103
    s_sleep 2
    s_branch KFN_102
KFN_103:
    s_add_u32 m0, s69, s70
    s_nop 0
    buffer_load_dwordx4 v2, s[32:35], s68 offen offset:0 sc1 lds
    s_sleep 2
    buffer_load_dwordx4 v2, s[32:35], s68 offen offset:1024 sc1 lds
    s_sleep 1
    buffer_load_dwordx4 v2, s[32:35], s68 offen offset:2048 sc1 lds
    s_sleep 2
    buffer_load_dwordx4 v2, s[32:35], s68 offen offset:3072 sc1 lds
    s_sleep 1
    s_add_u32 m0, m0, 16384
    s_add_u32 s68, s68, 16384
    buffer_load_dwordx4 v2, s[28:31], s68 offen offset:0 sc1 lds
    s_sleep 2
    buffer_load_dwordx4 v2, s[28:31], s68 offen offset:1024 sc1 lds
    s_sleep 1
    buffer_load_dwordx4 v2, s[28:31], s68 offen offset:2048 sc1 lds
    s_sleep 2
    buffer_load_dwordx4 v2, s[28:31], s68 offen offset:3072 sc1 lds
    s_mov_b32 m0, s55
    s_add_u32 s56, s56, 4
    buffer_load_dword v20, s[24:27], s56 offen lds
    s_add_u32 s70, s70, 0x8000
    s_and_b32 s70, s70, 0x1ffff
    s_add_u32 s47, s47, 1
KFL_101:
    s_add_u32 s59, s47, 3
    s_cmp_lt_u32 s59, s46
    s_cbranch_scc1 KFL_104
    s_waitcnt vmcnt(0)
    s_branch KFL_105
KFL_104:
    s_mov_b32 s66, 0
KFN_106:
    ds_read_b32 v18, v17
    s_add_u32 s66, s66, 1
    s_cmp_gt_u32 s66, 200000
    s_waitcnt lgkmcnt(0)
    v_cmp_ge_u32 vcc, s47, v18
    s_cbranch_scc1 KFN_107
    s_cbranch_vccz KFN_107
    s_sleep 2
    s_branch KFN_106
KFN_107:
    s_add_u32 m0, s69, s70
    s_nop 0
    buffer_load_dwordx4 v2, s[32:35], s68 offen offset:0 sc1 lds
    s_sleep 2
    buffer_load_dwordx4 v2, s[32:35], s68 offen offset:1024 sc1 lds
    s_sleep 1
    buffer_load_dwordx4 v2, s[32:35], s68 offen offset:2048 sc1 lds
    s_sleep 2
    buffer_load_dwordx4 v2, s[32:35], s68 offen offset:3072 sc1 lds
    s_sleep 1
    s_add_u32 m0, m0, 16384
    s_add_u32 s68, s68, 16384
    buffer_load_dwordx4 v2, s[28:31], s68 offen offset:0 sc1 lds
    s_sleep 2
    buffer_load_dwordx4 v2, s[28:31], s68 offen offset:1024 sc1 lds
    s_sleep 1
    buffer_load_dwordx4 v2, s[28:31], s68 offen offset:2048 sc1 lds
    s_sleep 2
    buffer_load_dwordx4 v2, s[28:31], s68 offen offset:3072 sc1 lds
    s_mov_b32 m0, s55
    s_add_u32 s56, s56, 4
    buffer_load_dword v20, s[24:27], s56 offen lds
    s_add_u32 s70, s70, 0x8000
    s_and_b32 s70, s70, 0x1ffff
    s_add_u32 s47, s47, 1
KFL_105:
    s_mov_b32 s66, 0
KFN_108:
    ds_read_b32 v13, v22
    s_add_u32 s66, s66, 1
    s_cmp_gt_u32 s66, 200000
    s_waitcnt lgkmcnt(0)
    v_cmp_gt_u32 vcc, 5, v13
    s_cbranch_scc1 KFN_109
    s_cbranch_vccz KFN_109
    s_sleep 1
    s_branch KFN_108
KFN_109:
    s_waitcnt vmcnt(63)
    ds_read_b64_tr_b16 v[96:97], v8 offset:0
    ds_read_b64_tr_b16 v[98:99], v8 offset:256
    ds_read_b64_tr_b16 v[100:101], v8 offset:2048
    ds_read_b64_tr_b16 v[102:103], v8 offset:2304
    ds_read_b64_tr_b16 v[104:105], v8 offset:4096
    ds_read_b64_tr_b16 v[106:107], v8 offset:4352
    ds_read_b64_tr_b16 v[108:109], v8 offset:6144
    ds_read_b64_tr_b16 v[110:111], v8 offset:6400
    ds_read_b64_tr_b16 v[80:81], v7 offset:0
    ds_read_b64_tr_b16 v[82:83], v7 offset:1024
    ds_read_b64_tr_b16 v[84:85], v7 offset:32
    ds_read_b64_tr_b16 v[86:87], v7 offset:1056
    s_waitcnt lgkmcnt(0)
    s_sub_u32 m0, s49, 24
    s_nop 0
    buffer_load_dword v20, s[24:27], s50 offen offset:24 lds
    v_mfma_f32_16x16x32_bf16 v[224:227], v[96:99], v[192:195], v[224:227]
    v_mfma_f32_16x16x32_bf16 v[224:227], v[100:103], v[196:199], v[224:227]
    v_mfma_f32_16x16x32_bf16 v[224:227], v[104:107], v[200:203], v[224:227]
    v_mfma_f32_16x16x32_bf16 v[224:227], v[108:111], v[204:207], v[224:227]
    s_add_u32 s59, s47, 3
    s_cmp_lt_u32 s59, s46
    s_cbranch_scc1 KFL_110
    s_waitcnt vmcnt(0)
    s_branch KFL_111
KFL_110:
    s_mov_b32 s66, 0
KFN_112:
    ds_read_b32 v18, v17
    s_add_u32 s66, s66, 1
    s_cmp_gt_u32 s66, 200000
    s_waitcnt lgkmcnt(0)
    v_cmp_ge_u32 vcc, s47, v18
    s_cbranch_scc1 KFN_113
    s_cbranch_vccz KFN_113
    s_sleep 2
    s_branch KFN_112
KFN_113:
    s_add_u32 m0, s69, s70
    s_nop 0
    buffer_load_dwordx4 v2, s[32:35], s68 offen offset:0 sc1 lds
    s_sleep 2
    buffer_load_dwordx4 v2, s[32:35], s68 offen offset:1024 sc1 lds
    s_sleep 1
    buffer_load_dwordx4 v2, s[32:35], s68 offen offset:2048 sc1 lds
    s_sleep 2
    buffer_load_dwordx4 v2, s[32:35], s68 offen offset:3072 sc1 lds
    s_sleep 1
    s_add_u32 m0, m0, 16384
    s_add_u32 s68, s68, 16384
    buffer_load_dwordx4 v2, s[28:31], s68 offen offset:0 sc1 lds
    s_sleep 2
    buffer_load_dwordx4 v2, s[28:31], s68 offen offset:1024 sc1 lds
    s_sleep 1
    buffer_load_dwordx4 v2, s[28:31], s68 offen offset:2048 sc1 lds
    s_sleep 2
    buffer_load_dwordx4 v2, s[28:31], s68 offen offset:3072 sc1 lds
    s_mov_b32 m0, s55
    s_add_u32 s56, s56, 4
    buffer_load_dword v20, s[24:27], s56 offen lds
    s_add_u32 s70, s70, 0x8000
    s_and_b32 s70, s70, 0x1ffff
    s_add_u32 s47, s47, 1
KFL_111:
    s_mov_b32 s66, 0
KFN_114:
    ds_read_b32 v13, v22
    s_add_u32 s66, s66, 1
    s_cmp_gt_u32 s66, 200000
    s_waitcnt lgkmcnt(0)
    v_cmp_gt_u32 vcc, 6, v13
    s_cbranch_scc1 KFN_115
    s_cbranch_vccz KFN_115
    s_sleep 1
    s_branch KFN_114
KFN_115:
    s_add_u32 m0, s94, 0
    s_add_u32 s87, s95, 1376256
    buffer_load_dwordx4 v6, s[4:7], s87 offen lds
    s_sleep 1
    s_add_u32 m0, s94, 1024
    s_add_u32 s87, s95, 1433600
    buffer_load_dwordx4 v6, s[4:7], s87 offen lds
    s_sleep 1
    s_add_u32 m0, s94, 2048
    s_add_u32 s87, s95, 1490944
    buffer_load_dwordx4 v6, s[4:7], s87 offen lds
    s_sleep 1
    s_add_u32 m0, s94, 3072
    s_add_u32 s87, s95, 1548288
    buffer_load_dwordx4 v6, s[4:7], s87 offen lds
    s_sleep 1
    s_add_u32 m0, s93, 0
    s_add_u32 s87, s91, 192
    buffer_load_dwordx4 v4, s[8:11], s87 offen lds
    s_sleep 1
    s_add_u32 m0, s93, 1024
    s_add_u32 s87, s91, 16576
    buffer_load_dwordx4 v4, s[8:11], s87 offen lds
    s_sleep 1
    s_sub_u32 m0, s49, 28
    s_nop 0
    buffer_load_dword v20, s[24:27], s50 offen offset:28 lds
    s_add_u32 s59, s47, 3
    s_cmp_lt_u32 s59, s46
    s_cbranch_scc1 KFL_116
    s_waitcnt vmcnt(0)
    s_branch KFL_117
KFL_116:
    s_mov_b32 s66, 0
KFN_118:
    ds_read_b32 v18, v17
    s_add_u32 s66, s66, 1
    s_cmp_gt_u32 s66, 200000
    s_waitcnt lgkmcnt(0)
    v_cmp_ge_u32 vcc, s47, v18
    s_cbranch_scc1 KFN_119
    s_cbranch_vccz KFN_119
    s_sleep 2
    s_branch KFN_118
KFN_119:
    s_add_u32 m0, s69, s70
    s_nop 0
    buffer_load_dwordx4 v2, s[32:35], s68 offen offset:0 sc1 lds
    s_sleep 2
    buffer_load_dwordx4 v2, s[32:35], s68 offen offset:1024 sc1 lds
    s_sleep 1
    buffer_load_dwordx4 v2, s[32:35], s68 offen offset:2048 sc1 lds
    s_sleep 2
    buffer_load_dwordx4 v2, s[32:35], s68 offen offset:3072 sc1 lds
    s_sleep 1
    s_add_u32 m0, m0, 16384
    s_add_u32 s68, s68, 16384
    buffer_load_dwordx4 v2, s[28:31], s68 offen offset:0 sc1 lds
    s_sleep 2
    buffer_load_dwordx4 v2, s[28:31], s68 offen offset:1024 sc1 lds
    s_sleep 1
    buffer_load_dwordx4 v2, s[28:31], s68 offen offset:2048 sc1 lds
    s_sleep 2
    buffer_load_dwordx4 v2, s[28:31], s68 offen offset:3072 sc1 lds
    s_mov_b32 m0, s55
    s_add_u32 s56, s56, 4
    buffer_load_dword v20, s[24:27], s56 offen lds
    s_add_u32 s70, s70, 0x8000
    s_and_b32 s70, s70, 0x1ffff
    s_add_u32 s47, s47, 1
KFL_117:
    s_add_u32 s59, s47, 3
    s_cmp_lt_u32 s59, s46
    s_cbranch_scc1 KFL_120
    s_waitcnt vmcnt(0)
    s_branch KFL_121
KFL_120:
    s_mov_b32 s66, 0
KFN_122:
    ds_read_b32 v18, v17
    s_add_u32 s66, s66, 1
    s_cmp_gt_u32 s66, 200000
    s_waitcnt lgkmcnt(0)
    v_cmp_ge_u32 vcc, s47, v18
    s_cbranch_scc1 KFN_123
    s_cbranch_vccz KFN_123
    s_sleep 2
    s_branch KFN_122
KFN_123:
    s_add_u32 m0, s69, s70
    s_nop 0
    buffer_load_dwordx4 v2, s[32:35], s68 offen offset:0 sc1 lds
    s_sleep 2
    buffer_load_dwordx4 v2, s[32:35], s68 offen offset:1024 sc1 lds
    s_sleep 1
    buffer_load_dwordx4 v2, s[32:35], s68 offen offset:2048 sc1 lds
    s_sleep 2
    buffer_load_dwordx4 v2, s[32:35], s68 offen offset:3072 sc1 lds
    s_sleep 1
    s_add_u32 m0, m0, 16384
    s_add_u32 s68, s68, 16384
    buffer_load_dwordx4 v2, s[28:31], s68 offen offset:0 sc1 lds
    s_sleep 2
    buffer_load_dwordx4 v2, s[28:31], s68 offen offset:1024 sc1 lds
    s_sleep 1
    buffer_load_dwordx4 v2, s[28:31], s68 offen offset:2048 sc1 lds
    s_sleep 2
    buffer_load_dwordx4 v2, s[28:31], s68 offen offset:3072 sc1 lds
    s_mov_b32 m0, s55
    s_add_u32 s56, s56, 4
    buffer_load_dword v20, s[24:27], s56 offen lds
    s_add_u32 s70, s70, 0x8000
    s_and_b32 s70, s70, 0x1ffff
    s_add_u32 s47, s47, 1
KFL_121:
    s_mov_b32 s66, 0
KFN_124:
    ds_read_b32 v13, v22
    s_add_u32 s66, s66, 1
    s_cmp_gt_u32 s66, 200000
    s_waitcnt lgkmcnt(0)
    v_cmp_gt_u32 vcc, 7, v13
    s_cbranch_scc1 KFN_125
    s_cbranch_vccz KFN_125
    s_sleep 1
    s_branch KFN_124
KFN_125:
    ds_read_b64_tr_b16 v[96:97], v8 offset:0
    ds_read_b64_tr_b16 v[98:99], v8 offset:256
    ds_read_b64_tr_b16 v[100:101], v8 offset:2048
    ds_read_b64_tr_b16 v[102:103], v8 offset:2304
    ds_read_b64_tr_b16 v[104:105], v8 offset:4096
    ds_read_b64_tr_b16 v[106:107], v8 offset:4352
    ds_read_b64_tr_b16 v[108:109], v8 offset:6144
    ds_read_b64_tr_b16 v[110:111], v8 offset:6400
    ds_read_b64_tr_b16 v[88:89], v7 offset:0
    ds_read_b64_tr_b16 v[90:91], v7 offset:1024
    ds_read_b64_tr_b16 v[92:93], v7 offset:32
    ds_read_b64_tr_b16 v[94:95], v7 offset:1056
    s_waitcnt lgkmcnt(0)
    s_sub_u32 m0, s49, 32
    s_nop 0
    buffer_load_dword v20, s[24:27], s50 offen offset:32 lds
    v_mfma_f32_16x16x32_bf16 v[224:227], v[96:99], v[208:211], v[224:227]
    v_mfma_f32_16x16x32_bf16 v[224:227], v[100:103], v[212:215], v[224:227]
    v_mfma_f32_16x16x32_bf16 v[224:227], v[104:107], v[216:219], v[224:227]
    v_mfma_f32_16x16x32_bf16 v[224:227], v[108:111], v[220:223], v[224:227]
    s_lshl_b32 s87, s43, 10
    s_add_u32 s87, s87, 151552
    v_add_u32 v4, s87, v2
    v_add_u32 v5, 151552, v2
    s_nop 4
    ds_write_b128 v4, v[224:227]
    s_waitcnt lgkmcnt(0)
    s_sub_u32 m0, s49, 36
    s_nop 0
    buffer_load_dword v20, s[24:27], s50 offen offset:36 lds
    s_add_u32 s59, s47, 3
    s_cmp_lt_u32 s59, s46
    s_cbranch_scc1 KFL_126
    s_waitcnt vmcnt(0)
    s_branch KFL_127
KFL_126:
    s_mov_b32 s66, 0
KFN_128:
    ds_read_b32 v18, v17
    s_add_u32 s66, s66, 1
    s_cmp_gt_u32 s66, 200000
    s_waitcnt lgkmcnt(0)
    v_cmp_ge_u32 vcc, s47, v18
    s_cbranch_scc1 KFN_129
    s_cbranch_vccz KFN_129
    s_sleep 2
    s_branch KFN_128
KFN_129:
    s_add_u32 m0, s69, s70
    s_nop 0
    buffer_load_dwordx4 v2, s[32:35], s68 offen offset:0 sc1 lds
    s_sleep 2
    buffer_load_dwordx4 v2, s[32:35], s68 offen offset:1024 sc1 lds
    s_sleep 1
    buffer_load_dwordx4 v2, s[32:35], s68 offen offset:2048 sc1 lds
    s_sleep 2
    buffer_load_dwordx4 v2, s[32:35], s68 offen offset:3072 sc1 lds
    s_sleep 1
    s_add_u32 m0, m0, 16384
    s_add_u32 s68, s68, 16384
    buffer_load_dwordx4 v2, s[28:31], s68 offen offset:0 sc1 lds
    s_sleep 2
    buffer_load_dwordx4 v2, s[28:31], s68 offen offset:1024 sc1 lds
    s_sleep 1
    buffer_load_dwordx4 v2, s[28:31], s68 offen offset:2048 sc1 lds
    s_sleep 2
    buffer_load_dwordx4 v2, s[28:31], s68 offen offset:3072 sc1 lds
    s_mov_b32 m0, s55
    s_add_u32 s56, s56, 4
    buffer_load_dword v20, s[24:27], s56 offen lds
    s_add_u32 s70, s70, 0x8000
    s_and_b32 s70, s70, 0x1ffff
    s_add_u32 s47, s47, 1
KFL_127:
    s_mov_b32 s66, 0
KFN_130:
    ds_read_b32 v13, v22
    s_add_u32 s66, s66, 1
    s_cmp_gt_u32 s66, 200000
    s_waitcnt lgkmcnt(0)
    v_cmp_gt_u32 vcc, 9, v13
    s_cbranch_scc1 KFN_131
    s_cbranch_vccz KFN_131
    s_sleep 1
    s_branch KFN_130
KFN_131:
    ds_read_b128 v[224:227], v5 offset:0
    ds_read_b128 v[228:231], v5 offset:1024
    ds_read_b128 v[232:235], v5 offset:2048
    ds_read_b128 v[236:239], v5 offset:3072
    s_waitcnt lgkmcnt(0)
    v_cvt_pk_bf16_f32 v96, v224, v225
    v_cvt_pk_bf16_f32 v97, v226, v227
    v_cvt_pk_bf16_f32 v98, v228, v229
    v_cvt_pk_bf16_f32 v99, v230, v231
    v_cvt_pk_bf16_f32 v100, v232, v233
    v_cvt_pk_bf16_f32 v101, v234, v235
    v_cvt_pk_bf16_f32 v102, v236, v237
    v_cvt_pk_bf16_f32 v103, v238, v239
    v_lshlrev_b32 v224, 16, v96
    v_lshlrev_b32 v232, 16, v100
    v_and_b32 v225, 0xffff0000, v96
    v_and_b32 v233, 0xffff0000, v100
    v_lshlrev_b32 v226, 16, v97
    v_lshlrev_b32 v234, 16, v101
    v_and_b32 v227, 0xffff0000, v97
    v_and_b32 v235, 0xffff0000, v101
    v_lshlrev_b32 v228, 16, v98
    v_lshlrev_b32 v236, 16, v102
    v_and_b32 v229, 0xffff0000, v98
    v_and_b32 v237, 0xffff0000, v102
    v_lshlrev_b32 v230, 16, v99
    v_lshlrev_b32 v238, 16, v103
    v_and_b32 v231, 0xffff0000, v99
    v_and_b32 v239, 0xffff0000, v103
    v_mul_f32 v96, 0xbfb8aa3b, v224
    v_mul_f32 v97, 0xbfb8aa3b, v225
    v_mul_f32 v98, 0xbfb8aa3b, v226
    v_mul_f32 v99, 0xbfb8aa3b, v227
    v_mul_f32 v100, 0xbfb8aa3b, v228
    v_mul_f32 v101, 0xbfb8aa3b, v229
    v_mul_f32 v102, 0xbfb8aa3b, v230
    v_mul_f32 v103, 0xbfb8aa3b, v231
    v_exp_f32 v96, v96
    v_exp_f32 v97, v97
    v_exp_f32 v98, v98
    v_exp_f32 v99, v99
    v_exp_f32 v100, v100
    v_exp_f32 v101, v101
    v_exp_f32 v102, v102
    v_exp_f32 v103, v103
    v_add_f32 v96, 1.0, v96
    v_add_f32 v97, 1.0, v97
    v_add_f32 v98, 1.0, v98
    v_add_f32 v99, 1.0, v99
    v_add_f32 v100, 1.0, v100
    v_add_f32 v101, 1.0, v101
    v_add_f32 v102, 1.0, v102
    v_add_f32 v103, 1.0, v103
    v_rcp_f32 v96, v96
    v_rcp_f32 v97, v97
    v_rcp_f32 v98, v98
    v_rcp_f32 v99, v99
    v_rcp_f32 v100, v100
    v_rcp_f32 v101, v101
    v_rcp_f32 v102, v102
    v_rcp_f32 v103, v103
    v_mul_f32 v224, v224, v96
    v_mul_f32 v225, v225, v97
    v_mul_f32 v226, v226, v98
    v_mul_f32 v227, v227, v99
    v_mul_f32 v228, v228, v100
    v_mul_f32 v229, v229, v101
    v_mul_f32 v230, v230, v102
    v_mul_f32 v231, v231, v103
    v_cvt_pk_bf16_f32 v96, v224, v225
    v_cvt_pk_bf16_f32 v97, v226, v227
    v_cvt_pk_bf16_f32 v98, v228, v229
    v_cvt_pk_bf16_f32 v99, v230, v231
    v_lshlrev_b32 v224, 16, v96
    v_and_b32 v225, 0xffff0000, v96
    v_lshlrev_b32 v226, 16, v97
    v_and_b32 v227, 0xffff0000, v97
    v_lshlrev_b32 v228, 16, v98
    v_and_b32 v229, 0xffff0000, v98
    v_lshlrev_b32 v230, 16, v99
    v_and_b32 v231, 0xffff0000, v99
    v_mul_f32 v224, v224, v232
    v_mul_f32 v225, v225, v233
    v_mul_f32 v226, v226, v234
    v_mul_f32 v227, v227, v235
    v_mul_f32 v228, v228, v236
    v_mul_f32 v229, v229, v237
    v_mul_f32 v230, v230, v238
    v_mul_f32 v231, v231, v239
    v_cvt_pk_bf16_f32 v232, v224, v225
    v_cvt_pk_bf16_f32 v233, v226, v227
    v_cvt_pk_bf16_f32 v234, v228, v229
    v_cvt_pk_bf16_f32 v235, v230, v231
    v_lshrrev_b32 v4, 4, v1
    v_lshlrev_b32 v4, 4, v4
    v_mfma_f32_16x16x32_bf16 v[96:99], v[64:67], v[232:235], 0
    v_mfma_f32_16x16x32_bf16 v[100:103], v[68:71], v[232:235], 0
    v_mfma_f32_16x16x32_bf16 v[104:107], v[72:75], v[232:235], 0
    v_mfma_f32_16x16x32_bf16 v[108:111], v[76:79], v[232:235], 0
    v_mfma_f32_16x16x32_bf16 v[112:115], v[80:83], v[232:235], 0
    v_mfma_f32_16x16x32_bf16 v[116:119], v[84:87], v[232:235], 0
    v_mfma_f32_16x16x32_bf16 v[120:123], v[88:91], v[232:235], 0
    v_mfma_f32_16x16x32_bf16 v[124:127], v[92:95], v[232:235], 0
    s_add_u32 s59, s47, 3
    s_cmp_lt_u32 s59, s46
    s_cbranch_scc1 KFL_132
    s_waitcnt vmcnt(0)
    s_branch KFL_133
KFL_132:
    s_mov_b32 s66, 0
KFN_134:
    ds_read_b32 v18, v17
    s_add_u32 s66, s66, 1
    s_cmp_gt_u32 s66, 200000
    s_waitcnt lgkmcnt(0)
    v_cmp_ge_u32 vcc, s47, v18
    s_cbranch_scc1 KFN_135
    s_cbranch_vccz KFN_135
    s_sleep 2
    s_branch KFN_134
KFN_135:
    s_add_u32 m0, s69, s70
    s_nop 0
    buffer_load_dwordx4 v2, s[32:35], s68 offen offset:0 sc1 lds
    s_sleep 2
    buffer_load_dwordx4 v2, s[32:35], s68 offen offset:1024 sc1 lds
    s_sleep 1
    buffer_load_dwordx4 v2, s[32:35], s68 offen offset:2048 sc1 lds
    s_sleep 2
    buffer_load_dwordx4 v2, s[32:35], s68 offen offset:3072 sc1 lds
    s_sleep 1
    s_add_u32 m0, m0, 16384
    s_add_u32 s68, s68, 16384
    buffer_load_dwordx4 v2, s[28:31], s68 offen offset:0 sc1 lds
    s_sleep 2
    buffer_load_dwordx4 v2, s[28:31], s68 offen offset:1024 sc1 lds
    s_sleep 1
    buffer_load_dwordx4 v2, s[28:31], s68 offen offset:2048 sc1 lds
    s_sleep 2
    buffer_load_dwordx4 v2, s[28:31], s68 offen offset:3072 sc1 lds
    s_mov_b32 m0, s55
    s_add_u32 s56, s56, 4
    buffer_load_dword v20, s[24:27], s56 offen lds
    s_add_u32 s70, s70, 0x8000
    s_and_b32 s70, s70, 0x1ffff
    s_add_u32 s47, s47, 1
KFL_133:
    s_lshl_b32 s86, s51, 11
    s_lshl_b32 s87, s43, 9
    s_add_u32 s86, s86, s87
    s_add_u32 s86, s86, 9322496
    s_mov_b32 exec_lo, 0x00010001
    s_mov_b32 exec_hi, 0x00010001
    buffer_store_dwordx4 v[96:99], v4, s[24:27], s86 offen offset:0 sc1
    buffer_store_dwordx4 v[100:103], v4, s[24:27], s86 offen offset:64 sc1
    buffer_store_dwordx4 v[104:107], v4, s[24:27], s86 offen offset:128 sc1
    buffer_store_dwordx4 v[108:111], v4, s[24:27], s86 offen offset:192 sc1
    buffer_store_dwordx4 v[112:115], v4, s[24:27], s86 offen offset:256 sc1
    buffer_store_dwordx4 v[116:119], v4, s[24:27], s86 offen offset:320 sc1
    buffer_store_dwordx4 v[120:123], v4, s[24:27], s86 offen offset:384 sc1
    buffer_store_dwordx4 v[124:127], v4, s[24:27], s86 offen offset:448 sc1
    s_mov_b64 exec, -1
    s_add_u32 s59, s47, 3
    s_cmp_lt_u32 s59, s46
    s_cbranch_scc1 KFL_136
    s_waitcnt vmcnt(0)
    s_branch KFL_137
KFL_136:
    s_mov_b32 s66, 0
KFN_138:
    ds_read_b32 v18, v17
    s_add_u32 s66, s66, 1
    s_cmp_gt_u32 s66, 200000
    s_waitcnt lgkmcnt(0)
    v_cmp_ge_u32 vcc, s47, v18
    s_cbranch_scc1 KFN_139
    s_cbranch_vccz KFN_139
    s_sleep 2
    s_branch KFN_138
KFN_139:
    s_add_u32 m0, s69, s70
    s_nop 0
    buffer_load_dwordx4 v2, s[32:35], s68 offen offset:0 sc1 lds
    s_sleep 2
    buffer_load_dwordx4 v2, s[32:35], s68 offen offset:1024 sc1 lds
    s_sleep 1
    buffer_load_dwordx4 v2, s[32:35], s68 offen offset:2048 sc1 lds
    s_sleep 2
    buffer_load_dwordx4 v2, s[32:35], s68 offen offset:3072 sc1 lds
    s_sleep 1
    s_add_u32 m0, m0, 16384
    s_add_u32 s68, s68, 16384
    buffer_load_dwordx4 v2, s[28:31], s68 offen offset:0 sc1 lds
    s_sleep 2
    buffer_load_dwordx4 v2, s[28:31], s68 offen offset:1024 sc1 lds
    s_sleep 1
    buffer_load_dwordx4 v2, s[28:31], s68 offen offset:2048 sc1 lds
    s_sleep 2
    buffer_load_dwordx4 v2, s[28:31], s68 offen offset:3072 sc1 lds
    s_mov_b32 m0, s55
    s_add_u32 s56, s56, 4
    buffer_load_dword v20, s[24:27], s56 offen lds
    s_add_u32 s70, s70, 0x8000
    s_and_b32 s70, s70, 0x1ffff
    s_add_u32 s47, s47, 1
KFL_137:
    s_waitcnt vmcnt(9)
    v_mov_b32 v4, 4
    v_mov_b32 v5, 1
    s_mov_b64 exec, 1
    buffer_atomic_add v5, v4, s[36:39], 0 offen sc1
    s_mov_b64 exec, -1
KF_A_LD:
    s_add_u32 s59, s47, 3
    s_cmp_ge_u32 s59, s46
    s_cbranch_scc1 KF_A_LDE
    s_mov_b32 s66, 0
KFN_140:
    ds_read_b32 v18, v17
    s_add_u32 s66, s66, 1
    s_cmp_gt_u32 s66, 200000
    s_waitcnt lgkmcnt(0)
    v_cmp_ge_u32 vcc, s47, v18
    s_cbranch_scc1 KFN_141
    s_cbranch_vccz KFN_141
    s_sleep 2
    s_branch KFN_140
KFN_141:
    s_add_u32 m0, s69, s70
    s_nop 0
    buffer_load_dwordx4 v2, s[32:35], s68 offen offset:0 sc1 lds
    s_sleep 2
    buffer_load_dwordx4 v2, s[32:35], s68 offen offset:1024 sc1 lds
    s_sleep 1
    buffer_load_dwordx4 v2, s[32:35], s68 offen offset:2048 sc1 lds
    s_sleep 2
    buffer_load_dwordx4 v2, s[32:35], s68 offen offset:3072 sc1 lds
    s_sleep 1
    s_add_u32 m0, m0, 16384
    s_add_u32 s68, s68, 16384
    buffer_load_dwordx4 v2, s[28:31], s68 offen offset:0 sc1 lds
    s_sleep 2
    buffer_load_dwordx4 v2, s[28:31], s68 offen offset:1024 sc1 lds
    s_sleep 1
    buffer_load_dwordx4 v2, s[28:31], s68 offen offset:2048 sc1 lds
    s_sleep 2
    buffer_load_dwordx4 v2, s[28:31], s68 offen offset:3072 sc1 lds
    s_mov_b32 m0, s55
    s_add_u32 s56, s56, 4
    buffer_load_dword v20, s[24:27], s56 offen lds
    s_add_u32 s70, s70, 0x8000
    s_and_b32 s70, s70, 0x1ffff
    s_add_u32 s47, s47, 1
    s_branch KF_A_LD
KF_A_LDE:
    s_waitcnt vmcnt(0)
    s_cmp_lg_u32 s72, 0
    s_cbranch_scc1 KF_FB
    s_mov_b32 s72, 2
    s_branch KF_D
KFS_34:
    s_mov_b32 s64, 0
KFL_142:
    s_sleep 8
    v_and_b32 v63, 7, v1
    v_lshlrev_b32 v63, 2, v63
    buffer_load_dword v63, v63, s[24:27], s76 offen sc1
    s_add_u32 s64, s64, 1
    s_cmp_gt_u32 s64, 100000
    s_waitcnt vmcnt(0)
    s_cbranch_scc1 KFR_35
    v_cmp_gt_u32 vcc, 1, v63
    s_nop 0
    s_bitcmp0_b32 vcc_lo, 0
    s_cbranch_scc0 KFL_142
    s_branch KFR_35
KFS_37:
    s_mov_b32 s64, 0
KFL_143:
    s_sleep 8
    v_and_b32 v63, 7, v1
    v_lshlrev_b32 v63, 2, v63
    buffer_load_dword v63, v63, s[24:27], s76 offen sc1
    s_add_u32 s64, s64, 1
    s_cmp_gt_u32 s64, 100000
    s_waitcnt vmcnt(0)
    s_cbranch_scc1 KFR_38
    v_cmp_gt_u32 vcc, 2, v63
    s_nop 0
    s_and_b32 s62, vcc_lo, s77
    s_cmp_eq_u32 s62, 0
    s_cbranch_scc0 KFL_143
    s_branch KFR_38
KF_FB:
    s_waitcnt vmcnt(0) lgkmcnt(0)
    v_mov_b32 v192, 0
    v_mov_b32 v193, 0
    v_mov_b32 v194, 0
    v_mov_b32 v195, 0
    v_mov_b32 v196, 0
    v_mov_b32 v197, 0
    v_mov_b32 v198, 0
    v_mov_b32 v199, 0
    v_mov_b32 v200, 0
    v_mov_b32 v201, 0
    v_mov_b32 v202, 0
    v_mov_b32 v203, 0
    v_mov_b32 v204, 0
    v_mov_b32 v205, 0
    v_mov_b32 v206, 0
    v_mov_b32 v207, 0
    v_mov_b32 v208, 0
    v_mov_b32 v209, 0
    v_mov_b32 v210, 0
    v_mov_b32 v211, 0
    v_mov_b32 v212, 0
    v_mov_b32 v213, 0
    v_mov_b32 v214, 0
    v_mov_b32 v215, 0
    v_mov_b32 v216, 0
    v_mov_b32 v217, 0
    v_mov_b32 v218, 0
    v_mov_b32 v219, 0
    v_mov_b32 v220, 0
    v_mov_b32 v221, 0
    v_mov_b32 v222, 0
    v_mov_b32 v223, 0
    v_mov_b32 v224, 0
    v_mov_b32 v225, 0
    v_mov_b32 v226, 0
    v_mov_b32 v227, 0
    v_mov_b32 v228, 0
    v_mov_b32 v229, 0
    v_mov_b32 v230, 0
    v_mov_b32 v231, 0
    v_mov_b32 v232, 0
    v_mov_b32 v233, 0
    v_mov_b32 v234, 0
    v_mov_b32 v235, 0
    v_mov_b32 v236, 0
    v_mov_b32 v237, 0
    v_mov_b32 v238, 0
    v_mov_b32 v239, 0
    v_mov_b32 v240, 0
    v_mov_b32 v241, 0
    v_mov_b32 v242, 0
    v_mov_b32 v243, 0
    v_mov_b32 v244, 0
    v_mov_b32 v245, 0
    v_mov_b32 v246, 0
    v_mov_b32 v247, 0
    v_mov_b32 v248, 0
    v_mov_b32 v249, 0
    v_mov_b32 v250, 0
    v_mov_b32 v251, 0
    v_mov_b32 v252, 0
    v_mov_b32 v253, 0
    v_mov_b32 v254, 0
    v_mov_b32 v255, 0
    v_mov_b32 v112, 0
    v_mov_b32 v113, 0
    v_mov_b32 v114, 0
    v_mov_b32 v115, 0
    v_mov_b32 v116, 0
    v_mov_b32 v117, 0
    v_mov_b32 v118, 0
    v_mov_b32 v119, 0
    v_mov_b32 v120, 0x3f803f80
    v_mov_b32 v121, 0x3f803f80
    v_mov_b32 v122, 0x3f803f80
    v_mov_b32 v123, 0x3f803f80
    v_mov_b32 v96, 0
    v_mov_b32 v97, 0
    v_mov_b32 v98, 0
    v_mov_b32 v99, 0
    v_mov_b32 v100, 0
    v_mov_b32 v101, 0
    v_mov_b32 v102, 0
    v_mov_b32 v103, 0
    v_mov_b32 v104, 0
    v_mov_b32 v105, 0
    v_mov_b32 v106, 0
    v_mov_b32 v107, 0
    v_mov_b32 v108, 0
    v_mov_b32 v109, 0
    v_mov_b32 v110, 0
    v_mov_b32 v111, 0
    v_mov_b32 v60, 0
    v_mov_b32 v61, 0
    v_mov_b32 v4, 0xff7fffff
    v_mov_b32 v5, 0xff7fffff
    s_mov_b32 s47, 0
KF_FBL:
    s_lshl_b32 s59, s47, 13
    s_add_u32 s60, s59, 4096
    buffer_load_dwordx4 v[128:131], v2, s[28:31], s59 offen offset:0 sc1
    buffer_load_dwordx4 v[132:135], v2, s[28:31], s59 offen offset:2048 sc1
    buffer_load_dwordx4 v[136:139], v2, s[28:31], s60 offen offset:0 sc1
    buffer_load_dwordx4 v[140:143], v2, s[28:31], s60 offen offset:2048 sc1
    buffer_load_dwordx4 v[144:147], v2, s[28:31], s59 offen offset:1024 sc1
    buffer_load_dwordx4 v[148:151], v2, s[28:31], s59 offen offset:3072 sc1
    buffer_load_dwordx4 v[152:155], v2, s[28:31], s60 offen offset:1024 sc1
    buffer_load_dwordx4 v[156:159], v2, s[28:31], s60 offen offset:3072 sc1
    buffer_load_dwordx4 v[160:163], v2, s[32:35], s59 offen offset:0 sc1
    buffer_load_dwordx4 v[164:167], v2, s[32:35], s59 offen offset:1024 sc1
    buffer_load_dwordx4 v[168:171], v2, s[32:35], s59 offen offset:2048 sc1
    buffer_load_dwordx4 v[172:175], v2, s[32:35], s59 offen offset:3072 sc1
    buffer_load_dwordx4 v[176:179], v2, s[32:35], s60 offen offset:0 sc1
    buffer_load_dwordx4 v[180:183], v2, s[32:35], s60 offen offset:1024 sc1
    buffer_load_dwordx4 v[184:187], v2, s[32:35], s60 offen offset:2048 sc1
    buffer_load_dwordx4 v[188:191], v2, s[32:35], s60 offen offset:3072 sc1
    s_cmp_lg_u32 s47, s44
    s_cbranch_scc1 KF_FBN
    v_cndmask_b32 v96, v62, v60, s[78:79]
    v_cndmask_b32 v108, v62, v61, s[78:79]
    v_mov_b32 v100, v62
    v_cndmask_b32 v97, v62, v60, s[80:81]
    v_cndmask_b32 v109, v62, v61, s[80:81]
    v_mov_b32 v101, v62
    v_cndmask_b32 v98, v62, v60, s[82:83]
    v_cndmask_b32 v110, v62, v61, s[82:83]
    v_mov_b32 v102, v62
    v_cndmask_b32 v99, v62, v60, s[84:85]
    v_cndmask_b32 v111, v62, v61, s[84:85]
    v_mov_b32 v103, v62
KF_FBN:
    s_waitcnt vmcnt(0)
    s_nop 0
    v_mfma_f32_16x16x32_bf16 v[64:67], v[128:131], v[28:31], v[96:99]
    v_mfma_f32_16x16x32_bf16 v[64:67], v[132:135], v[32:35], v[64:67]
    v_mfma_f32_16x16x32_bf16 v[64:67], v[136:139], v[36:39], v[64:67]
    v_mfma_f32_16x16x32_bf16 v[64:67], v[140:143], v[40:43], v[64:67]
    v_mfma_f32_16x16x32_bf16 v[72:75], v[128:131], v[44:47], v[104:107]
    v_mfma_f32_16x16x32_bf16 v[72:75], v[132:135], v[48:51], v[72:75]
    v_mfma_f32_16x16x32_bf16 v[72:75], v[136:139], v[52:55], v[72:75]
    v_mfma_f32_16x16x32_bf16 v[72:75], v[140:143], v[56:59], v[72:75]
    v_mfma_f32_16x16x32_bf16 v[68:71], v[144:147], v[28:31], v[100:103]
    v_mfma_f32_16x16x32_bf16 v[68:71], v[148:151], v[32:35], v[68:71]
    v_mfma_f32_16x16x32_bf16 v[68:71], v[152:155], v[36:39], v[68:71]
    v_mfma_f32_16x16x32_bf16 v[68:71], v[156:159], v[40:43], v[68:71]
    v_mfma_f32_16x16x32_bf16 v[76:79], v[144:147], v[44:47], v[108:111]
    v_mfma_f32_16x16x32_bf16 v[76:79], v[148:151], v[48:51], v[76:79]
    v_mfma_f32_16x16x32_bf16 v[76:79], v[152:155], v[52:55], v[76:79]
    v_mfma_f32_16x16x32_bf16 v[76:79], v[156:159], v[56:59], v[76:79]
    s_nop 7
    v_max3_f32 v6, v64, v65, v66
    v_max3_f32 v6, v6, v67, v68
    v_max3_f32 v6, v6, v69, v70
    v_max_f32 v6, v6, v71
    v_max3_f32 v7, v72, v73, v74
    v_max3_f32 v7, v7, v75, v76
    v_max3_f32 v7, v7, v77, v78
    v_max_f32 v7, v7, v79
    v_mov_b32 v10, v6
    v_mov_b32 v11, v7
    s_nop 1
    v_permlane16_swap_b32 v6, v10
    v_permlane16_swap_b32 v7, v11
    s_nop 0
    v_max_f32 v6, v6, v10
    v_max_f32 v7, v7, v11
    v_mov_b32 v10, v6
    v_mov_b32 v11, v7
    s_nop 1
    v_permlane32_swap_b32 v6, v10
    v_permlane32_swap_b32 v7, v11
    s_nop 0
    v_max_f32 v6, v6, v10
    v_max_f32 v7, v7, v11
    v_max_f32 v6, v6, v4
    v_sub_f32 v8, v4, v6
    v_exp_f32 v8, v8
    v_mov_b32 v4, v6
    v_max_f32 v7, v7, v5
    v_sub_f32 v9, v5, v7
    v_exp_f32 v9, v9
    v_mov_b32 v5, v7
    v_mul_f32 v192, v192, v8
    v_mul_f32 v193, v193, v8
    v_mul_f32 v194, v194, v8
    v_mul_f32 v195, v195, v8
    v_mul_f32 v196, v196, v8
    v_mul_f32 v197, v197, v8
    v_mul_f32 v198, v198, v8
    v_mul_f32 v199, v199, v8
    v_mul_f32 v200, v200, v8
    v_mul_f32 v201, v201, v8
    v_mul_f32 v202, v202, v8
    v_mul_f32 v203, v203, v8
    v_mul_f32 v204, v204, v8
    v_mul_f32 v205, v205, v8
    v_mul_f32 v206, v206, v8
    v_mul_f32 v207, v207, v8
    v_mul_f32 v208, v208, v8
    v_mul_f32 v209, v209, v8
    v_mul_f32 v210, v210, v8
    v_mul_f32 v211, v211, v8
    v_mul_f32 v212, v212, v8
    v_mul_f32 v213, v213, v8
    v_mul_f32 v214, v214, v8
    v_mul_f32 v215, v215, v8
    v_mul_f32 v216, v216, v8
    v_mul_f32 v217, v217, v8
    v_mul_f32 v218, v218, v8
    v_mul_f32 v219, v219, v8
    v_mul_f32 v220, v220, v8
    v_mul_f32 v221, v221, v8
    v_mul_f32 v222, v222, v8
    v_mul_f32 v223, v223, v8
    v_mul_f32 v112, v112, v8
    v_mul_f32 v113, v113, v8
    v_mul_f32 v114, v114, v8
    v_mul_f32 v115, v115, v8
    v_mul_f32 v224, v224, v9
    v_mul_f32 v225, v225, v9
    v_mul_f32 v226, v226, v9
    v_mul_f32 v227, v227, v9
    v_mul_f32 v228, v228, v9
    v_mul_f32 v229, v229, v9
    v_mul_f32 v230, v230, v9
    v_mul_f32 v231, v231, v9
    v_mul_f32 v232, v232, v9
    v_mul_f32 v233, v233, v9
    v_mul_f32 v234, v234, v9
    v_mul_f32 v235, v235, v9
    v_mul_f32 v236, v236, v9
    v_mul_f32 v237, v237, v9
    v_mul_f32 v238, v238, v9
    v_mul_f32 v239, v239, v9
    v_mul_f32 v240, v240, v9
    v_mul_f32 v241, v241, v9
    v_mul_f32 v242, v242, v9
    v_mul_f32 v243, v243, v9
    v_mul_f32 v244, v244, v9
    v_mul_f32 v245, v245, v9
    v_mul_f32 v246, v246, v9
    v_mul_f32 v247, v247, v9
    v_mul_f32 v248, v248, v9
    v_mul_f32 v249, v249, v9
    v_mul_f32 v250, v250, v9
    v_mul_f32 v251, v251, v9
    v_mul_f32 v252, v252, v9
    v_mul_f32 v253, v253, v9
    v_mul_f32 v254, v254, v9
    v_mul_f32 v255, v255, v9
    v_mul_f32 v116, v116, v9
    v_mul_f32 v117, v117, v9
    v_mul_f32 v118, v118, v9
    v_mul_f32 v119, v119, v9
    v_sub_f32 v64, v64, v4
    v_sub_f32 v65, v65, v4
    v_sub_f32 v66, v66, v4
    v_sub_f32 v67, v67, v4
    v_sub_f32 v68, v68, v4
    v_sub_f32 v69, v69, v4
    v_sub_f32 v70, v70, v4
    v_sub_f32 v71, v71, v4
    v_sub_f32 v72, v72, v5
    v_sub_f32 v73, v73, v5
    v_sub_f32 v74, v74, v5
    v_sub_f32 v75, v75, v5
    v_sub_f32 v76, v76, v5
    v_sub_f32 v77, v77, v5
    v_sub_f32 v78, v78, v5
    v_sub_f32 v79, v79, v5
    v_exp_f32 v64, v64
    v_exp_f32 v65, v65
    v_exp_f32 v66, v66
    v_exp_f32 v67, v67
    v_exp_f32 v68, v68
    v_exp_f32 v69, v69
    v_exp_f32 v70, v70
    v_exp_f32 v71, v71
    v_exp_f32 v72, v72
    v_exp_f32 v73, v73
    v_exp_f32 v74, v74
    v_exp_f32 v75, v75
    v_exp_f32 v76, v76
    v_exp_f32 v77, v77
    v_exp_f32 v78, v78
    v_exp_f32 v79, v79
    s_nop 0
    v_cvt_pk_bf16_f32 v64, v64, v65
    v_cvt_pk_bf16_f32 v65, v66, v67
    v_cvt_pk_bf16_f32 v66, v68, v69
    v_cvt_pk_bf16_f32 v67, v70, v71
    v_cvt_pk_bf16_f32 v72, v72, v73
    v_cvt_pk_bf16_f32 v73, v74, v75
    v_cvt_pk_bf16_f32 v74, v76, v77
    v_cvt_pk_bf16_f32 v75, v78, v79
    s_nop 1
    v_mfma_f32_16x16x32_bf16 v[192:195], v[160:163], v[64:67], v[192:195]
    v_mfma_f32_16x16x32_bf16 v[196:199], v[164:167], v[64:67], v[196:199]
    v_mfma_f32_16x16x32_bf16 v[200:203], v[168:171], v[64:67], v[200:203]
    v_mfma_f32_16x16x32_bf16 v[204:207], v[172:175], v[64:67], v[204:207]
    v_mfma_f32_16x16x32_bf16 v[208:211], v[176:179], v[64:67], v[208:211]
    v_mfma_f32_16x16x32_bf16 v[212:215], v[180:183], v[64:67], v[212:215]
    v_mfma_f32_16x16x32_bf16 v[216:219], v[184:187], v[64:67], v[216:219]
    v_mfma_f32_16x16x32_bf16 v[220:223], v[188:191], v[64:67], v[220:223]
    v_mfma_f32_16x16x32_bf16 v[112:115], v[120:123], v[64:67], v[112:115]
    v_mfma_f32_16x16x32_bf16 v[224:227], v[160:163], v[72:75], v[224:227]
    v_mfma_f32_16x16x32_bf16 v[228:231], v[164:167], v[72:75], v[228:231]
    v_mfma_f32_16x16x32_bf16 v[232:235], v[168:171], v[72:75], v[232:235]
    v_mfma_f32_16x16x32_bf16 v[236:239], v[172:175], v[72:75], v[236:239]
    v_mfma_f32_16x16x32_bf16 v[240:243], v[176:179], v[72:75], v[240:243]
    v_mfma_f32_16x16x32_bf16 v[244:247], v[180:183], v[72:75], v[244:247]
    v_mfma_f32_16x16x32_bf16 v[248:251], v[184:187], v[72:75], v[248:251]
    v_mfma_f32_16x16x32_bf16 v[252:255], v[188:191], v[72:75], v[252:255]
    v_mfma_f32_16x16x32_bf16 v[116:119], v[120:123], v[72:75], v[116:119]
    s_add_u32 s47, s47, 1
    s_cmp_le_u32 s47, s44
    s_nop 7
    s_cbranch_scc1 KF_FBL
    v_rcp_f32 v10, v112
    v_rcp_f32 v11, v116
    s_lshr_b32 s59, s44, 2
    s_lshl_b32 s59, s59, 20
    s_lshl_b32 s60, s41, 15
    s_add_u32 s59, s59, s60
    s_and_b32 s60, s44, 3
    s_lshl_b32 s60, s60, 11
    s_add_u32 s59, s59, s60
    v_mul_f32 v192, v192, v10
    v_mul_f32 v193, v193, v10
    v_mul_f32 v194, v194, v10
    v_mul_f32 v195, v195, v10
    v_mul_f32 v196, v196, v10
    v_mul_f32 v197, v197, v10
    v_mul_f32 v198, v198, v10
    v_mul_f32 v199, v199, v10
    v_cvt_pk_bf16_f32 v192, v192, v193
    v_cvt_pk_bf16_f32 v193, v194, v195
    v_cvt_pk_bf16_f32 v194, v196, v197
    v_cvt_pk_bf16_f32 v195, v198, v199
    buffer_store_dwordx4 v[192:195], v2, s[20:23], s59 offen offset:0 sc1
    v_mul_f32 v224, v224, v11
    v_mul_f32 v225, v225, v11
    v_mul_f32 v226, v226, v11
    v_mul_f32 v227, v227, v11
    v_mul_f32 v228, v228, v11
    v_mul_f32 v229, v229, v11
    v_mul_f32 v230, v230, v11
    v_mul_f32 v231, v231, v11
    v_cvt_pk_bf16_f32 v224, v224, v225
    v_cvt_pk_bf16_f32 v225, v226, v227
    v_cvt_pk_bf16_f32 v226, v228, v229
    v_cvt_pk_bf16_f32 v227, v230, v231
    buffer_store_dwordx4 v[224:227], v2, s[20:23], s59 offen offset:1024 sc1
    s_add_u32 s59, s59, 8192
    v_mul_f32 v200, v200, v10
    v_mul_f32 v201, v201, v10
    v_mul_f32 v202, v202, v10
    v_mul_f32 v203, v203, v10
    v_mul_f32 v204, v204, v10
    v_mul_f32 v205, v205, v10
    v_mul_f32 v206, v206, v10
    v_mul_f32 v207, v207, v10
    v_cvt_pk_bf16_f32 v200, v200, v201
    v_cvt_pk_bf16_f32 v201, v202, v203
    v_cvt_pk_bf16_f32 v202, v204, v205
    v_cvt_pk_bf16_f32 v203, v206, v207
    buffer_store_dwordx4 v[200:203], v2, s[20:23], s59 offen offset:0 sc1
    v_mul_f32 v232, v232, v11
    v_mul_f32 v233, v233, v11
    v_mul_f32 v234, v234, v11
    v_mul_f32 v235, v235, v11
    v_mul_f32 v236, v236, v11
    v_mul_f32 v237, v237, v11
    v_mul_f32 v238, v238, v11
    v_mul_f32 v239, v239, v11
    v_cvt_pk_bf16_f32 v232, v232, v233
    v_cvt_pk_bf16_f32 v233, v234, v235
    v_cvt_pk_bf16_f32 v234, v236, v237
    v_cvt_pk_bf16_f32 v235, v238, v239
    buffer_store_dwordx4 v[232:235], v2, s[20:23], s59 offen offset:1024 sc1
    s_add_u32 s59, s59, 8192
    v_mul_f32 v208, v208, v10
    v_mul_f32 v209, v209, v10
    v_mul_f32 v210, v210, v10
    v_mul_f32 v211, v211, v10
    v_mul_f32 v212, v212, v10
    v_mul_f32 v213, v213, v10
    v_mul_f32 v214, v214, v10
    v_mul_f32 v215, v215, v10
    v_cvt_pk_bf16_f32 v208, v208, v209
    v_cvt_pk_bf16_f32 v209, v210, v211
    v_cvt_pk_bf16_f32 v210, v212, v213
    v_cvt_pk_bf16_f32 v211, v214, v215
    buffer_store_dwordx4 v[208:211], v2, s[20:23], s59 offen offset:0 sc1
    v_mul_f32 v240, v240, v11
    v_mul_f32 v241, v241, v11
    v_mul_f32 v242, v242, v11
    v_mul_f32 v243, v243, v11
    v_mul_f32 v244, v244, v11
    v_mul_f32 v245, v245, v11
    v_mul_f32 v246, v246, v11
    v_mul_f32 v247, v247, v11
    v_cvt_pk_bf16_f32 v240, v240, v241
    v_cvt_pk_bf16_f32 v241, v242, v243
    v_cvt_pk_bf16_f32 v242, v244, v245
    v_cvt_pk_bf16_f32 v243, v246, v247
    buffer_store_dwordx4 v[240:243], v2, s[20:23], s59 offen offset:1024 sc1
    s_add_u32 s59, s59, 8192
    v_mul_f32 v216, v216, v10
    v_mul_f32 v217, v217, v10
    v_mul_f32 v218, v218, v10
    v_mul_f32 v219, v219, v10
    v_mul_f32 v220, v220, v10
    v_mul_f32 v221, v221, v10
    v_mul_f32 v222, v222, v10
    v_mul_f32 v223, v223, v10
    v_cvt_pk_bf16_f32 v216, v216, v217
    v_cvt_pk_bf16_f32 v217, v218, v219
    v_cvt_pk_bf16_f32 v218, v220, v221
    v_cvt_pk_bf16_f32 v219, v222, v223
    buffer_store_dwordx4 v[216:219], v2, s[20:23], s59 offen offset:0 sc1
    v_mul_f32 v248, v248, v11
    v_mul_f32 v249, v249, v11
    v_mul_f32 v250, v250, v11
    v_mul_f32 v251, v251, v11
    v_mul_f32 v252, v252, v11
    v_mul_f32 v253, v253, v11
    v_mul_f32 v254, v254, v11
    v_mul_f32 v255, v255, v11
    v_cvt_pk_bf16_f32 v248, v248, v249
    v_cvt_pk_bf16_f32 v249, v250, v251
    v_cvt_pk_bf16_f32 v250, v252, v253
    v_cvt_pk_bf16_f32 v251, v254, v255
    buffer_store_dwordx4 v[248:251], v2, s[20:23], s59 offen offset:1024 sc1
    s_branch KF_D
KF_D:
    s_load_dwordx2 s[8:9], s[0:1], 40
    s_load_dwordx2 s[4:5], s[0:1], 0
    s_load_dwordx2 s[12:13], s[0:1], 88
    s_load_dwordx2 s[16:17], s[0:1], 104
    s_lshr_b32 s48, s41, 2
    s_and_b32 s49, s41, 3
    s_lshl_b32 s74, s49, 15
    s_lshl_b32 s53, s40, 11
    s_lshl_b32 s59, s48, 17
    s_lshl_b32 s50, s42, 20
    s_add_u32 s50, s50, s59
    s_sub_u32 s60, 15, s42
    s_lshl_b32 s51, s60, 20
    s_add_u32 s51, s51, s59
    s_lshl_b32 s73, s60, 9
    s_lshl_b32 s59, s48, 6
    s_add_u32 s73, s73, s59
    s_add_u32 s73, s73, 2301952
    s_lshl_b32 s52, s48, 19
    s_lshl_b32 s59, s49, 8
    s_add_u32 s52, s52, s59
    s_lshr_b32 s59, s40, 2
    s_lshl_b32 s59, s59, 2
    s_cmp_lt_u32 s48, 4
    s_cselect_b32 s60, s42, s60
    s_lshl_b32 s57, s60, 3
    s_add_u32 s57, s57, s59
    s_and_b32 s60, s48, 3
    s_add_u32 s57, s57, s60
    s_lshl_b32 s56, s42, 2
    s_add_u32 s56, s56, s49
    s_lshl_b32 s55, s56, 19
    s_lshl_b32 s60, s40, 10
    s_add_u32 s55, s55, s60
    s_lshl_b32 s56, s56, 13
    s_lshl_b32 s60, s40, 7
    s_add_u32 s56, s56, s60
    s_add_u32 s56, s56, 4194304
    v_lshrrev_b32 v40, 4, v1
    v_and_b32 v41, 15, v1
    v_lshlrev_b32 v6, 1, v40
    v_xor_b32 v6, v6, v41
    v_lshlrev_b32 v7, 10, v40
    v_lshl_add_u32 v8, v6, 4, v7
    v_xor_b32 v6, 8, v6
    v_lshl_add_u32 v9, v6, 4, v7
    v_add_u32 v9, 3072, v9
    s_add_u32 s60, s59, 0
    s_lshl_b32 s60, s60, 10
    v_add_u32 v28, s60, v2
    v_add_u32 v32, 0x10000, v28
    s_add_u32 s60, s59, 1
    s_lshl_b32 s60, s60, 10
    v_add_u32 v29, s60, v2
    v_add_u32 v33, 0x10000, v29
    s_add_u32 s60, s59, 2
    s_lshl_b32 s60, s60, 10
    v_add_u32 v30, s60, v2
    v_add_u32 v34, 0x10000, v30
    s_add_u32 s60, s59, 3
    s_lshl_b32 s60, s60, 10
    v_add_u32 v31, s60, v2
    v_add_u32 v35, 0x10000, v31
    v_lshrrev_b32 v6, 2, v1
    v_and_b32 v7, 7, v6
    s_lshl_b32 s60, s43, 1
    v_xor_b32 v7, s60, v7
    v_lshlrev_b32 v6, 8, v6
    v_lshl_add_u32 v6, v7, 5, v6
    v_and_b32 v7, 3, v1
    v_lshl_add_u32 v6, v7, 3, v6
    v_add_u32 v36, 16384, v6
    v_xor_b32 v37, 32, v36
    v_add_u32 v38, 0x10000, v36
    v_add_u32 v39, 0x10000, v37
    s_lshl_b32 s61, s49, 3
    s_add_u32 s61, s61, s60
    v_lshlrev_b32 v10, 10, v41
    v_lshl_add_u32 v10, v40, 3, v10
    s_lshl_b32 s60, s61, 5
    v_add_u32 v10, s60, v10
    v_lshrrev_b32 v11, 1, v40
    v_lshlrev_b32 v11, 8, v11
    v_lshl_add_u32 v11, v41, 4, v11
    v_and_b32 v6, 1, v40
    v_lshl_add_u32 v11, v6, 3, v11
    s_lshl_b32 s60, s61, 9
    v_add_u32 v11, s60, v11
    v_lshrrev_b32 v42, 2, v41
    v_lshlrev_b32 v42, 11, v42
    v_and_b32 v6, 3, v41
    v_lshl_add_u32 v42, v6, 6, v42
    v_add_u32 v42, 155648, v42
    v_lshlrev_b32 v43, 2, v41
    s_waitcnt lgkmcnt(0)
    s_add_u32 s16, s16, 67108864
    s_addc_u32 s17, s17, 0
    s_and_b32 s9, s9, 0xffff
    s_mov_b32 s10, 0x400000
    s_mov_b32 s11, 0x00020000
    s_and_b32 s5, s5, 0xffff
    s_mov_b32 s6, 0x200000
    s_mov_b32 s7, 0x00020000
    s_and_b32 s13, s13, 0xffff
    s_mov_b32 s14, 0x200000
    s_mov_b32 s15, 0x00020000
    s_and_b32 s17, s17, 0xffff
    s_mov_b32 s18, 0x1000000
    s_mov_b32 s19, 0x00020000
    s_cmp_eq_u32 s72, 2
    s_cbranch_scc1 KF_DA
    s_cmp_lt_u32 s40, 4
    s_cbranch_scc1 KF_D0
    s_waitcnt vmcnt(0)
    s_lshr_b32 s59, s44, 2
    s_lshl_b32 s59, s59, 9
    s_lshl_b32 s60, s41, 4
    s_add_u32 s59, s59, s60
    s_and_b32 s60, s44, 3
    s_lshl_b32 s60, s60, 2
    s_add_u32 s59, s59, s60
    s_add_u32 s59, s59, 2301952
    v_mov_b32 v4, 0
    v_mov_b32 v5, 1
    s_mov_b64 exec, 1
    buffer_store_dword v5, v4, s[24:27], s59 offen sc1
    s_mov_b64 exec, -1
    s_mov_b32 s72, 2
KF_DA:
    s_lshl_b32 s59, s43, 11
    s_add_u32 s59, s59, 2097152
    buffer_load_dwordx4 v[64:67], v2, s[24:27], s59 offen offset:0 sc1
    buffer_load_dwordx4 v[68:71], v2, s[24:27], s59 offen offset:1024 sc1
    s_lshl_b32 s59, s43, 11
    s_add_u32 s59, s59, 155648
    v_lshlrev_b32 v6, 2, v1
    v_add_u32 v6, s59, v6
    s_lshl_b32 s58, s42, 9
    s_lshl_b32 s59, s48, 6
    s_add_u32 s58, s58, s59
    s_add_u32 s58, s58, 2301952
    buffer_load_dword v7, v43, s[24:27], s58 offen sc1
    s_waitcnt vmcnt(0)
    v_max3_u32 v63, v64, v65, v66
    v_max3_u32 v63, v63, v67, v68
    v_max3_u32 v63, v63, v69, v70
    v_max_u32 v63, v63, v71
    s_nop 1
    v_max_u32_dpp v63, v63, v63 quad_perm:[1,0,3,2] row_mask:0xf bank_mask:0xf
    s_nop 1
    v_max_u32_dpp v63, v63, v63 quad_perm:[2,3,0,1] row_mask:0xf bank_mask:0xf
    s_nop 1
    v_max_u32_dpp v63, v63, v63 row_half_mirror row_mask:0xf bank_mask:0xf
    s_nop 1
    v_max_u32_dpp v63, v63, v63 row_mirror row_mask:0xf bank_mask:0xf
    ds_write_b32 v6, v63
    s_mov_b32 s64, 0
KFD_144:
    ds_read_b32 v18, v17
    s_add_u32 s64, s64, 1
    s_cmp_gt_u32 s64, 200000
    s_waitcnt lgkmcnt(0)
    v_cmp_gt_u32 vcc, s46, v18
    s_cbranch_scc1 KFD_145
    s_cbranch_vccz KFD_145
    s_sleep 2
    s_branch KFD_144
KFD_145:
    s_add_u32 s60, s74, 0
    s_and_b32 s60, s60, 0x1ffff
    s_add_u32 s60, s60, s69
    s_add_u32 m0, s69, 16384
    s_lshl_b32 s59, s60, 2
    s_add_u32 s59, s59, s52
    buffer_load_dwordx4 v8, s[8:11], s59 offen lds
    buffer_load_dwordx4 v9, s[8:11], s59 offen offset:1024 lds
    s_add_u32 m0, s69, 18432
    s_lshl_b32 s59, s60, 2
    s_add_u32 s59, s59, s52
    s_add_u32 s59, s59, 8192
    buffer_load_dwordx4 v8, s[8:11], s59 offen lds
    buffer_load_dwordx4 v9, s[8:11], s59 offen offset:1024 lds
    s_mov_b32 s64, 0
    s_cmp_eq_u32 0, 1
    s_branch KFD_148
KFD_146:
    buffer_load_dword v7, v43, s[24:27], s58 offen sc1
    s_add_u32 s64, s64, 1
    s_cmp_gt_u32 s64, 100000
    s_waitcnt vmcnt(0)
KFD_148:
    v_cmp_eq_u32 vcc, 0, v7
    s_cbranch_scc1 KFD_147
    s_cbranch_vccz KFD_147
    s_sleep 4
    s_branch KFD_146
KFD_147:
    s_add_u32 m0, s69, 0
    s_add_u32 s59, s60, s50
    buffer_load_dwordx4 v2, s[20:23], s59 offen offset:0 sc1 lds
    buffer_load_dwordx4 v2, s[20:23], s59 offen offset:1024 sc1 lds
    buffer_load_dwordx4 v2, s[20:23], s59 offen offset:2048 sc1 lds
    buffer_load_dwordx4 v2, s[20:23], s59 offen offset:3072 sc1 lds
    s_add_u32 s60, s74, 16384
    s_and_b32 s60, s60, 0x1ffff
    s_add_u32 s60, s60, s69
    s_add_u32 m0, s69, 49152
    s_lshl_b32 s59, s60, 2
    s_add_u32 s59, s59, s52
    buffer_load_dwordx4 v8, s[8:11], s59 offen lds
    buffer_load_dwordx4 v9, s[8:11], s59 offen offset:1024 lds
    s_add_u32 m0, s69, 51200
    s_lshl_b32 s59, s60, 2
    s_add_u32 s59, s59, s52
    s_add_u32 s59, s59, 8192
    buffer_load_dwordx4 v8, s[8:11], s59 offen lds
    buffer_load_dwordx4 v9, s[8:11], s59 offen offset:1024 lds
    s_add_u32 m0, s69, 65536
    s_add_u32 s59, s60, s50
    buffer_load_dwordx4 v2, s[20:23], s59 offen offset:0 sc1 lds
    buffer_load_dwordx4 v2, s[20:23], s59 offen offset:1024 sc1 lds
    buffer_load_dwordx4 v2, s[20:23], s59 offen offset:2048 sc1 lds
    buffer_load_dwordx4 v2, s[20:23], s59 offen offset:3072 sc1 lds
    s_add_u32 s60, s74, 32768
    s_and_b32 s60, s60, 0x1ffff
    s_add_u32 s60, s60, s69
    s_add_u32 m0, s69, 81920
    s_lshl_b32 s59, s60, 2
    s_add_u32 s59, s59, s52
    buffer_load_dwordx4 v8, s[8:11], s59 offen lds
    buffer_load_dwordx4 v9, s[8:11], s59 offen offset:1024 lds
    s_add_u32 m0, s69, 83968
    s_lshl_b32 s59, s60, 2
    s_add_u32 s59, s59, s52
    s_add_u32 s59, s59, 8192
    buffer_load_dwordx4 v8, s[8:11], s59 offen lds
    buffer_load_dwordx4 v9, s[8:11], s59 offen offset:1024 lds
    s_add_u32 s60, s74, 49152
    s_and_b32 s60, s60, 0x1ffff
    s_add_u32 s60, s60, s69
    s_add_u32 m0, s69, 114688
    s_lshl_b32 s59, s60, 2
    s_add_u32 s59, s59, s52
    buffer_load_dwordx4 v8, s[8:11], s59 offen lds
    buffer_load_dwordx4 v9, s[8:11], s59 offen offset:1024 lds
    s_add_u32 m0, s69, 116736
    s_lshl_b32 s59, s60, 2
    s_add_u32 s59, s59, s52
    s_add_u32 s59, s59, 8192
    buffer_load_dwordx4 v8, s[8:11], s59 offen lds
    buffer_load_dwordx4 v9, s[8:11], s59 offen offset:1024 lds
    s_waitcnt vmcnt(16)
KF_D0:
    s_setprio 0
    s_barrier
    ds_read_b32 v42, v42
    ds_read_b64_tr_b16 v[128:129], v36 offset:0
    ds_read_b64_tr_b16 v[130:131], v36 offset:4096
    ds_read_b64_tr_b16 v[132:133], v37 offset:0
    ds_read_b64_tr_b16 v[134:135], v37 offset:4096
    ds_read_b128 v[44:47], v28 offset:0
    ds_read_b128 v[48:51], v29 offset:0
    ds_read_b128 v[52:55], v30 offset:0
    ds_read_b128 v[56:59], v31 offset:0
    v_add_u32 v60, 0x20000, v28
    v_add_u32 v61, 0x20000, v29
    v_add_u32 v62, 0x20000, v30
    v_add_u32 v63, 0x20000, v31
    s_add_u32 m0, s53, 32768
    s_add_u32 s59, s74, 32768
    s_and_b32 s59, s59, 0x1ffff
    s_add_u32 s59, s59, s53
    s_add_u32 s59, s59, s50
    buffer_load_dwordx4 v2, s[20:23], s59 offen sc1 lds
    buffer_load_dwordx4 v2, s[20:23], s59 offen offset:1024 sc1 lds
    s_add_u32 m0, s53, 98304
    s_add_u32 s59, s74, 49152
    s_and_b32 s59, s59, 0x1ffff
    s_add_u32 s59, s59, s53
    s_add_u32 s59, s59, s50
    buffer_load_dwordx4 v2, s[20:23], s59 offen sc1 lds
    buffer_load_dwordx4 v2, s[20:23], s59 offen offset:1024 sc1 lds
    s_waitcnt lgkmcnt(0)
    v_mfma_f32_16x16x32_bf16 v[64:67], v[128:131], v[44:47], 0
    ds_read_b64_tr_b16 v[136:137], v36 offset:8192
    ds_read_b64_tr_b16 v[138:139], v36 offset:12288
    v_mfma_f32_16x16x32_bf16 v[68:71], v[132:135], v[44:47], 0
    ds_read_b64_tr_b16 v[140:141], v37 offset:8192
    ds_read_b64_tr_b16 v[142:143], v37 offset:12288
    v_mfma_f32_16x16x32_bf16 v[72:75], v[128:131], v[48:51], 0
    ds_read_b128 v[12:15], v28 offset:8192
    ds_read_b128 v[16:19], v29 offset:8192
    v_mfma_f32_16x16x32_bf16 v[76:79], v[132:135], v[48:51], 0
    ds_read_b128 v[20:23], v30 offset:8192
    ds_read_b128 v[24:27], v31 offset:8192
    v_mfma_f32_16x16x32_bf16 v[80:83], v[128:131], v[52:55], 0
    v_mfma_f32_16x16x32_bf16 v[84:87], v[132:135], v[52:55], 0
    v_mfma_f32_16x16x32_bf16 v[88:91], v[128:131], v[56:59], 0
    v_mfma_f32_16x16x32_bf16 v[92:95], v[132:135], v[56:59], 0
    s_cmp_lt_u32 s40, 4
    s_cbranch_scc1 KFD_149
    s_waitcnt vmcnt(12)
KFD_149:
    s_barrier
    s_waitcnt lgkmcnt(0)
    v_mfma_f32_16x16x32_bf16 v[64:67], v[136:139], v[12:15], v[64:67]
    ds_read_b64_tr_b16 v[144:145], v36 offset:32768
    ds_read_b64_tr_b16 v[146:147], v36 offset:36864
    v_mfma_f32_16x16x32_bf16 v[68:71], v[140:143], v[12:15], v[68:71]
    ds_read_b64_tr_b16 v[148:149], v37 offset:32768
    ds_read_b64_tr_b16 v[150:151], v37 offset:36864
    v_mfma_f32_16x16x32_bf16 v[72:75], v[136:139], v[16:19], v[72:75]
    ds_read_b128 v[44:47], v32 offset:0
    ds_read_b128 v[48:51], v33 offset:0
    v_mfma_f32_16x16x32_bf16 v[76:79], v[140:143], v[16:19], v[76:79]
    ds_read_b128 v[52:55], v34 offset:0
    ds_read_b128 v[56:59], v35 offset:0
    v_mfma_f32_16x16x32_bf16 v[80:83], v[136:139], v[20:23], v[80:83]
    v_mfma_f32_16x16x32_bf16 v[84:87], v[140:143], v[20:23], v[84:87]
    v_mfma_f32_16x16x32_bf16 v[88:91], v[136:139], v[24:27], v[88:91]
    v_mfma_f32_16x16x32_bf16 v[92:95], v[140:143], v[24:27], v[92:95]
    s_waitcnt lgkmcnt(0)
    v_mfma_f32_16x16x32_bf16 v[64:67], v[144:147], v[44:47], v[64:67]
    ds_read_b64_tr_b16 v[152:153], v36 offset:40960
    ds_read_b64_tr_b16 v[154:155], v36 offset:45056
    v_mfma_f32_16x16x32_bf16 v[68:71], v[148:151], v[44:47], v[68:71]
    ds_read_b64_tr_b16 v[156:157], v37 offset:40960
    ds_read_b64_tr_b16 v[158:159], v37 offset:45056
    v_mfma_f32_16x16x32_bf16 v[72:75], v[144:147], v[48:51], v[72:75]
    ds_read_b128 v[12:15], v32 offset:8192
    ds_read_b128 v[16:19], v33 offset:8192
    v_mfma_f32_16x16x32_bf16 v[76:79], v[148:151], v[48:51], v[76:79]
    ds_read_b128 v[20:23], v34 offset:8192
    ds_read_b128 v[24:27], v35 offset:8192
    v_mfma_f32_16x16x32_bf16 v[80:83], v[144:147], v[52:55], v[80:83]
    v_mfma_f32_16x16x32_bf16 v[84:87], v[148:151], v[52:55], v[84:87]
    v_mfma_f32_16x16x32_bf16 v[88:91], v[144:147], v[56:59], v[88:91]
    v_mfma_f32_16x16x32_bf16 v[92:95], v[148:151], v[56:59], v[92:95]
    s_waitcnt vmcnt(2)
    s_cmp_eq_u32 s72, 2
    s_cbranch_scc1 KFD_150
    s_lshr_b32 s59, s44, 2
    s_lshl_b32 s59, s59, 9
    s_lshl_b32 s60, s41, 4
    s_add_u32 s59, s59, s60
    s_and_b32 s60, s44, 3
    s_lshl_b32 s60, s60, 2
    s_add_u32 s59, s59, s60
    s_add_u32 s59, s59, 2301952
    v_mov_b32 v4, 0
    v_mov_b32 v5, 1
    s_mov_b64 exec, 1
    buffer_store_dword v5, v4, s[24:27], s59 offen sc1
    s_mov_b64 exec, -1
KFD_150:
    s_barrier
    s_waitcnt lgkmcnt(0)
    v_mfma_f32_16x16x32_bf16 v[64:67], v[152:155], v[12:15], v[64:67]
    ds_read_b64_tr_b16 v[160:161], v38 offset:0
    ds_read_b64_tr_b16 v[162:163], v38 offset:4096
    v_mfma_f32_16x16x32_bf16 v[68:71], v[156:159], v[12:15], v[68:71]
    ds_read_b64_tr_b16 v[164:165], v39 offset:0
    ds_read_b64_tr_b16 v[166:167], v39 offset:4096
    v_mfma_f32_16x16x32_bf16 v[72:75], v[152:155], v[16:19], v[72:75]
    ds_read_b128 v[44:47], v28 offset:32768
    ds_read_b128 v[48:51], v29 offset:32768
    v_mfma_f32_16x16x32_bf16 v[76:79], v[156:159], v[16:19], v[76:79]
    ds_read_b128 v[52:55], v30 offset:32768
    ds_read_b128 v[56:59], v31 offset:32768
    v_mfma_f32_16x16x32_bf16 v[80:83], v[152:155], v[20:23], v[80:83]
    s_add_u32 m0, s53, 16384
    s_add_u32 s59, s74, 65536
    s_and_b32 s59, s59, 0x1ffff
    s_add_u32 s59, s59, s53
    s_lshl_b32 s59, s59, 2
    s_add_u32 s59, s59, s52
    buffer_load_dwordx4 v8, s[8:11], s59 offen lds
    buffer_load_dwordx4 v9, s[8:11], s59 offen offset:1024 lds
    v_mfma_f32_16x16x32_bf16 v[84:87], v[156:159], v[20:23], v[84:87]
    s_add_u32 m0, s53, 0
    s_add_u32 s59, s74, 65536
    s_and_b32 s59, s59, 0x1ffff
    s_add_u32 s59, s59, s53
    s_add_u32 s59, s59, s50
    buffer_load_dwordx4 v2, s[20:23], s59 offen sc1 lds
    buffer_load_dwordx4 v2, s[20:23], s59 offen offset:1024 sc1 lds
    v_mfma_f32_16x16x32_bf16 v[88:91], v[152:155], v[24:27], v[88:91]
    v_mfma_f32_16x16x32_bf16 v[92:95], v[156:159], v[24:27], v[92:95]
    v_max_u32_dpp v42, v42, v42 quad_perm:[1,0,3,2] row_mask:0xf bank_mask:0xf
    s_nop 1
    v_max_u32_dpp v42, v42, v42 quad_perm:[2,3,0,1] row_mask:0xf bank_mask:0xf
    s_nop 1
    v_max_u32_dpp v42, v42, v42 row_half_mirror row_mask:0xf bank_mask:0xf
    s_nop 1
    v_max_u32_dpp v42, v42, v42 row_mirror row_mask:0xf bank_mask:0xf
    s_nop 1
    v_readfirstlane_b32 s59, v42
    s_nop 0
    s_and_b32 s54, s59, 0x7ff
    s_sub_u32 s54, 2047, s54
    s_and_b32 s59, s59, 0xffff0000
    s_ashr_i32 s60, s59, 31
    s_not_b32 s60, s60
    s_or_b32 s60, s60, 0x80000000
    s_xor_b32 s59, s59, s60
    s_and_b32 s59, s59, 0xffff0000
    v_mov_b32 v40, s59
    v_mul_f32 v40, 0xbfb8aa3b, v40
    v_exp_f32 v40, v40
    s_nop 0
    v_add_f32 v40, 1.0, v40
    v_rcp_f32 v40, v40
    s_nop 0
    v_cvt_pk_bf16_f32 v40, v40, v40
    v_lshlrev_b32 v40, 16, v40
    s_lshr_b32 s59, s54, 4
    s_cmp_eq_u32 s59, s57
    s_cselect_b32 s75, 1, 0
    s_waitcnt lgkmcnt(0)
    v_mfma_f32_16x16x32_bf16 v[64:67], v[160:163], v[44:47], v[64:67]
    ds_read_b64_tr_b16 v[168:169], v38 offset:8192
    ds_read_b64_tr_b16 v[170:171], v38 offset:12288
    v_mfma_f32_16x16x32_bf16 v[68:71], v[164:167], v[44:47], v[68:71]
    ds_read_b64_tr_b16 v[172:173], v39 offset:8192
    ds_read_b64_tr_b16 v[174:175], v39 offset:12288
    v_mfma_f32_16x16x32_bf16 v[72:75], v[160:163], v[48:51], v[72:75]
    ds_read_b128 v[12:15], v28 offset:40960
    ds_read_b128 v[16:19], v29 offset:40960
    v_mfma_f32_16x16x32_bf16 v[76:79], v[164:167], v[48:51], v[76:79]
    ds_read_b128 v[20:23], v30 offset:40960
    ds_read_b128 v[24:27], v31 offset:40960
    v_mfma_f32_16x16x32_bf16 v[80:83], v[160:163], v[52:55], v[80:83]
    v_mfma_f32_16x16x32_bf16 v[84:87], v[164:167], v[52:55], v[84:87]
    v_mfma_f32_16x16x32_bf16 v[88:91], v[160:163], v[56:59], v[88:91]
    v_mfma_f32_16x16x32_bf16 v[92:95], v[164:167], v[56:59], v[92:95]
    s_waitcnt vmcnt(4)
    s_barrier
    s_waitcnt lgkmcnt(0)
    v_mfma_f32_16x16x32_bf16 v[64:67], v[168:171], v[12:15], v[64:67]
    ds_read_b64_tr_b16 v[176:177], v38 offset:32768
    ds_read_b64_tr_b16 v[178:179], v38 offset:36864
    v_mfma_f32_16x16x32_bf16 v[68:71], v[172:175], v[12:15], v[68:71]
    ds_read_b64_tr_b16 v[180:181], v39 offset:32768
    ds_read_b64_tr_b16 v[182:183], v39 offset:36864
    v_mfma_f32_16x16x32_bf16 v[72:75], v[168:171], v[16:19], v[72:75]
    ds_read_b128 v[44:47], v32 offset:32768
    ds_read_b128 v[48:51], v33 offset:32768
    v_mfma_f32_16x16x32_bf16 v[76:79], v[172:175], v[16:19], v[76:79]
    ds_read_b128 v[52:55], v34 offset:32768
    ds_read_b128 v[56:59], v35 offset:32768
    v_mfma_f32_16x16x32_bf16 v[80:83], v[168:171], v[20:23], v[80:83]
    s_add_u32 m0, s53, 49152
    s_add_u32 s59, s74, 81920
    s_and_b32 s59, s59, 0x1ffff
    s_add_u32 s59, s59, s53
    s_lshl_b32 s59, s59, 2
    s_add_u32 s59, s59, s52
    buffer_load_dwordx4 v8, s[8:11], s59 offen lds
    buffer_load_dwordx4 v9, s[8:11], s59 offen offset:1024 lds
    v_mfma_f32_16x16x32_bf16 v[84:87], v[172:175], v[20:23], v[84:87]
    s_add_u32 m0, s53, 65536
    s_add_u32 s59, s74, 81920
    s_and_b32 s59, s59, 0x1ffff
    s_add_u32 s59, s59, s53
    s_add_u32 s59, s59, s50
    buffer_load_dwordx4 v2, s[20:23], s59 offen sc1 lds
    buffer_load_dwordx4 v2, s[20:23], s59 offen offset:1024 sc1 lds
    v_mfma_f32_16x16x32_bf16 v[88:91], v[168:171], v[24:27], v[88:91]
    v_mfma_f32_16x16x32_bf16 v[92:95], v[172:175], v[24:27], v[92:95]
    s_waitcnt lgkmcnt(0)
    v_mfma_f32_16x16x32_bf16 v[64:67], v[176:179], v[44:47], v[64:67]
    ds_read_b64_tr_b16 v[184:185], v38 offset:40960
    ds_read_b64_tr_b16 v[186:187], v38 offset:45056
    v_mfma_f32_16x16x32_bf16 v[68:71], v[180:183], v[44:47], v[68:71]
    ds_read_b64_tr_b16 v[188:189], v39 offset:40960
    ds_read_b64_tr_b16 v[190:191], v39 offset:45056
    v_mfma_f32_16x16x32_bf16 v[72:75], v[176:179], v[48:51], v[72:75]
    ds_read_b128 v[12:15], v32 offset:40960
    ds_read_b128 v[16:19], v33 offset:40960
    v_mfma_f32_16x16x32_bf16 v[76:79], v[180:183], v[48:51], v[76:79]
    ds_read_b128 v[20:23], v34 offset:40960
    ds_read_b128 v[24:27], v35 offset:40960
    v_mfma_f32_16x16x32_bf16 v[80:83], v[176:179], v[52:55], v[80:83]
    v_mfma_f32_16x16x32_bf16 v[84:87], v[180:183], v[52:55], v[84:87]
    v_mfma_f32_16x16x32_bf16 v[88:91], v[176:179], v[56:59], v[88:91]
    v_mfma_f32_16x16x32_bf16 v[92:95], v[180:183], v[56:59], v[92:95]
    s_waitcnt vmcnt(4)
    s_barrier
    s_waitcnt lgkmcnt(0)
    v_mfma_f32_16x16x32_bf16 v[64:67], v[184:187], v[12:15], v[64:67]
    ds_read_b64_tr_b16 v[192:193], v36 offset:0
    ds_read_b64_tr_b16 v[194:195], v36 offset:4096
    v_mfma_f32_16x16x32_bf16 v[68:71], v[188:191], v[12:15], v[68:71]
    ds_read_b64_tr_b16 v[196:197], v37 offset:0
    ds_read_b64_tr_b16 v[198:199], v37 offset:4096
    v_mfma_f32_16x16x32_bf16 v[72:75], v[184:187], v[16:19], v[72:75]
    ds_read_b128 v[44:47], v28 offset:0
    ds_read_b128 v[48:51], v29 offset:0
    v_mfma_f32_16x16x32_bf16 v[76:79], v[188:191], v[16:19], v[76:79]
    ds_read_b128 v[52:55], v30 offset:0
    ds_read_b128 v[56:59], v31 offset:0
    v_mfma_f32_16x16x32_bf16 v[80:83], v[184:187], v[20:23], v[80:83]
    s_cmp_lg_u32 s40, 4
    s_cbranch_scc1 KFD_151
    buffer_load_dword v7, v43, s[24:27], s73 offen sc1
KFD_151:
    v_mfma_f32_16x16x32_bf16 v[84:87], v[188:191], v[20:23], v[84:87]
    s_add_u32 m0, s53, 81920
    s_add_u32 s59, s74, 98304
    s_and_b32 s59, s59, 0x1ffff
    s_add_u32 s59, s59, s53
    s_lshl_b32 s59, s59, 2
    s_add_u32 s59, s59, s52
    buffer_load_dwordx4 v8, s[8:11], s59 offen lds
    buffer_load_dwordx4 v9, s[8:11], s59 offen offset:1024 lds
    v_mfma_f32_16x16x32_bf16 v[88:91], v[184:187], v[24:27], v[88:91]
    s_add_u32 m0, s53, 32768
    s_add_u32 s59, s74, 98304
    s_and_b32 s59, s59, 0x1ffff
    s_add_u32 s59, s59, s53
    s_add_u32 s59, s59, s50
    buffer_load_dwordx4 v2, s[20:23], s59 offen sc1 lds
    buffer_load_dwordx4 v2, s[20:23], s59 offen offset:1024 sc1 lds
    v_mfma_f32_16x16x32_bf16 v[92:95], v[188:191], v[24:27], v[92:95]
    s_waitcnt lgkmcnt(0)
    v_mfma_f32_16x16x32_bf16 v[64:67], v[192:195], v[44:47], v[64:67]
    ds_read_b64_tr_b16 v[200:201], v36 offset:8192
    ds_read_b64_tr_b16 v[202:203], v36 offset:12288
    v_mfma_f32_16x16x32_bf16 v[68:71], v[196:199], v[44:47], v[68:71]
    ds_read_b64_tr_b16 v[204:205], v37 offset:8192
    ds_read_b64_tr_b16 v[206:207], v37 offset:12288
    v_mfma_f32_16x16x32_bf16 v[72:75], v[192:195], v[48:51], v[72:75]
    ds_read_b128 v[12:15], v28 offset:8192
    ds_read_b128 v[16:19], v29 offset:8192
    v_mfma_f32_16x16x32_bf16 v[76:79], v[196:199], v[48:51], v[76:79]
    ds_read_b128 v[20:23], v30 offset:8192
    ds_read_b128 v[24:27], v31 offset:8192
    v_mfma_f32_16x16x32_bf16 v[80:83], v[192:195], v[52:55], v[80:83]
    s_add_u32 m0, s53, 131072
    s_add_u32 s59, s74, 0
    s_and_b32 s59, s59, 0x1ffff
    s_add_u32 s59, s59, s53
    s_add_u32 s59, s59, s51
    buffer_load_dwordx4 v2, s[20:23], s59 offen offset:0 sc1 lds
    buffer_load_dwordx4 v2, s[20:23], s59 offen offset:1024 sc1 lds
    v_mfma_f32_16x16x32_bf16 v[84:87], v[196:199], v[52:55], v[84:87]
    v_mfma_f32_16x16x32_bf16 v[88:91], v[192:195], v[56:59], v[88:91]
    v_mfma_f32_16x16x32_bf16 v[92:95], v[196:199], v[56:59], v[92:95]
    s_waitcnt vmcnt(6)
    s_barrier
    s_waitcnt lgkmcnt(0)
    v_mfma_f32_16x16x32_bf16 v[64:67], v[200:203], v[12:15], v[64:67]
    ds_read_b64_tr_b16 v[208:209], v36 offset:32768
    ds_read_b64_tr_b16 v[210:211], v36 offset:36864
    v_mfma_f32_16x16x32_bf16 v[68:71], v[204:207], v[12:15], v[68:71]
    ds_read_b64_tr_b16 v[212:213], v37 offset:32768
    ds_read_b64_tr_b16 v[214:215], v37 offset:36864
    v_mfma_f32_16x16x32_bf16 v[72:75], v[200:203], v[16:19], v[72:75]
    ds_read_b128 v[44:47], v32 offset:0
    ds_read_b128 v[48:51], v33 offset:0
    v_mfma_f32_16x16x32_bf16 v[76:79], v[204:207], v[16:19], v[76:79]
    ds_read_b128 v[52:55], v34 offset:0
    ds_read_b128 v[56:59], v35 offset:0
    v_mfma_f32_16x16x32_bf16 v[80:83], v[200:203], v[20:23], v[80:83]
    s_cmp_lg_u32 s40, 4
    s_cbranch_scc1 KFD_152
    buffer_load_dword v6, v43, s[24:27], s73 offen sc1
KFD_152:
    v_mfma_f32_16x16x32_bf16 v[84:87], v[204:207], v[20:23], v[84:87]
    s_add_u32 m0, s53, 114688
    s_add_u32 s59, s74, 114688
    s_and_b32 s59, s59, 0x1ffff
    s_add_u32 s59, s59, s53
    s_lshl_b32 s59, s59, 2
    s_add_u32 s59, s59, s52
    buffer_load_dwordx4 v8, s[8:11], s59 offen lds
    buffer_load_dwordx4 v9, s[8:11], s59 offen offset:1024 lds
    v_mfma_f32_16x16x32_bf16 v[88:91], v[200:203], v[24:27], v[88:91]
    s_add_u32 m0, s53, 98304
    s_add_u32 s59, s74, 114688
    s_and_b32 s59, s59, 0x1ffff
    s_add_u32 s59, s59, s53
    s_add_u32 s59, s59, s50
    buffer_load_dwordx4 v2, s[20:23], s59 offen sc1 lds
    buffer_load_dwordx4 v2, s[20:23], s59 offen offset:1024 sc1 lds
    v_mfma_f32_16x16x32_bf16 v[92:95], v[204:207], v[24:27], v[92:95]
    s_waitcnt lgkmcnt(0)
    v_mfma_f32_16x16x32_bf16 v[64:67], v[208:211], v[44:47], v[64:67]
    ds_read_b64_tr_b16 v[216:217], v36 offset:40960
    ds_read_b64_tr_b16 v[218:219], v36 offset:45056
    v_mfma_f32_16x16x32_bf16 v[68:71], v[212:215], v[44:47], v[68:71]
    ds_read_b64_tr_b16 v[220:221], v37 offset:40960
    ds_read_b64_tr_b16 v[222:223], v37 offset:45056
    v_mfma_f32_16x16x32_bf16 v[72:75], v[208:211], v[48:51], v[72:75]
    ds_read_b128 v[12:15], v32 offset:8192
    ds_read_b128 v[16:19], v33 offset:8192
    v_mfma_f32_16x16x32_bf16 v[76:79], v[212:215], v[48:51], v[76:79]
    ds_read_b128 v[20:23], v34 offset:8192
    ds_read_b128 v[24:27], v35 offset:8192
    v_mfma_f32_16x16x32_bf16 v[80:83], v[208:211], v[52:55], v[80:83]
    s_add_u32 m0, s53, 147456
    s_add_u32 s59, s74, 16384
    s_and_b32 s59, s59, 0x1ffff
    s_add_u32 s59, s59, s53
    s_add_u32 s59, s59, s51
    buffer_load_dwordx4 v2, s[20:23], s59 offen offset:0 sc1 lds
    buffer_load_dwordx4 v2, s[20:23], s59 offen offset:1024 sc1 lds
    v_mfma_f32_16x16x32_bf16 v[84:87], v[212:215], v[52:55], v[84:87]
    v_mfma_f32_16x16x32_bf16 v[88:91], v[208:211], v[56:59], v[88:91]
    v_mfma_f32_16x16x32_bf16 v[92:95], v[212:215], v[56:59], v[92:95]
    s_cmp_lg_u32 s40, 4
    s_cbranch_scc1 KFD_153
    s_waitcnt vmcnt(12)
    s_add_u32 s60, s49, 1
    s_and_b32 s60, s60, 3
    s_lshl_b32 s60, s60, 2
    s_lshl_b32 s60, 15, s60
    s_mov_b32 s64, 0
    s_cmp_eq_u32 0, 1
    s_branch KFD_156
KFD_154:
    buffer_load_dword v7, v43, s[24:27], s73 offen sc1
    s_add_u32 s64, s64, 1
    s_cmp_gt_u32 s64, 100000
    s_waitcnt vmcnt(0)
KFD_156:
    s_mov_b32 exec_lo, s60
    s_mov_b32 exec_hi, 0
    v_cmp_eq_u32 vcc, 0, v7
    s_mov_b64 exec, -1
    s_cbranch_scc1 KFD_155
    s_cbranch_vccz KFD_155
    s_sleep 2
    s_branch KFD_154
KFD_155:
KFD_153:
    s_waitcnt vmcnt(8)
    s_barrier
    s_waitcnt lgkmcnt(0)
    v_mfma_f32_16x16x32_bf16 v[64:67], v[216:219], v[12:15], v[64:67]
    ds_read_b64_tr_b16 v[224:225], v38 offset:0
    ds_read_b64_tr_b16 v[226:227], v38 offset:4096
    v_mfma_f32_16x16x32_bf16 v[68:71], v[220:223], v[12:15], v[68:71]
    ds_read_b64_tr_b16 v[228:229], v39 offset:0
    ds_read_b64_tr_b16 v[230:231], v39 offset:4096
    v_mfma_f32_16x16x32_bf16 v[72:75], v[216:219], v[16:19], v[72:75]
    ds_read_b128 v[44:47], v28 offset:32768
    ds_read_b128 v[48:51], v29 offset:32768
    v_mfma_f32_16x16x32_bf16 v[76:79], v[220:223], v[16:19], v[76:79]
    ds_read_b128 v[52:55], v30 offset:32768
    ds_read_b128 v[56:59], v31 offset:32768
    v_mfma_f32_16x16x32_bf16 v[80:83], v[216:219], v[20:23], v[80:83]
    s_cmp_lg_u32 s40, 4
    s_cbranch_scc1 KFD_157
    buffer_load_dword v7, v43, s[24:27], s73 offen sc1
KFD_157:
    v_mfma_f32_16x16x32_bf16 v[84:87], v[220:223], v[20:23], v[84:87]
    s_add_u32 m0, s53, 0
    s_add_u32 s59, s74, 32768
    s_and_b32 s59, s59, 0x1ffff
    s_add_u32 s59, s59, s53
    s_add_u32 s59, s59, s51
    buffer_load_dwordx4 v2, s[20:23], s59 offen offset:0 sc1 lds
    buffer_load_dwordx4 v2, s[20:23], s59 offen offset:1024 sc1 lds
    v_mfma_f32_16x16x32_bf16 v[88:91], v[216:219], v[24:27], v[88:91]
    s_add_u32 m0, s53, 16384
    s_add_u32 s59, s74, 49152
    s_and_b32 s59, s59, 0x1ffff
    s_add_u32 s59, s59, s53
    s_add_u32 s59, s59, s51
    buffer_load_dwordx4 v2, s[20:23], s59 offen offset:0 sc1 lds
    buffer_load_dwordx4 v2, s[20:23], s59 offen offset:1024 sc1 lds
    v_mfma_f32_16x16x32_bf16 v[92:95], v[220:223], v[24:27], v[92:95]
    s_waitcnt lgkmcnt(0)
    v_mfma_f32_16x16x32_bf16 v[64:67], v[224:227], v[44:47], v[64:67]
    ds_read_b64_tr_b16 v[232:233], v38 offset:8192
    ds_read_b64_tr_b16 v[234:235], v38 offset:12288
    v_mfma_f32_16x16x32_bf16 v[68:71], v[228:231], v[44:47], v[68:71]
    ds_read_b64_tr_b16 v[236:237], v39 offset:8192
    ds_read_b64_tr_b16 v[238:239], v39 offset:12288
    v_mfma_f32_16x16x32_bf16 v[72:75], v[224:227], v[48:51], v[72:75]
    ds_read_b128 v[12:15], v28 offset:40960
    ds_read_b128 v[16:19], v29 offset:40960
    v_mfma_f32_16x16x32_bf16 v[76:79], v[228:231], v[48:51], v[76:79]
    ds_read_b128 v[20:23], v30 offset:40960
    ds_read_b128 v[24:27], v31 offset:40960
    v_mfma_f32_16x16x32_bf16 v[80:83], v[224:227], v[52:55], v[80:83]
    v_mfma_f32_16x16x32_bf16 v[84:87], v[228:231], v[52:55], v[84:87]
    v_mfma_f32_16x16x32_bf16 v[88:91], v[224:227], v[56:59], v[88:91]
    v_mfma_f32_16x16x32_bf16 v[92:95], v[228:231], v[56:59], v[92:95]
    s_cmp_lg_u32 s40, 4
    s_cbranch_scc1 KFD_158
    s_waitcnt vmcnt(10)
    s_add_u32 s60, s49, 2
    s_and_b32 s60, s60, 3
    s_lshl_b32 s60, s60, 2
    s_lshl_b32 s60, 15, s60
    s_mov_b32 s64, 0
    s_cmp_eq_u32 0, 1
    s_branch KFD_161
KFD_159:
    buffer_load_dword v6, v43, s[24:27], s73 offen sc1
    s_add_u32 s64, s64, 1
    s_cmp_gt_u32 s64, 100000
    s_waitcnt vmcnt(0)
KFD_161:
    s_mov_b32 exec_lo, s60
    s_mov_b32 exec_hi, 0
    v_cmp_eq_u32 vcc, 0, v6
    s_mov_b64 exec, -1
    s_cbranch_scc1 KFD_160
    s_cbranch_vccz KFD_160
    s_sleep 2
    s_branch KFD_159
KFD_160:
KFD_158:
    s_waitcnt vmcnt(6)
    s_barrier
    s_waitcnt lgkmcnt(0)
    v_mfma_f32_16x16x32_bf16 v[64:67], v[232:235], v[12:15], v[64:67]
    ds_read_b64_tr_b16 v[240:241], v38 offset:32768
    ds_read_b64_tr_b16 v[242:243], v38 offset:36864
    v_mfma_f32_16x16x32_bf16 v[68:71], v[236:239], v[12:15], v[68:71]
    ds_read_b64_tr_b16 v[244:245], v39 offset:32768
    ds_read_b64_tr_b16 v[246:247], v39 offset:36864
    v_mfma_f32_16x16x32_bf16 v[72:75], v[232:235], v[16:19], v[72:75]
    ds_read_b128 v[44:47], v32 offset:32768
    ds_read_b128 v[48:51], v33 offset:32768
    v_mfma_f32_16x16x32_bf16 v[76:79], v[236:239], v[16:19], v[76:79]
    ds_read_b128 v[52:55], v34 offset:32768
    ds_read_b128 v[56:59], v35 offset:32768
    v_mfma_f32_16x16x32_bf16 v[80:83], v[232:235], v[20:23], v[80:83]
    s_add_u32 m0, s53, 65536
    s_add_u32 s59, s74, 65536
    s_and_b32 s59, s59, 0x1ffff
    s_add_u32 s59, s59, s53
    s_add_u32 s59, s59, s51
    buffer_load_dwordx4 v2, s[20:23], s59 offen offset:0 sc1 lds
    buffer_load_dwordx4 v2, s[20:23], s59 offen offset:1024 sc1 lds
    v_mfma_f32_16x16x32_bf16 v[84:87], v[236:239], v[20:23], v[84:87]
    s_add_u32 m0, s53, 49152
    s_add_u32 s59, s74, 81920
    s_and_b32 s59, s59, 0x1ffff
    s_add_u32 s59, s59, s53
    s_add_u32 s59, s59, s51
    buffer_load_dwordx4 v2, s[20:23], s59 offen offset:0 sc1 lds
    buffer_load_dwordx4 v2, s[20:23], s59 offen offset:1024 sc1 lds
    v_mfma_f32_16x16x32_bf16 v[88:91], v[232:235], v[24:27], v[88:91]
    v_mfma_f32_16x16x32_bf16 v[92:95], v[236:239], v[24:27], v[92:95]
    s_waitcnt lgkmcnt(0)
    v_mfma_f32_16x16x32_bf16 v[64:67], v[240:243], v[44:47], v[64:67]
    ds_read_b64_tr_b16 v[248:249], v38 offset:40960
    ds_read_b64_tr_b16 v[250:251], v38 offset:45056
    v_mfma_f32_16x16x32_bf16 v[68:71], v[244:247], v[44:47], v[68:71]
    ds_read_b64_tr_b16 v[252:253], v39 offset:40960
    ds_read_b64_tr_b16 v[254:255], v39 offset:45056
    v_mfma_f32_16x16x32_bf16 v[72:75], v[240:243], v[48:51], v[72:75]
    ds_read_b128 v[12:15], v32 offset:40960
    ds_read_b128 v[16:19], v33 offset:40960
    v_mfma_f32_16x16x32_bf16 v[76:79], v[244:247], v[48:51], v[76:79]
    ds_read_b128 v[20:23], v34 offset:40960
    ds_read_b128 v[24:27], v35 offset:40960
    v_mfma_f32_16x16x32_bf16 v[80:83], v[240:243], v[52:55], v[80:83]
    v_mfma_f32_16x16x32_bf16 v[84:87], v[244:247], v[52:55], v[84:87]
    v_mfma_f32_16x16x32_bf16 v[88:91], v[240:243], v[56:59], v[88:91]
    v_mfma_f32_16x16x32_bf16 v[92:95], v[244:247], v[56:59], v[92:95]
    s_cmp_lg_u32 s40, 4
    s_cbranch_scc1 KFD_162
    s_waitcnt vmcnt(8)
    s_add_u32 s60, s49, 3
    s_and_b32 s60, s60, 3
    s_lshl_b32 s60, s60, 2
    s_lshl_b32 s60, 15, s60
    s_mov_b32 s64, 0
    s_cmp_eq_u32 0, 1
    s_branch KFD_165
KFD_163:
    buffer_load_dword v7, v43, s[24:27], s73 offen sc1
    s_add_u32 s64, s64, 1
    s_cmp_gt_u32 s64, 100000
    s_waitcnt vmcnt(0)
KFD_165:
    s_mov_b32 exec_lo, s60
    s_mov_b32 exec_hi, 0
    v_cmp_eq_u32 vcc, 0, v7
    s_mov_b64 exec, -1
    s_cbranch_scc1 KFD_164
    s_cbranch_vccz KFD_164
    s_sleep 2
    s_branch KFD_163
KFD_164:
KFD_162:
    s_waitcnt vmcnt(8)
    s_barrier
    s_waitcnt lgkmcnt(0)
    v_mfma_f32_16x16x32_bf16 v[64:67], v[248:251], v[12:15], v[64:67]
    v_mfma_f32_16x16x32_bf16 v[68:71], v[252:255], v[12:15], v[68:71]
    v_mfma_f32_16x16x32_bf16 v[72:75], v[248:251], v[16:19], v[72:75]
    ds_read_b128 v[44:47], v60 offset:0
    ds_read_b128 v[48:51], v61 offset:0
    v_mfma_f32_16x16x32_bf16 v[76:79], v[252:255], v[16:19], v[76:79]
    ds_read_b128 v[52:55], v62 offset:0
    ds_read_b128 v[56:59], v63 offset:0
    v_mfma_f32_16x16x32_bf16 v[80:83], v[248:251], v[20:23], v[80:83]
    s_add_u32 m0, s53, 32768
    s_add_u32 s59, s74, 98304
    s_and_b32 s59, s59, 0x1ffff
    s_add_u32 s59, s59, s53
    s_add_u32 s59, s59, s51
    buffer_load_dwordx4 v2, s[20:23], s59 offen offset:0 sc1 lds
    buffer_load_dwordx4 v2, s[20:23], s59 offen offset:1024 sc1 lds
    v_mfma_f32_16x16x32_bf16 v[84:87], v[252:255], v[20:23], v[84:87]
    s_add_u32 m0, s53, 81920
    s_add_u32 s59, s74, 114688
    s_and_b32 s59, s59, 0x1ffff
    s_add_u32 s59, s59, s53
    s_add_u32 s59, s59, s51
    buffer_load_dwordx4 v2, s[20:23], s59 offen offset:0 sc1 lds
    buffer_load_dwordx4 v2, s[20:23], s59 offen offset:1024 sc1 lds
    v_mfma_f32_16x16x32_bf16 v[88:91], v[248:251], v[24:27], v[88:91]
    v_mfma_f32_16x16x32_bf16 v[92:95], v[252:255], v[24:27], v[92:95]
    s_cmp_eq_u32 s75, 0
    s_cbranch_scc1 KFD_166
    v_mov_b32 v42, 4
    buffer_load_dword v42, v42, s[36:39], 0 offen sc1
KFD_166:
    s_waitcnt lgkmcnt(0)
    v_mfma_f32_16x16x32_bf16 v[96:99], v[128:131], v[44:47], 0
    v_mfma_f32_16x16x32_bf16 v[100:103], v[132:135], v[44:47], 0
    v_mfma_f32_16x16x32_bf16 v[104:107], v[128:131], v[48:51], 0
    ds_read_b128 v[12:15], v60 offset:8192
    ds_read_b128 v[16:19], v61 offset:8192
    v_mfma_f32_16x16x32_bf16 v[108:111], v[132:135], v[48:51], 0
    ds_read_b128 v[20:23], v62 offset:8192
    ds_read_b128 v[24:27], v63 offset:8192
    v_mfma_f32_16x16x32_bf16 v[112:115], v[128:131], v[52:55], 0
    v_mfma_f32_16x16x32_bf16 v[116:119], v[132:135], v[52:55], 0
    v_mfma_f32_16x16x32_bf16 v[120:123], v[128:131], v[56:59], 0
    v_mfma_f32_16x16x32_bf16 v[124:127], v[132:135], v[56:59], 0
    s_waitcnt lgkmcnt(0)
    v_mfma_f32_16x16x32_bf16 v[96:99], v[136:139], v[12:15], v[96:99]
    v_mfma_f32_16x16x32_bf16 v[100:103], v[140:143], v[12:15], v[100:103]
    v_mfma_f32_16x16x32_bf16 v[104:107], v[136:139], v[16:19], v[104:107]
    ds_read_b128 v[44:47], v60 offset:16384
    ds_read_b128 v[48:51], v61 offset:16384
    v_mfma_f32_16x16x32_bf16 v[108:111], v[140:143], v[16:19], v[108:111]
    ds_read_b128 v[52:55], v62 offset:16384
    ds_read_b128 v[56:59], v63 offset:16384
    v_mfma_f32_16x16x32_bf16 v[112:115], v[136:139], v[20:23], v[112:115]
    v_mfma_f32_16x16x32_bf16 v[116:119], v[140:143], v[20:23], v[116:119]
    v_mfma_f32_16x16x32_bf16 v[120:123], v[136:139], v[24:27], v[120:123]
    v_mfma_f32_16x16x32_bf16 v[124:127], v[140:143], v[24:27], v[124:127]
    s_waitcnt lgkmcnt(0)
    v_mfma_f32_16x16x32_bf16 v[96:99], v[144:147], v[44:47], v[96:99]
    v_mfma_f32_16x16x32_bf16 v[100:103], v[148:151], v[44:47], v[100:103]
    v_mfma_f32_16x16x32_bf16 v[104:107], v[144:147], v[48:51], v[104:107]
    ds_read_b128 v[12:15], v60 offset:24576
    ds_read_b128 v[16:19], v61 offset:24576
    v_mfma_f32_16x16x32_bf16 v[108:111], v[148:151], v[48:51], v[108:111]
    ds_read_b128 v[20:23], v62 offset:24576
    ds_read_b128 v[24:27], v63 offset:24576
    v_mfma_f32_16x16x32_bf16 v[112:115], v[144:147], v[52:55], v[112:115]
    v_cvt_pk_bf16_f32 v64, v64, v65
    v_cvt_pk_bf16_f32 v65, v66, v67
    v_cvt_pk_bf16_f32 v66, v68, v69
    v_cvt_pk_bf16_f32 v67, v70, v71
    s_lshl_b32 s59, s48, 13
    s_add_u32 s59, s59, s55
    s_add_u32 s59, s59, 0
    buffer_store_dwordx4 v[64:67], v2, s[16:19], s59 offen sc1
    v_mfma_f32_16x16x32_bf16 v[116:119], v[148:151], v[52:55], v[116:119]
    v_cvt_pk_bf16_f32 v72, v72, v73
    v_cvt_pk_bf16_f32 v73, v74, v75
    v_cvt_pk_bf16_f32 v74, v76, v77
    v_cvt_pk_bf16_f32 v75, v78, v79
    s_lshl_b32 s59, s48, 13
    s_add_u32 s59, s59, s55
    s_add_u32 s59, s59, 65536
    buffer_store_dwordx4 v[72:75], v2, s[16:19], s59 offen sc1
    v_mfma_f32_16x16x32_bf16 v[120:123], v[144:147], v[56:59], v[120:123]
    v_cvt_pk_bf16_f32 v80, v80, v81
    v_cvt_pk_bf16_f32 v81, v82, v83
    v_cvt_pk_bf16_f32 v82, v84, v85
    v_cvt_pk_bf16_f32 v83, v86, v87
    s_lshl_b32 s59, s48, 13
    s_add_u32 s59, s59, s55
    s_add_u32 s59, s59, 131072
    buffer_store_dwordx4 v[80:83], v2, s[16:19], s59 offen sc1
    v_mfma_f32_16x16x32_bf16 v[124:127], v[148:151], v[56:59], v[124:127]
    s_waitcnt vmcnt(11)
    s_barrier
    s_waitcnt lgkmcnt(0)
    v_mfma_f32_16x16x32_bf16 v[96:99], v[152:155], v[12:15], v[96:99]
    v_mfma_f32_16x16x32_bf16 v[100:103], v[156:159], v[12:15], v[100:103]
    v_mfma_f32_16x16x32_bf16 v[104:107], v[152:155], v[16:19], v[104:107]
    ds_read_b128 v[44:47], v28 offset:0
    ds_read_b128 v[48:51], v29 offset:0
    v_mfma_f32_16x16x32_bf16 v[108:111], v[156:159], v[16:19], v[108:111]
    ds_read_b128 v[52:55], v30 offset:0
    ds_read_b128 v[56:59], v31 offset:0
    v_mfma_f32_16x16x32_bf16 v[112:115], v[152:155], v[20:23], v[112:115]
    v_cvt_pk_bf16_f32 v88, v88, v89
    v_cvt_pk_bf16_f32 v89, v90, v91
    v_cvt_pk_bf16_f32 v90, v92, v93
    v_cvt_pk_bf16_f32 v91, v94, v95
    s_lshl_b32 s59, s48, 13
    s_add_u32 s59, s59, s55
    s_add_u32 s59, s59, 196608
    buffer_store_dwordx4 v[88:91], v2, s[16:19], s59 offen sc1
    v_mfma_f32_16x16x32_bf16 v[116:119], v[156:159], v[20:23], v[116:119]
    v_mfma_f32_16x16x32_bf16 v[120:123], v[152:155], v[24:27], v[120:123]
    v_mfma_f32_16x16x32_bf16 v[124:127], v[156:159], v[24:27], v[124:127]
    s_waitcnt lgkmcnt(0)
    v_mfma_f32_16x16x32_bf16 v[96:99], v[160:163], v[44:47], v[96:99]
    v_mfma_f32_16x16x32_bf16 v[100:103], v[164:167], v[44:47], v[100:103]
    v_mfma_f32_16x16x32_bf16 v[104:107], v[160:163], v[48:51], v[104:107]
    ds_read_b128 v[12:15], v28 offset:8192
    ds_read_b128 v[16:19], v29 offset:8192
    v_mfma_f32_16x16x32_bf16 v[108:111], v[164:167], v[48:51], v[108:111]
    ds_read_b128 v[20:23], v30 offset:8192
    ds_read_b128 v[24:27], v31 offset:8192
    v_mfma_f32_16x16x32_bf16 v[112:115], v[160:163], v[52:55], v[112:115]
    v_mfma_f32_16x16x32_bf16 v[116:119], v[164:167], v[52:55], v[116:119]
    v_mfma_f32_16x16x32_bf16 v[120:123], v[160:163], v[56:59], v[120:123]
    v_mfma_f32_16x16x32_bf16 v[124:127], v[164:167], v[56:59], v[124:127]
    s_waitcnt lgkmcnt(0)
    v_mfma_f32_16x16x32_bf16 v[96:99], v[168:171], v[12:15], v[96:99]
    v_mfma_f32_16x16x32_bf16 v[100:103], v[172:175], v[12:15], v[100:103]
    v_mfma_f32_16x16x32_bf16 v[104:107], v[168:171], v[16:19], v[104:107]
    ds_read_b128 v[44:47], v28 offset:16384
    ds_read_b128 v[48:51], v29 offset:16384
    v_mfma_f32_16x16x32_bf16 v[108:111], v[172:175], v[16:19], v[108:111]
    ds_read_b128 v[52:55], v30 offset:16384
    ds_read_b128 v[56:59], v31 offset:16384
    v_mfma_f32_16x16x32_bf16 v[112:115], v[168:171], v[20:23], v[112:115]
    v_mfma_f32_16x16x32_bf16 v[116:119], v[172:175], v[20:23], v[116:119]
    v_mfma_f32_16x16x32_bf16 v[120:123], v[168:171], v[24:27], v[120:123]
    v_mfma_f32_16x16x32_bf16 v[124:127], v[172:175], v[24:27], v[124:127]
    s_waitcnt lgkmcnt(0)
    v_mfma_f32_16x16x32_bf16 v[96:99], v[176:179], v[44:47], v[96:99]
    v_mfma_f32_16x16x32_bf16 v[100:103], v[180:183], v[44:47], v[100:103]
    v_mfma_f32_16x16x32_bf16 v[104:107], v[176:179], v[48:51], v[104:107]
    ds_read_b128 v[12:15], v28 offset:24576
    ds_read_b128 v[16:19], v29 offset:24576
    v_mfma_f32_16x16x32_bf16 v[108:111], v[180:183], v[48:51], v[108:111]
    ds_read_b128 v[20:23], v30 offset:24576
    ds_read_b128 v[24:27], v31 offset:24576
    v_mfma_f32_16x16x32_bf16 v[112:115], v[176:179], v[52:55], v[112:115]
    v_mfma_f32_16x16x32_bf16 v[116:119], v[180:183], v[52:55], v[116:119]
    v_mfma_f32_16x16x32_bf16 v[120:123], v[176:179], v[56:59], v[120:123]
    v_mfma_f32_16x16x32_bf16 v[124:127], v[180:183], v[56:59], v[124:127]
    s_waitcnt vmcnt(8)
    s_barrier
    s_waitcnt lgkmcnt(0)
    v_mfma_f32_16x16x32_bf16 v[96:99], v[184:187], v[12:15], v[96:99]
    v_mfma_f32_16x16x32_bf16 v[100:103], v[188:191], v[12:15], v[100:103]
    v_mfma_f32_16x16x32_bf16 v[104:107], v[184:187], v[16:19], v[104:107]
    ds_read_b128 v[44:47], v32 offset:0
    ds_read_b128 v[48:51], v33 offset:0
    v_mfma_f32_16x16x32_bf16 v[108:111], v[188:191], v[16:19], v[108:111]
    ds_read_b128 v[52:55], v34 offset:0
    ds_read_b128 v[56:59], v35 offset:0
    v_mfma_f32_16x16x32_bf16 v[112:115], v[184:187], v[20:23], v[112:115]
    v_mfma_f32_16x16x32_bf16 v[116:119], v[188:191], v[20:23], v[116:119]
    v_mfma_f32_16x16x32_bf16 v[120:123], v[184:187], v[24:27], v[120:123]
    v_mfma_f32_16x16x32_bf16 v[124:127], v[188:191], v[24:27], v[124:127]
    s_waitcnt lgkmcnt(0)
    v_mfma_f32_16x16x32_bf16 v[96:99], v[192:195], v[44:47], v[96:99]
    v_mfma_f32_16x16x32_bf16 v[100:103], v[196:199], v[44:47], v[100:103]
    v_mfma_f32_16x16x32_bf16 v[104:107], v[192:195], v[48:51], v[104:107]
    ds_read_b128 v[12:15], v32 offset:8192
    ds_read_b128 v[16:19], v33 offset:8192
    v_mfma_f32_16x16x32_bf16 v[108:111], v[196:199], v[48:51], v[108:111]
    ds_read_b128 v[20:23], v34 offset:8192
    ds_read_b128 v[24:27], v35 offset:8192
    v_mfma_f32_16x16x32_bf16 v[112:115], v[192:195], v[52:55], v[112:115]
    s_lshl_b32 s58, s57, 14
    buffer_load_dwordx2 v[132:133], v11, s[24:27], s58 offen offset:0 sc1
    buffer_load_dwordx2 v[128:129], v10, s[4:7], s58 offen offset:0
    buffer_load_dwordx2 v[134:135], v11, s[24:27], s58 offen offset:512 sc1
    buffer_load_dwordx2 v[130:131], v10, s[4:7], s58 offen offset:32
    v_mfma_f32_16x16x32_bf16 v[116:119], v[196:199], v[52:55], v[116:119]
    v_mfma_f32_16x16x32_bf16 v[120:123], v[192:195], v[56:59], v[120:123]
    v_mfma_f32_16x16x32_bf16 v[124:127], v[196:199], v[56:59], v[124:127]
    s_waitcnt lgkmcnt(0)
    v_mfma_f32_16x16x32_bf16 v[96:99], v[200:203], v[12:15], v[96:99]
    v_mfma_f32_16x16x32_bf16 v[100:103], v[204:207], v[12:15], v[100:103]
    v_mfma_f32_16x16x32_bf16 v[104:107], v[200:203], v[16:19], v[104:107]
    ds_read_b128 v[44:47], v28 offset:49152
    ds_read_b128 v[48:51], v29 offset:49152
    v_mfma_f32_16x16x32_bf16 v[108:111], v[204:207], v[16:19], v[108:111]
    ds_read_b128 v[52:55], v30 offset:49152
    ds_read_b128 v[56:59], v31 offset:49152
    v_mfma_f32_16x16x32_bf16 v[112:115], v[200:203], v[20:23], v[112:115]
    v_mfma_f32_16x16x32_bf16 v[116:119], v[204:207], v[20:23], v[116:119]
    v_mfma_f32_16x16x32_bf16 v[120:123], v[200:203], v[24:27], v[120:123]
    v_mfma_f32_16x16x32_bf16 v[124:127], v[204:207], v[24:27], v[124:127]
    s_waitcnt lgkmcnt(0)
    v_mfma_f32_16x16x32_bf16 v[96:99], v[208:211], v[44:47], v[96:99]
    v_mfma_f32_16x16x32_bf16 v[100:103], v[212:215], v[44:47], v[100:103]
    v_mfma_f32_16x16x32_bf16 v[104:107], v[208:211], v[48:51], v[104:107]
    ds_read_b128 v[12:15], v28 offset:57344
    ds_read_b128 v[16:19], v29 offset:57344
    v_mfma_f32_16x16x32_bf16 v[108:111], v[212:215], v[48:51], v[108:111]
    ds_read_b128 v[20:23], v30 offset:57344
    ds_read_b128 v[24:27], v31 offset:57344
    v_mfma_f32_16x16x32_bf16 v[112:115], v[208:211], v[52:55], v[112:115]
    v_mfma_f32_16x16x32_bf16 v[116:119], v[212:215], v[52:55], v[116:119]
    v_mfma_f32_16x16x32_bf16 v[120:123], v[208:211], v[56:59], v[120:123]
    v_mfma_f32_16x16x32_bf16 v[124:127], v[212:215], v[56:59], v[124:127]
    s_waitcnt vmcnt(8)
    s_barrier
    s_waitcnt lgkmcnt(0)
    v_mfma_f32_16x16x32_bf16 v[96:99], v[216:219], v[12:15], v[96:99]
    v_mfma_f32_16x16x32_bf16 v[100:103], v[220:223], v[12:15], v[100:103]
    v_mfma_f32_16x16x32_bf16 v[104:107], v[216:219], v[16:19], v[104:107]
    ds_read_b128 v[44:47], v28 offset:32768
    ds_read_b128 v[48:51], v29 offset:32768
    v_mfma_f32_16x16x32_bf16 v[108:111], v[220:223], v[16:19], v[108:111]
    ds_read_b128 v[52:55], v30 offset:32768
    ds_read_b128 v[56:59], v31 offset:32768
    v_mfma_f32_16x16x32_bf16 v[112:115], v[216:219], v[20:23], v[112:115]
    v_mfma_f32_16x16x32_bf16 v[116:119], v[220:223], v[20:23], v[116:119]
    v_mfma_f32_16x16x32_bf16 v[120:123], v[216:219], v[24:27], v[120:123]
    v_mfma_f32_16x16x32_bf16 v[124:127], v[220:223], v[24:27], v[124:127]
    s_waitcnt vmcnt(4)
    s_lshl_b32 s59, s48, 2
    s_add_u32 s59, s59, s56
    v_lshlrev_b32 v4, 10, v1
    v_mov_b32 v5, 1
    s_mov_b64 exec, 15
    buffer_store_dword v5, v4, s[24:27], s59 offen sc1
    s_mov_b64 exec, -1
    s_waitcnt lgkmcnt(0)
    v_mfma_f32_16x16x32_bf16 v[96:99], v[224:227], v[44:47], v[96:99]
    v_mfma_f32_16x16x32_bf16 v[100:103], v[228:231], v[44:47], v[100:103]
    v_mfma_f32_16x16x32_bf16 v[104:107], v[224:227], v[48:51], v[104:107]
    ds_read_b128 v[12:15], v28 offset:40960
    ds_read_b128 v[16:19], v29 offset:40960
    v_mfma_f32_16x16x32_bf16 v[108:111], v[228:231], v[48:51], v[108:111]
    ds_read_b128 v[20:23], v30 offset:40960
    ds_read_b128 v[24:27], v31 offset:40960
    v_mfma_f32_16x16x32_bf16 v[112:115], v[224:227], v[52:55], v[112:115]
    v_mfma_f32_16x16x32_bf16 v[116:119], v[228:231], v[52:55], v[116:119]
    v_mfma_f32_16x16x32_bf16 v[120:123], v[224:227], v[56:59], v[120:123]
    v_mfma_f32_16x16x32_bf16 v[124:127], v[228:231], v[56:59], v[124:127]
    s_cmp_eq_u32 s75, 0
    s_cbranch_scc1 KFD_167
    s_mov_b32 s64, 0
    s_cmp_eq_u32 0, 1
    s_branch KFD_170
KFD_168:
    v_mov_b32 v42, 4
    buffer_load_dword v42, v42, s[36:39], 0 offen sc1
    s_add_u32 s64, s64, 1
    s_cmp_gt_u32 s64, 100000
    s_waitcnt vmcnt(0)
KFD_170:
    v_cmp_gt_u32 vcc, 0xe0, v42
    s_cbranch_scc1 KFD_169
    s_cbranch_vccz KFD_169
    s_sleep 2
    s_branch KFD_168
KFD_169:
    v_lshlrev_b32 v42, 1, v10
    s_mov_b32 s60, 9322496
    buffer_load_dwordx4 v[160:163], v42, s[24:27], s60 offen offset:0 sc1
    buffer_load_dwordx4 v[164:167], v42, s[24:27], s60 offen offset:64 sc1
    s_add_u32 s60, s60, 32768
    buffer_load_dwordx4 v[168:171], v42, s[24:27], s60 offen offset:0 sc1
    buffer_load_dwordx4 v[172:175], v42, s[24:27], s60 offen offset:64 sc1
    s_add_u32 s60, s60, 32768
    buffer_load_dwordx4 v[176:179], v42, s[24:27], s60 offen offset:0 sc1
    buffer_load_dwordx4 v[180:183], v42, s[24:27], s60 offen offset:64 sc1
    s_add_u32 s60, s60, 32768
    buffer_load_dwordx4 v[184:187], v42, s[24:27], s60 offen offset:0 sc1
    buffer_load_dwordx4 v[188:191], v42, s[24:27], s60 offen offset:64 sc1
    s_add_u32 s60, s60, 32768
KFD_167:
    s_waitcnt lgkmcnt(0)
    v_mfma_f32_16x16x32_bf16 v[96:99], v[232:235], v[12:15], v[96:99]
    v_mfma_f32_16x16x32_bf16 v[100:103], v[236:239], v[12:15], v[100:103]
    v_mfma_f32_16x16x32_bf16 v[104:107], v[232:235], v[16:19], v[104:107]
    ds_read_b128 v[44:47], v32 offset:16384
    ds_read_b128 v[48:51], v33 offset:16384
    v_mfma_f32_16x16x32_bf16 v[108:111], v[236:239], v[16:19], v[108:111]
    ds_read_b128 v[52:55], v34 offset:16384
    ds_read_b128 v[56:59], v35 offset:16384
    v_mfma_f32_16x16x32_bf16 v[112:115], v[232:235], v[20:23], v[112:115]
    v_mfma_f32_16x16x32_bf16 v[116:119], v[236:239], v[20:23], v[116:119]
    v_mfma_f32_16x16x32_bf16 v[120:123], v[232:235], v[24:27], v[120:123]
    v_mfma_f32_16x16x32_bf16 v[124:127], v[236:239], v[24:27], v[124:127]
    s_waitcnt lgkmcnt(0)
    v_mfma_f32_16x16x32_bf16 v[96:99], v[240:243], v[44:47], v[96:99]
    v_mfma_f32_16x16x32_bf16 v[100:103], v[244:247], v[44:47], v[100:103]
    v_mfma_f32_16x16x32_bf16 v[104:107], v[240:243], v[48:51], v[104:107]
    ds_read_b128 v[12:15], v32 offset:24576
    ds_read_b128 v[16:19], v33 offset:24576
    v_mfma_f32_16x16x32_bf16 v[108:111], v[244:247], v[48:51], v[108:111]
    ds_read_b128 v[20:23], v34 offset:24576
    ds_read_b128 v[24:27], v35 offset:24576
    v_mfma_f32_16x16x32_bf16 v[112:115], v[240:243], v[52:55], v[112:115]
    v_mfma_f32_16x16x32_bf16 v[116:119], v[244:247], v[52:55], v[116:119]
    v_mfma_f32_16x16x32_bf16 v[120:123], v[240:243], v[56:59], v[120:123]
    v_mfma_f32_16x16x32_bf16 v[124:127], v[244:247], v[56:59], v[124:127]
    s_waitcnt lgkmcnt(0)
    v_mfma_f32_16x16x32_bf16 v[96:99], v[248:251], v[12:15], v[96:99]
    v_mfma_f32_16x16x32_bf16 v[100:103], v[252:255], v[12:15], v[100:103]
    v_mfma_f32_16x16x32_bf16 v[104:107], v[248:251], v[16:19], v[104:107]
    v_mfma_f32_16x16x32_bf16 v[108:111], v[252:255], v[16:19], v[108:111]
    v_mfma_f32_16x16x32_bf16 v[112:115], v[248:251], v[20:23], v[112:115]
    v_mfma_f32_16x16x32_bf16 v[116:119], v[252:255], v[20:23], v[116:119]
    v_mfma_f32_16x16x32_bf16 v[120:123], v[248:251], v[24:27], v[120:123]
    v_mfma_f32_16x16x32_bf16 v[124:127], v[252:255], v[24:27], v[124:127]
    s_nop 1
    v_cvt_pk_bf16_f32 v96, v96, v97
    v_cvt_pk_bf16_f32 v97, v98, v99
    v_cvt_pk_bf16_f32 v98, v100, v101
    v_cvt_pk_bf16_f32 v99, v102, v103
    s_lshl_b32 s59, s48, 13
    s_add_u32 s59, s59, s55
    s_add_u32 s59, s59, 262144
    buffer_store_dwordx4 v[96:99], v2, s[16:19], s59 offen sc1
    v_cvt_pk_bf16_f32 v104, v104, v105
    v_cvt_pk_bf16_f32 v105, v106, v107
    v_cvt_pk_bf16_f32 v106, v108, v109
    v_cvt_pk_bf16_f32 v107, v110, v111
    s_lshl_b32 s59, s48, 13
    s_add_u32 s59, s59, s55
    s_add_u32 s59, s59, 327680
    buffer_store_dwordx4 v[104:107], v2, s[16:19], s59 offen sc1
    v_cvt_pk_bf16_f32 v112, v112, v113
    v_cvt_pk_bf16_f32 v113, v114, v115
    v_cvt_pk_bf16_f32 v114, v116, v117
    v_cvt_pk_bf16_f32 v115, v118, v119
    s_lshl_b32 s59, s48, 13
    s_add_u32 s59, s59, s55
    s_add_u32 s59, s59, 393216
    buffer_store_dwordx4 v[112:115], v2, s[16:19], s59 offen sc1
    v_cvt_pk_bf16_f32 v120, v120, v121
    v_cvt_pk_bf16_f32 v121, v122, v123
    v_cvt_pk_bf16_f32 v122, v124, v125
    v_cvt_pk_bf16_f32 v123, v126, v127
    s_lshl_b32 s59, s48, 13
    s_add_u32 s59, s59, s55
    s_add_u32 s59, s59, 458752
    buffer_store_dwordx4 v[120:123], v2, s[16:19], s59 offen sc1
    v_mov_b32 v136, 0
    v_mov_b32 v137, 0
    v_mov_b32 v138, 0
    v_mov_b32 v139, 0
    v_mov_b32 v140, 0
    v_mov_b32 v141, 0
    v_mov_b32 v142, 0
    v_mov_b32 v143, 0
    s_waitcnt vmcnt(0)
    s_lshl_b32 s59, s48, 2
    s_add_u32 s59, s59, s56
    s_add_u32 s59, s59, 4096
    v_lshlrev_b32 v4, 10, v1
    v_mov_b32 v5, 1
    s_mov_b64 exec, 15
    buffer_store_dword v5, v4, s[24:27], s59 offen sc1
    s_mov_b64 exec, -1
    s_cmp_eq_u32 s75, 0
    s_cbranch_scc1 KF_DNOY
    s_lshl_b32 s60, s57, 4
    v_add_u32 v4, s60, v41
    v_cmp_eq_u32 vcc, s54, v4
    v_add_f32 v136, v160, v168
    v_add_f32 v176, v176, v184
    v_add_f32 v137, v161, v169
    v_add_f32 v177, v177, v185
    v_add_f32 v138, v162, v170
    v_add_f32 v178, v178, v186
    v_add_f32 v139, v163, v171
    v_add_f32 v179, v179, v187
    v_add_f32 v140, v164, v172
    v_add_f32 v180, v180, v188
    v_add_f32 v141, v165, v173
    v_add_f32 v181, v181, v189
    v_add_f32 v142, v166, v174
    v_add_f32 v182, v182, v190
    v_add_f32 v143, v167, v175
    v_add_f32 v183, v183, v191
    v_add_f32 v136, v136, v176
    v_add_f32 v137, v137, v177
    v_add_f32 v138, v138, v178
    v_add_f32 v139, v139, v179
    v_add_f32 v140, v140, v180
    v_add_f32 v141, v141, v181
    v_add_f32 v142, v142, v182
    v_add_f32 v143, v143, v183
    v_add_f32_dpp v136, v136, v136 quad_perm:[1,0,3,2] row_mask:0xf bank_mask:0xf
    v_add_f32_dpp v137, v137, v137 quad_perm:[1,0,3,2] row_mask:0xf bank_mask:0xf
    v_add_f32_dpp v138, v138, v138 quad_perm:[1,0,3,2] row_mask:0xf bank_mask:0xf
    v_add_f32_dpp v139, v139, v139 quad_perm:[1,0,3,2] row_mask:0xf bank_mask:0xf
    v_add_f32_dpp v140, v140, v140 quad_perm:[1,0,3,2] row_mask:0xf bank_mask:0xf
    v_add_f32_dpp v141, v141, v141 quad_perm:[1,0,3,2] row_mask:0xf bank_mask:0xf
    v_add_f32_dpp v142, v142, v142 quad_perm:[1,0,3,2] row_mask:0xf bank_mask:0xf
    v_add_f32_dpp v143, v143, v143 quad_perm:[1,0,3,2] row_mask:0xf bank_mask:0xf
    v_add_f32_dpp v136, v136, v136 quad_perm:[2,3,0,1] row_mask:0xf bank_mask:0xf
    v_add_f32_dpp v137, v137, v137 quad_perm:[2,3,0,1] row_mask:0xf bank_mask:0xf
    v_add_f32_dpp v138, v138, v138 quad_perm:[2,3,0,1] row_mask:0xf bank_mask:0xf
    v_add_f32_dpp v139, v139, v139 quad_perm:[2,3,0,1] row_mask:0xf bank_mask:0xf
    v_add_f32_dpp v140, v140, v140 quad_perm:[2,3,0,1] row_mask:0xf bank_mask:0xf
    v_add_f32_dpp v141, v141, v141 quad_perm:[2,3,0,1] row_mask:0xf bank_mask:0xf
    v_add_f32_dpp v142, v142, v142 quad_perm:[2,3,0,1] row_mask:0xf bank_mask:0xf
    v_add_f32_dpp v143, v143, v143 quad_perm:[2,3,0,1] row_mask:0xf bank_mask:0xf
    v_add_f32_dpp v136, v136, v136 row_half_mirror row_mask:0xf bank_mask:0xf
    v_add_f32_dpp v137, v137, v137 row_half_mirror row_mask:0xf bank_mask:0xf
    v_add_f32_dpp v138, v138, v138 row_half_mirror row_mask:0xf bank_mask:0xf
    v_add_f32_dpp v139, v139, v139 row_half_mirror row_mask:0xf bank_mask:0xf
    v_add_f32_dpp v140, v140, v140 row_half_mirror row_mask:0xf bank_mask:0xf
    v_add_f32_dpp v141, v141, v141 row_half_mirror row_mask:0xf bank_mask:0xf
    v_add_f32_dpp v142, v142, v142 row_half_mirror row_mask:0xf bank_mask:0xf
    v_add_f32_dpp v143, v143, v143 row_half_mirror row_mask:0xf bank_mask:0xf
    v_add_f32_dpp v136, v136, v136 row_mirror row_mask:0xf bank_mask:0xf
    v_add_f32_dpp v137, v137, v137 row_mirror row_mask:0xf bank_mask:0xf
    v_add_f32_dpp v138, v138, v138 row_mirror row_mask:0xf bank_mask:0xf
    v_add_f32_dpp v139, v139, v139 row_mirror row_mask:0xf bank_mask:0xf
    v_add_f32_dpp v140, v140, v140 row_mirror row_mask:0xf bank_mask:0xf
    v_add_f32_dpp v141, v141, v141 row_mirror row_mask:0xf bank_mask:0xf
    v_add_f32_dpp v142, v142, v142 row_mirror row_mask:0xf bank_mask:0xf
    v_add_f32_dpp v143, v143, v143 row_mirror row_mask:0xf bank_mask:0xf
    v_cvt_pk_bf16_f32 v136, v136, v136
    v_lshlrev_b32 v136, 16, v136
    v_mul_f32 v136, v136, v40
    v_cvt_pk_bf16_f32 v136, v136, v136
    v_lshlrev_b32 v136, 16, v136
    v_cndmask_b32 v136, 0, v136, vcc
    v_cvt_pk_bf16_f32 v137, v137, v137
    v_lshlrev_b32 v137, 16, v137
    v_mul_f32 v137, v137, v40
    v_cvt_pk_bf16_f32 v137, v137, v137
    v_lshlrev_b32 v137, 16, v137
    v_cndmask_b32 v137, 0, v137, vcc
    v_cvt_pk_bf16_f32 v138, v138, v138
    v_lshlrev_b32 v138, 16, v138
    v_mul_f32 v138, v138, v40
    v_cvt_pk_bf16_f32 v138, v138, v138
    v_lshlrev_b32 v138, 16, v138
    v_cndmask_b32 v138, 0, v138, vcc
    v_cvt_pk_bf16_f32 v139, v139, v139
    v_lshlrev_b32 v139, 16, v139
    v_mul_f32 v139, v139, v40
    v_cvt_pk_bf16_f32 v139, v139, v139
    v_lshlrev_b32 v139, 16, v139
    v_cndmask_b32 v139, 0, v139, vcc
    v_cvt_pk_bf16_f32 v140, v140, v140
    v_lshlrev_b32 v140, 16, v140
    v_mul_f32 v140, v140, v40
    v_cvt_pk_bf16_f32 v140, v140, v140
    v_lshlrev_b32 v140, 16, v140
    v_cndmask_b32 v140, 0, v140, vcc
    v_cvt_pk_bf16_f32 v141, v141, v141
    v_lshlrev_b32 v141, 16, v141
    v_mul_f32 v141, v141, v40
    v_cvt_pk_bf16_f32 v141, v141, v141
    v_lshlrev_b32 v141, 16, v141
    v_cndmask_b32 v141, 0, v141, vcc
    v_cvt_pk_bf16_f32 v142, v142, v142
    v_lshlrev_b32 v142, 16, v142
    v_mul_f32 v142, v142, v40
    v_cvt_pk_bf16_f32 v142, v142, v142
    v_lshlrev_b32 v142, 16, v142
    v_cndmask_b32 v142, 0, v142, vcc
    v_cvt_pk_bf16_f32 v143, v143, v143
    v_lshlrev_b32 v143, 16, v143
    v_mul_f32 v143, v143, v40
    v_cvt_pk_bf16_f32 v143, v143, v143
    v_lshlrev_b32 v143, 16, v143
    v_cndmask_b32 v143, 0, v143, vcc
KF_DNOY:
    v_lshlrev_b32 v144, 16, v132
    v_and_b32 v145, 0xffff0000, v132
    v_lshlrev_b32 v146, 16, v133
    v_and_b32 v147, 0xffff0000, v133
    v_lshlrev_b32 v148, 16, v134
    v_and_b32 v149, 0xffff0000, v134
    v_lshlrev_b32 v150, 16, v135
    v_and_b32 v151, 0xffff0000, v135
    v_add_f32 v144, v144, v136
    v_add_f32 v145, v145, v137
    v_add_f32 v146, v146, v138
    v_add_f32 v147, v147, v139
    v_add_f32 v148, v148, v140
    v_add_f32 v149, v149, v141
    v_add_f32 v150, v150, v142
    v_add_f32 v151, v151, v143
    v_cvt_pk_bf16_f32 v132, v144, v145
    v_cvt_pk_bf16_f32 v133, v146, v147
    v_cvt_pk_bf16_f32 v134, v148, v149
    v_cvt_pk_bf16_f32 v135, v150, v151
    v_lshlrev_b32 v144, 16, v132
    v_and_b32 v145, 0xffff0000, v132
    v_lshlrev_b32 v146, 16, v133
    v_and_b32 v147, 0xffff0000, v133
    v_lshlrev_b32 v148, 16, v134
    v_and_b32 v149, 0xffff0000, v134
    v_lshlrev_b32 v150, 16, v135
    v_and_b32 v151, 0xffff0000, v135
    v_mul_f32 v136, 0xbfb8aa3b, v144
    v_mul_f32 v137, 0xbfb8aa3b, v145
    v_mul_f32 v138, 0xbfb8aa3b, v146
    v_mul_f32 v139, 0xbfb8aa3b, v147
    v_mul_f32 v140, 0xbfb8aa3b, v148
    v_mul_f32 v141, 0xbfb8aa3b, v149
    v_mul_f32 v142, 0xbfb8aa3b, v150
    v_mul_f32 v143, 0xbfb8aa3b, v151
    v_exp_f32 v136, v136
    v_exp_f32 v137, v137
    v_exp_f32 v138, v138
    v_exp_f32 v139, v139
    v_exp_f32 v140, v140
    v_exp_f32 v141, v141
    v_exp_f32 v142, v142
    v_exp_f32 v143, v143
    v_add_f32 v136, 1.0, v136
    v_add_f32 v137, 1.0, v137
    v_add_f32 v138, 1.0, v138
    v_add_f32 v139, 1.0, v139
    v_add_f32 v140, 1.0, v140
    v_add_f32 v141, 1.0, v141
    v_add_f32 v142, 1.0, v142
    v_add_f32 v143, 1.0, v143
    v_rcp_f32 v136, v136
    v_rcp_f32 v137, v137
    v_rcp_f32 v138, v138
    v_rcp_f32 v139, v139
    v_rcp_f32 v140, v140
    v_rcp_f32 v141, v141
    v_rcp_f32 v142, v142
    v_rcp_f32 v143, v143
    v_mul_f32 v144, v144, v136
    v_mul_f32 v145, v145, v137
    v_mul_f32 v146, v146, v138
    v_mul_f32 v147, v147, v139
    v_mul_f32 v148, v148, v140
    v_mul_f32 v149, v149, v141
    v_mul_f32 v150, v150, v142
    v_mul_f32 v151, v151, v143
    v_cvt_pk_bf16_f32 v132, v144, v145
    v_cvt_pk_bf16_f32 v133, v146, v147
    v_cvt_pk_bf16_f32 v134, v148, v149
    v_cvt_pk_bf16_f32 v135, v150, v151
    v_lshlrev_b32 v144, 16, v132
    v_and_b32 v145, 0xffff0000, v132
    v_lshlrev_b32 v146, 16, v133
    v_and_b32 v147, 0xffff0000, v133
    v_lshlrev_b32 v148, 16, v134
    v_and_b32 v149, 0xffff0000, v134
    v_lshlrev_b32 v150, 16, v135
    v_and_b32 v151, 0xffff0000, v135
    v_lshlrev_b32 v152, 16, v128
    v_and_b32 v153, 0xffff0000, v128
    v_lshlrev_b32 v154, 16, v129
    v_and_b32 v155, 0xffff0000, v129
    v_lshlrev_b32 v156, 16, v130
    v_and_b32 v157, 0xffff0000, v130
    v_lshlrev_b32 v158, 16, v131
    v_and_b32 v159, 0xffff0000, v131
    s_lshl_b32 s59, s48, 10
    s_add_u32 s56, s56, s59
    s_lshl_b32 s59, s48, 16
    s_add_u32 s55, s55, s59
    s_mov_b32 s50, 0
    s_mov_b32 s64, 0
KF_DP:
    buffer_load_dword v7, v43, s[24:27], s56 offen sc1
    s_add_u32 s64, s64, 1
    s_waitcnt vmcnt(0)
    v_cmp_ne_u32 vcc, 0, v7
    s_cmp_gt_u32 s64, 100000
    s_cselect_b32 s51, -1, vcc_lo
    s_and_b32 s51, s51, 0xff
    s_andn2_b32 s60, s51, s50
    s_mov_b32 s50, s51
    s_bitcmp0_b32 s60, 0
    s_cbranch_scc1 KFD_171
    s_add_u32 s59, s55, 0
    buffer_load_dwordx4 v[160:163], v2, s[16:19], s59 offen sc1
KFD_171:
    s_bitcmp0_b32 s60, 1
    s_cbranch_scc1 KFD_172
    s_add_u32 s59, s55, 8192
    buffer_load_dwordx4 v[164:167], v2, s[16:19], s59 offen sc1
KFD_172:
    s_bitcmp0_b32 s60, 2
    s_cbranch_scc1 KFD_173
    s_add_u32 s59, s55, 16384
    buffer_load_dwordx4 v[168:171], v2, s[16:19], s59 offen sc1
KFD_173:
    s_bitcmp0_b32 s60, 3
    s_cbranch_scc1 KFD_174
    s_add_u32 s59, s55, 24576
    buffer_load_dwordx4 v[172:175], v2, s[16:19], s59 offen sc1
KFD_174:
    s_bitcmp0_b32 s60, 4
    s_cbranch_scc1 KFD_175
    s_add_u32 s59, s55, 32768
    buffer_load_dwordx4 v[176:179], v2, s[16:19], s59 offen sc1
KFD_175:
    s_bitcmp0_b32 s60, 5
    s_cbranch_scc1 KFD_176
    s_add_u32 s59, s55, 40960
    buffer_load_dwordx4 v[180:183], v2, s[16:19], s59 offen sc1
KFD_176:
    s_bitcmp0_b32 s60, 6
    s_cbranch_scc1 KFD_177
    s_add_u32 s59, s55, 49152
    buffer_load_dwordx4 v[184:187], v2, s[16:19], s59 offen sc1
KFD_177:
    s_bitcmp0_b32 s60, 7
    s_cbranch_scc1 KFD_178
    s_add_u32 s59, s55, 57344
    buffer_load_dwordx4 v[188:191], v2, s[16:19], s59 offen sc1
KFD_178:
    s_cmp_eq_u32 s50, 0xff
    s_cbranch_scc1 KF_DQ
    s_sleep 2
    s_branch KF_DP
KF_DQ:
    s_waitcnt vmcnt(0)
    v_lshlrev_b32 v64, 16, v160
    v_and_b32 v65, 0xffff0000, v160
    v_lshlrev_b32 v66, 16, v161
    v_and_b32 v67, 0xffff0000, v161
    v_lshlrev_b32 v68, 16, v162
    v_and_b32 v69, 0xffff0000, v162
    v_lshlrev_b32 v70, 16, v163
    v_and_b32 v71, 0xffff0000, v163
    v_lshlrev_b32 v72, 16, v164
    v_and_b32 v73, 0xffff0000, v164
    v_lshlrev_b32 v74, 16, v165
    v_and_b32 v75, 0xffff0000, v165
    v_lshlrev_b32 v76, 16, v166
    v_and_b32 v77, 0xffff0000, v166
    v_lshlrev_b32 v78, 16, v167
    v_and_b32 v79, 0xffff0000, v167
    v_add_f32 v64, v64, v72
    v_add_f32 v65, v65, v73
    v_add_f32 v66, v66, v74
    v_add_f32 v67, v67, v75
    v_add_f32 v68, v68, v76
    v_add_f32 v69, v69, v77
    v_add_f32 v70, v70, v78
    v_add_f32 v71, v71, v79
    v_lshlrev_b32 v72, 16, v168
    v_and_b32 v73, 0xffff0000, v168
    v_lshlrev_b32 v74, 16, v169
    v_and_b32 v75, 0xffff0000, v169
    v_lshlrev_b32 v76, 16, v170
    v_and_b32 v77, 0xffff0000, v170
    v_lshlrev_b32 v78, 16, v171
    v_and_b32 v79, 0xffff0000, v171
    v_add_f32 v64, v64, v72
    v_add_f32 v65, v65, v73
    v_add_f32 v66, v66, v74
    v_add_f32 v67, v67, v75
    v_add_f32 v68, v68, v76
    v_add_f32 v69, v69, v77
    v_add_f32 v70, v70, v78
    v_add_f32 v71, v71, v79
    v_lshlrev_b32 v72, 16, v172
    v_and_b32 v73, 0xffff0000, v172
    v_lshlrev_b32 v74, 16, v173
    v_and_b32 v75, 0xffff0000, v173
    v_lshlrev_b32 v76, 16, v174
    v_and_b32 v77, 0xffff0000, v174
    v_lshlrev_b32 v78, 16, v175
    v_and_b32 v79, 0xffff0000, v175
    v_add_f32 v64, v64, v72
    v_add_f32 v65, v65, v73
    v_add_f32 v66, v66, v74
    v_add_f32 v67, v67, v75
    v_add_f32 v68, v68, v76
    v_add_f32 v69, v69, v77
    v_add_f32 v70, v70, v78
    v_add_f32 v71, v71, v79
    v_lshlrev_b32 v72, 16, v176
    v_and_b32 v73, 0xffff0000, v176
    v_lshlrev_b32 v74, 16, v177
    v_and_b32 v75, 0xffff0000, v177
    v_lshlrev_b32 v76, 16, v178
    v_and_b32 v77, 0xffff0000, v178
    v_lshlrev_b32 v78, 16, v179
    v_and_b32 v79, 0xffff0000, v179
    v_add_f32 v64, v64, v72
    v_add_f32 v65, v65, v73
    v_add_f32 v66, v66, v74
    v_add_f32 v67, v67, v75
    v_add_f32 v68, v68, v76
    v_add_f32 v69, v69, v77
    v_add_f32 v70, v70, v78
    v_add_f32 v71, v71, v79
    v_lshlrev_b32 v72, 16, v180
    v_and_b32 v73, 0xffff0000, v180
    v_lshlrev_b32 v74, 16, v181
    v_and_b32 v75, 0xffff0000, v181
    v_lshlrev_b32 v76, 16, v182
    v_and_b32 v77, 0xffff0000, v182
    v_lshlrev_b32 v78, 16, v183
    v_and_b32 v79, 0xffff0000, v183
    v_add_f32 v64, v64, v72
    v_add_f32 v65, v65, v73
    v_add_f32 v66, v66, v74
    v_add_f32 v67, v67, v75
    v_add_f32 v68, v68, v76
    v_add_f32 v69, v69, v77
    v_add_f32 v70, v70, v78
    v_add_f32 v71, v71, v79
    v_lshlrev_b32 v72, 16, v184
    v_and_b32 v73, 0xffff0000, v184
    v_lshlrev_b32 v74, 16, v185
    v_and_b32 v75, 0xffff0000, v185
    v_lshlrev_b32 v76, 16, v186
    v_and_b32 v77, 0xffff0000, v186
    v_lshlrev_b32 v78, 16, v187
    v_and_b32 v79, 0xffff0000, v187
    v_add_f32 v64, v64, v72
    v_add_f32 v65, v65, v73
    v_add_f32 v66, v66, v74
    v_add_f32 v67, v67, v75
    v_add_f32 v68, v68, v76
    v_add_f32 v69, v69, v77
    v_add_f32 v70, v70, v78
    v_add_f32 v71, v71, v79
    v_lshlrev_b32 v72, 16, v188
    v_and_b32 v73, 0xffff0000, v188
    v_lshlrev_b32 v74, 16, v189
    v_and_b32 v75, 0xffff0000, v189
    v_lshlrev_b32 v76, 16, v190
    v_and_b32 v77, 0xffff0000, v190
    v_lshlrev_b32 v78, 16, v191
    v_and_b32 v79, 0xffff0000, v191
    v_add_f32 v64, v64, v72
    v_add_f32 v65, v65, v73
    v_add_f32 v66, v66, v74
    v_add_f32 v67, v67, v75
    v_add_f32 v68, v68, v76
    v_add_f32 v69, v69, v77
    v_add_f32 v70, v70, v78
    v_add_f32 v71, v71, v79
    v_cvt_pk_bf16_f32 v72, v64, v65
    v_cvt_pk_bf16_f32 v73, v66, v67
    v_cvt_pk_bf16_f32 v74, v68, v69
    v_cvt_pk_bf16_f32 v75, v70, v71
    v_lshlrev_b32 v64, 16, v72
    v_and_b32 v65, 0xffff0000, v72
    v_lshlrev_b32 v66, 16, v73
    v_and_b32 v67, 0xffff0000, v73
    v_lshlrev_b32 v68, 16, v74
    v_and_b32 v69, 0xffff0000, v74
    v_lshlrev_b32 v70, 16, v75
    v_and_b32 v71, 0xffff0000, v75
    v_mul_f32 v64, v64, v144
    v_mul_f32 v65, v65, v145
    v_mul_f32 v66, v66, v146
    v_mul_f32 v67, v67, v147
    v_mul_f32 v68, v68, v148
    v_mul_f32 v69, v69, v149
    v_mul_f32 v70, v70, v150
    v_mul_f32 v71, v71, v151
    v_cvt_pk_bf16_f32 v72, v64, v65
    v_cvt_pk_bf16_f32 v73, v66, v67
    v_cvt_pk_bf16_f32 v74, v68, v69
    v_cvt_pk_bf16_f32 v75, v70, v71
    v_lshlrev_b32 v64, 16, v72
    v_and_b32 v65, 0xffff0000, v72
    v_lshlrev_b32 v66, 16, v73
    v_and_b32 v67, 0xffff0000, v73
    v_lshlrev_b32 v68, 16, v74
    v_and_b32 v69, 0xffff0000, v74
    v_lshlrev_b32 v70, 16, v75
    v_and_b32 v71, 0xffff0000, v75
    v_add_f32 v64, v64, v152
    v_add_f32 v65, v65, v153
    v_add_f32 v66, v66, v154
    v_add_f32 v67, v67, v155
    v_add_f32 v68, v68, v156
    v_add_f32 v69, v69, v157
    v_add_f32 v70, v70, v158
    v_add_f32 v71, v71, v159
    v_cvt_pk_bf16_f32 v64, v64, v65
    v_cvt_pk_bf16_f32 v65, v66, v67
    v_cvt_pk_bf16_f32 v66, v68, v69
    v_cvt_pk_bf16_f32 v67, v70, v71
    buffer_store_dwordx2 v[64:65], v10, s[12:15], s58 offen offset:0
    buffer_store_dwordx2 v[66:67], v10, s[12:15], s58 offen offset:32
    s_endpgm
KF_END:
    s_endpgm

.section .rodata,"a"
.p2align 6
.amdhsa_kernel kvattn_kernel
  .amdhsa_next_free_vgpr 256
  .amdhsa_next_free_sgpr 102
  .amdhsa_accum_offset 256
  .amdhsa_group_segment_fixed_size 0
  .amdhsa_kernarg_size 112
  .amdhsa_user_sgpr_count 2
  .amdhsa_user_sgpr_kernarg_segment_ptr 1
  .amdhsa_system_sgpr_workgroup_id_x 1
  .amdhsa_float_denorm_mode_32 3
  .amdhsa_float_denorm_mode_16_64 3
.end_amdhsa_kernel
```
